```python
import torch

def _softmax(x, axis=-1):
    return torch.softmax(x, dim=axis)

def _gelu(x):
    return torch.nn.functional.gelu(x, approximate='tanh')

def _silu(x):
    return torch.nn.functional.silu(x)

def _sigmoid(x):
    return torch.sigmoid(x)

def _layernorm(x, axis=-1, eps=1e-05):
    m = x.mean(dim=axis, keepdim=True)
    v = x.var(dim=axis, keepdim=True, unbiased=False)
    return (x - m) / torch.sqrt(v + eps)

def _scatter_add(tgt, idx, src, axis=0):
    return tgt.clone().index_add_(axis, idx, src)

def _segment_sum(src, seg, n):
    out = torch.zeros((n,) + src.shape[1:], dtype=src.dtype)
    return out.index_add_(0, seg, src)

def _pad(x, pw):
    flat = tuple((v for pair in reversed(pw) for v in pair))
    return torch.nn.functional.pad(x, flat)
kernel_name = 'adaLN_cond__sliding_block__glu_gated_bilinear__prompt'

def setup_inputs():

    _w = lambda a: (lambda t: t.to(torch.bfloat16) if t.is_floating_point() else t)(torch.as_tensor(a))

    def _A_setup():
        B, S, D = (1, 2048, 640)
        return {'x': _w((lambda *s: torch.randn(*s, dtype=torch.bfloat16) * 0.05)(B, S, D)), 'wqkv': _w((lambda *s: torch.randn(*s, dtype=torch.bfloat16) * 0.05)(D, 3 * D)), 'wo': _w((lambda *s: torch.randn(*s, dtype=torch.bfloat16) * 0.05)(D, D))}
    _A_in = _A_setup()

    def _B_setup():
        B, S, D, F = (1, 2048, 640, 1536)
        return {'x': _w((lambda *s: torch.randn(*s, dtype=torch.bfloat16) * 0.05)(B, S, D)), 'w_gate': _w((lambda *s: torch.randn(*s, dtype=torch.bfloat16) * 0.8)(D, F) * D ** (-0.5)), 'w_up': _w((lambda *s: torch.randn(*s, dtype=torch.bfloat16) * 0.8)(D, F) * D ** (-0.5)), 'w_down': _w((lambda *s: torch.randn(*s, dtype=torch.bfloat16) * 0.8)(F, D) * F ** (-0.5))}
    _B_in = _B_setup()
    return {'A_x': _A_in['x'], 'A_wqkv': _A_in['wqkv'], 'A_wo': _A_in['wo'], 'B_x': _B_in['x'], 'B_w_gate': _B_in['w_gate'], 'B_w_up': _B_in['w_up'], 'B_w_down': _B_in['w_down'], 'c': _w((lambda *s: torch.randn(*s, dtype=torch.bfloat16) * 0.1)(1, 640) * 8.0), 'w_mod': _w((lambda *s: torch.randn(*s, dtype=torch.bfloat16) * 0.1)(640, 6 * 640) * 640 ** (-0.5) * 8.0)}

def reference(A_x, A_wqkv, A_wo, B_x, B_w_gate, B_w_up, B_w_down, c, w_mod):

    def _A_ref(x, wqkv, wo):
        B, S, D = x.shape
        H = 32
        Dh = D // H
        W = 256
        qkv = (lambda x, *d: x.permute(*d))((x @ wqkv).reshape(B, S, 3, H, Dh), 2, 0, 3, 1, 4)
        q, k, v = (qkv[0], qkv[1], qkv[2])
        scores = torch.einsum('bhqd,bhkd->bhqk', q, k) * Dh ** (-0.5)
        idx = torch.arange(S)
        mask = (idx[:, None] - idx[None, :] >= 0) & (idx[:, None] - idx[None, :] < W)
        scores = torch.where(mask[None, None], scores, -1000000000.0)
        p = _softmax(scores, axis=-1)
        o = torch.einsum('bhqk,bhkd->bhqd', p, v)
        return (lambda x, *d: x.permute(*d))(o, 0, 2, 1, 3).reshape(B, S, D) @ wo

    def _B_ref(x, w_gate, w_up, w_down):
        g = torch.einsum('bsd,df->bsf', x, w_gate)
        u = torch.einsum('bsd,df->bsf', x, w_up)
        h = g * u
        return torch.einsum('bsf,fd->bsd', h, w_down)
    x = A_x
    mod = (_silu(c) @ w_mod).reshape(c.shape[0], 6, 1, -1)
    sa, ca, ga, sb, cb, gb = (mod[:, 0].clone(), mod[:, 1].clone(), mod[:, 2].clone(), mod[:, 3].clone(), mod[:, 4].clone(), mod[:, 5].clone())
    h = _layernorm(x, axis=-1) * (1 + ca) + sa
    x = x + ga * _A_ref(h, A_wqkv, A_wo)
    h = _layernorm(x, axis=-1) * (1 + cb) + sb
    x = x + gb * _B_ref(h, B_w_gate, B_w_up, B_w_down)
    return x
```

```asm
; @launch kernel=k0_kernel grid=(992,1,1) block=(256,1,1) lds=16384
; @launch kernel=kp_kernel grid=(256,1,1) block=(256,1,1) lds=163840
.amdgcn_target "amdgcn-amd-amdhsa--gfx950"
.text
.globl k0_kernel
.p2align 8
.type k0_kernel,@function
k0_kernel:
    s_cmp_ge_u32 s2, 992
    s_cbranch_scc1 K0_END
    s_load_dwordx4 s[4:7], s[0:1], 8
    s_load_dwordx4 s[8:11], s[0:1], 32
    s_load_dwordx4 s[12:15], s[0:1], 48
    s_load_dwordx2 s[16:17], s[0:1], 64
    s_load_dwordx2 s[18:19], s[0:1], 88
    s_load_dwordx2 s[20:21], s[0:1], 0
    s_load_dwordx2 s[68:69], s[0:1], 80
    v_lshrrev_b32 v1, 6, v0
    s_nop 0
    v_readfirstlane_b32 s3, v1
    v_and_b32 v2, 63, v0
    s_waitcnt lgkmcnt(0)
    s_mov_b32 s32, s18
    s_mov_b32 s33, s19
    s_mov_b32 s34, 54525952
    s_mov_b32 s35, 131072
    s_cmp_ge_u32 s2, 240
    s_cbranch_scc1 K0_RELAY
    s_cmp_ge_u32 s2, 240
    s_cbranch_scc1 K0_END
    s_mov_b32 s24, s16
    s_mov_b32 s25, s17
    s_mov_b32 s26, 4915200
    s_mov_b32 s27, 131072
    s_mov_b32 s28, s14
    s_mov_b32 s29, s15
    s_mov_b32 s30, 1280
    s_mov_b32 s31, 131072
    s_lshr_b32 s22, s2, 2
    s_and_b32 s23, s2, 3
    v_lshrrev_b32 v3, 3, v0
    v_and_b32 v4, 7, v0
    v_mul_u32_u24 v5, 7680, v3
    v_lshl_add_u32 v5, v4, 4, v5
    v_lshlrev_b32 v6, 1, v3
    s_mul_i32 s36, s23, 320
    buffer_load_ushort v10, v6, s[28:31], s36 offen offset:0
    buffer_load_ushort v11, v6, s[28:31], s36 offen offset:64
    buffer_load_ushort v12, v6, s[28:31], s36 offen offset:128
    buffer_load_ushort v13, v6, s[28:31], s36 offen offset:192
    buffer_load_ushort v14, v6, s[28:31], s36 offen offset:256
    s_lshl_b32 s37, s22, 7
    s_mul_i32 s38, s23, 1228800
    s_add_u32 s37, s37, s38
    buffer_load_dwordx4 v[16:19], v5, s[24:27], s37 offen
    s_add_u32 s37, s37, 245760
    buffer_load_dwordx4 v[20:23], v5, s[24:27], s37 offen
    s_add_u32 s37, s37, 245760
    buffer_load_dwordx4 v[24:27], v5, s[24:27], s37 offen
    s_add_u32 s37, s37, 245760
    buffer_load_dwordx4 v[28:31], v5, s[24:27], s37 offen
    s_add_u32 s37, s37, 245760
    buffer_load_dwordx4 v[32:35], v5, s[24:27], s37 offen
    s_mov_b32 s56, s20
    s_mov_b32 s57, s21
    s_mov_b32 s58, 2621440
    s_mov_b32 s59, 131072
    s_and_b32 s60, s2, 7
    s_lshl_b32 s60, s60, 8
    s_lshr_b32 s61, s2, 3
    s_lshl_b32 s61, s61, 3
    s_add_u32 s60, s60, s61
    s_lshl_b32 s61, s3, 1
    s_add_u32 s60, s60, s61
    s_mul_i32 s60, s60, 1280
    v_lshlrev_b32 v9, 7, v2
    s_mov_b64 exec, 0xfffff
    buffer_load_dword v64, v9, s[56:59], s60 offen
    s_mov_b64 exec, -1
    s_getpc_b64 s[60:61]
K0_PC_1:
    s_add_u32 s60, s60, kp_kernel-K0_PC_1
    s_addc_u32 s61, s61, 0
    s_lshr_b32 s62, s2, 3
    s_lshl_b32 s62, s62, 2
    s_add_u32 s62, s62, s3
    s_lshl_b32 s62, s62, 10
    v_add_u32 v9, s62, v9
    v_min_u32 v9, KP_CODE_END-kp_kernel-4, v9
    s_mov_b64 exec, 0xff
    global_load_dword v65, v9, s[60:61]
    s_mov_b64 exec, -1
    s_waitcnt vmcnt(7)
    v_lshlrev_b32 v10, 16, v10
    v_mul_f32 v7, 0xbfb8aa3b, v10
    v_exp_f32 v7, v7
    s_nop 0
    v_add_f32 v7, 1.0, v7
    v_rcp_f32 v7, v7
    s_nop 0
    v_mul_f32 v7, v10, v7
    v_cvt_pk_bf16_f32 v7, v7, v7
    v_lshlrev_b32 v10, 16, v7
    v_lshlrev_b32 v11, 16, v11
    v_mul_f32 v7, 0xbfb8aa3b, v11
    v_exp_f32 v7, v7
    s_nop 0
    v_add_f32 v7, 1.0, v7
    v_rcp_f32 v7, v7
    s_nop 0
    v_mul_f32 v7, v11, v7
    v_cvt_pk_bf16_f32 v7, v7, v7
    v_lshlrev_b32 v11, 16, v7
    v_lshlrev_b32 v12, 16, v12
    v_mul_f32 v7, 0xbfb8aa3b, v12
    v_exp_f32 v7, v7
    s_nop 0
    v_add_f32 v7, 1.0, v7
    v_rcp_f32 v7, v7
    s_nop 0
    v_mul_f32 v7, v12, v7
    v_cvt_pk_bf16_f32 v7, v7, v7
    v_lshlrev_b32 v12, 16, v7
    v_lshlrev_b32 v13, 16, v13
    v_mul_f32 v7, 0xbfb8aa3b, v13
    v_exp_f32 v7, v7
    s_nop 0
    v_add_f32 v7, 1.0, v7
    v_rcp_f32 v7, v7
    s_nop 0
    v_mul_f32 v7, v13, v7
    v_cvt_pk_bf16_f32 v7, v7, v7
    v_lshlrev_b32 v13, 16, v7
    v_lshlrev_b32 v14, 16, v14
    v_mul_f32 v7, 0xbfb8aa3b, v14
    v_exp_f32 v7, v7
    s_nop 0
    v_add_f32 v7, 1.0, v7
    v_rcp_f32 v7, v7
    s_nop 0
    v_mul_f32 v7, v14, v7
    v_cvt_pk_bf16_f32 v7, v7, v7
    v_lshlrev_b32 v14, 16, v7
    s_waitcnt vmcnt(6)
    v_lshlrev_b32 v7, 16, v16
    v_and_b32 v8, 0xffff0000, v16
    v_mul_f32 v44, v10, v7
    v_mul_f32 v45, v10, v8
    v_lshlrev_b32 v7, 16, v17
    v_and_b32 v8, 0xffff0000, v17
    v_mul_f32 v46, v10, v7
    v_mul_f32 v47, v10, v8
    v_lshlrev_b32 v7, 16, v18
    v_and_b32 v8, 0xffff0000, v18
    v_mul_f32 v48, v10, v7
    v_mul_f32 v49, v10, v8
    v_lshlrev_b32 v7, 16, v19
    v_and_b32 v8, 0xffff0000, v19
    v_mul_f32 v50, v10, v7
    v_mul_f32 v51, v10, v8
    s_waitcnt vmcnt(5)
    v_lshlrev_b32 v7, 16, v20
    v_and_b32 v8, 0xffff0000, v20
    v_fmac_f32 v44, v11, v7
    v_fmac_f32 v45, v11, v8
    v_lshlrev_b32 v7, 16, v21
    v_and_b32 v8, 0xffff0000, v21
    v_fmac_f32 v46, v11, v7
    v_fmac_f32 v47, v11, v8
    v_lshlrev_b32 v7, 16, v22
    v_and_b32 v8, 0xffff0000, v22
    v_fmac_f32 v48, v11, v7
    v_fmac_f32 v49, v11, v8
    v_lshlrev_b32 v7, 16, v23
    v_and_b32 v8, 0xffff0000, v23
    v_fmac_f32 v50, v11, v7
    v_fmac_f32 v51, v11, v8
    s_waitcnt vmcnt(4)
    v_lshlrev_b32 v7, 16, v24
    v_and_b32 v8, 0xffff0000, v24
    v_fmac_f32 v44, v12, v7
    v_fmac_f32 v45, v12, v8
    v_lshlrev_b32 v7, 16, v25
    v_and_b32 v8, 0xffff0000, v25
    v_fmac_f32 v46, v12, v7
    v_fmac_f32 v47, v12, v8
    v_lshlrev_b32 v7, 16, v26
    v_and_b32 v8, 0xffff0000, v26
    v_fmac_f32 v48, v12, v7
    v_fmac_f32 v49, v12, v8
    v_lshlrev_b32 v7, 16, v27
    v_and_b32 v8, 0xffff0000, v27
    v_fmac_f32 v50, v12, v7
    v_fmac_f32 v51, v12, v8
    s_waitcnt vmcnt(3)
    v_lshlrev_b32 v7, 16, v28
    v_and_b32 v8, 0xffff0000, v28
    v_fmac_f32 v44, v13, v7
    v_fmac_f32 v45, v13, v8
    v_lshlrev_b32 v7, 16, v29
    v_and_b32 v8, 0xffff0000, v29
    v_fmac_f32 v46, v13, v7
    v_fmac_f32 v47, v13, v8
    v_lshlrev_b32 v7, 16, v30
    v_and_b32 v8, 0xffff0000, v30
    v_fmac_f32 v48, v13, v7
    v_fmac_f32 v49, v13, v8
    v_lshlrev_b32 v7, 16, v31
    v_and_b32 v8, 0xffff0000, v31
    v_fmac_f32 v50, v13, v7
    v_fmac_f32 v51, v13, v8
    s_waitcnt vmcnt(2)
    v_lshlrev_b32 v7, 16, v32
    v_and_b32 v8, 0xffff0000, v32
    v_fmac_f32 v44, v14, v7
    v_fmac_f32 v45, v14, v8
    v_lshlrev_b32 v7, 16, v33
    v_and_b32 v8, 0xffff0000, v33
    v_fmac_f32 v46, v14, v7
    v_fmac_f32 v47, v14, v8
    v_lshlrev_b32 v7, 16, v34
    v_and_b32 v8, 0xffff0000, v34
    v_fmac_f32 v48, v14, v7
    v_fmac_f32 v49, v14, v8
    v_lshlrev_b32 v7, 16, v35
    v_and_b32 v8, 0xffff0000, v35
    v_fmac_f32 v50, v14, v7
    v_fmac_f32 v51, v14, v8
    v_add_f32_dpp v44, v44, v44 row_ror:8 row_mask:0xf bank_mask:0xf
    v_add_f32_dpp v45, v45, v45 row_ror:8 row_mask:0xf bank_mask:0xf
    v_add_f32_dpp v46, v46, v46 row_ror:8 row_mask:0xf bank_mask:0xf
    v_add_f32_dpp v47, v47, v47 row_ror:8 row_mask:0xf bank_mask:0xf
    v_add_f32_dpp v48, v48, v48 row_ror:8 row_mask:0xf bank_mask:0xf
    v_add_f32_dpp v49, v49, v49 row_ror:8 row_mask:0xf bank_mask:0xf
    v_add_f32_dpp v50, v50, v50 row_ror:8 row_mask:0xf bank_mask:0xf
    v_add_f32_dpp v51, v51, v51 row_ror:8 row_mask:0xf bank_mask:0xf
    v_lshrrev_b32 v7, 4, v0
    v_lshlrev_b32 v7, 3, v7
    v_and_b32 v8, 7, v0
    v_add_u32 v7, v7, v8
    v_lshlrev_b32 v7, 5, v7
    s_mov_b32 exec_lo, 0x00ff00ff
    s_mov_b32 exec_hi, 0x00ff00ff
    ds_write_b128 v7, v[44:47]
    ds_write_b128 v7, v[48:51] offset:16
    s_mov_b64 exec, -1
    s_waitcnt lgkmcnt(0)
    s_barrier
    s_cmp_lg_u32 s3, 0
    s_cbranch_scc1 K0_END
    v_lshrrev_b32 v7, 3, v2
    v_lshlrev_b32 v7, 5, v7
    v_and_b32 v8, 7, v2
    v_lshl_add_u32 v7, v8, 2, v7
    ds_read_b32 v16, v7 offset:0
    ds_read_b32 v17, v7 offset:256
    ds_read_b32 v18, v7 offset:512
    ds_read_b32 v19, v7 offset:768
    ds_read_b32 v20, v7 offset:1024
    ds_read_b32 v21, v7 offset:1280
    ds_read_b32 v22, v7 offset:1536
    ds_read_b32 v23, v7 offset:1792
    ds_read_b32 v24, v7 offset:2048
    ds_read_b32 v25, v7 offset:2304
    ds_read_b32 v26, v7 offset:2560
    ds_read_b32 v27, v7 offset:2816
    ds_read_b32 v28, v7 offset:3072
    ds_read_b32 v29, v7 offset:3328
    ds_read_b32 v30, v7 offset:3584
    ds_read_b32 v31, v7 offset:3840
    s_waitcnt lgkmcnt(0)
    v_add_f32 v16, v16, v24
    v_add_f32 v17, v17, v25
    v_add_f32 v18, v18, v26
    v_add_f32 v19, v19, v27
    v_add_f32 v20, v20, v28
    v_add_f32 v21, v21, v29
    v_add_f32 v22, v22, v30
    v_add_f32 v23, v23, v31
    v_add_f32 v16, v16, v20
    v_add_f32 v17, v17, v21
    v_add_f32 v18, v18, v22
    v_add_f32 v19, v19, v23
    v_add_f32 v16, v16, v18
    v_add_f32 v17, v17, v19
    v_add_f32 v16, v16, v17
    s_mul_i32 s36, s23, 15360
    s_lshl_b32 s37, s22, 8
    s_add_u32 s36, s36, s37
    s_add_u32 s36, s36, 393216
    v_lshlrev_b32 v7, 2, v2
    buffer_store_dword v16, v7, s[32:35], s36 offen
    s_endpgm
K0_RELAY:
    s_cmp_ge_u32 s2, 256
    s_cbranch_scc1 K0_NW_2
    s_mov_b32 s56, s20
    s_mov_b32 s57, s21
    s_mov_b32 s58, 2621440
    s_mov_b32 s59, 131072
    s_and_b32 s60, s2, 7
    s_lshl_b32 s60, s60, 8
    s_lshr_b32 s61, s2, 3
    s_lshl_b32 s61, s61, 3
    s_add_u32 s60, s60, s61
    s_lshl_b32 s61, s3, 1
    s_add_u32 s60, s60, s61
    s_mul_i32 s60, s60, 1280
    v_lshlrev_b32 v9, 7, v2
    s_mov_b64 exec, 0xfffff
    buffer_load_dword v64, v9, s[56:59], s60 offen
    s_mov_b64 exec, -1
    s_getpc_b64 s[60:61]
K0_PC_3:
    s_add_u32 s60, s60, kp_kernel-K0_PC_3
    s_addc_u32 s61, s61, 0
    s_lshr_b32 s62, s2, 3
    s_lshl_b32 s62, s62, 2
    s_add_u32 s62, s62, s3
    s_lshl_b32 s62, s62, 10
    v_add_u32 v9, s62, v9
    v_min_u32 v9, KP_CODE_END-kp_kernel-4, v9
    s_mov_b64 exec, 0xff
    global_load_dword v65, v9, s[60:61]
    s_mov_b64 exec, -1
K0_NW_2:
    s_cmp_ge_u32 s2, 256
    s_cbranch_scc1 K0_NZ_4
    s_cmp_lg_u32 s3, 0
    s_cbranch_scc1 K0_NZ_4
    v_mov_b32 v8, 0
    v_mov_b32 v9, 0
    v_mov_b32 v10, 0
    v_mov_b32 v11, 0
    v_lshlrev_b32 v7, 4, v2
    s_sub_u32 s36, s2, 240
    s_lshl_b32 s36, s36, 10
    s_add_u32 s36, s36, 524288
    buffer_store_dwordx4 v[8:11], v7, s[32:35], s36 offen
K0_NZ_4:
    v_lshrrev_b32 v20, 5, v2
    v_lshlrev_b32 v20, 2, v20
    v_bfe_u32 v8, v2, 2, 2
    v_add_u32 v20, v20, v8
    v_bfe_u32 v8, v2, 4, 1
    v_lshlrev_b32 v21, 5, v8
    v_and_b32 v9, 3, v2
    v_lshl_add_u32 v21, v9, 3, v21
    v_lshlrev_b32 v9, 4, v2
    v_lshrrev_b32 v22, 5, v2
    v_lshlrev_b32 v22, 8, v22
    v_and_b32 v8, 15, v2
    v_lshl_add_u32 v22, v8, 4, v22
    s_cmp_ge_u32 s2, 400
    s_cbranch_scc1 K0_R_GU
    s_sub_u32 s40, s2, 240
    s_lshr_b32 s41, s40, 2
    s_and_b32 s42, s40, 3
    s_mul_i32 s63, s41, 61440
    s_mul_i32 s43, s42, 320
    s_add_u32 s63, s63, s43
    s_mov_b32 s56, s4
    s_mov_b32 s57, s5
    s_mov_b32 s58, 2457600
    s_mov_b32 s59, 131072
    s_mul_i32 s60, s3, 4
    s_add_u32 s60, s60, 0
    s_lshl_b32 s61, s60, 6
    v_add_u32 v23, s61, v2
    s_mov_b32 s62, 1093
    v_mul_lo_u32 v24, v23, s62
    v_lshrrev_b32 v24, 16, v24
    v_mul_u32_u24 v25, 60, v24
    v_sub_u32 v25, v23, v25
    v_mul_u32_u24 v27, 3277, v25
    v_lshrrev_b32 v27, 16, v27
    v_lshlrev_b32 v25, 4, v25
    v_mul_u32_u24 v27, 960, v27
    v_add_u32 v25, v25, v27
    v_mul_u32_u24 v24, 3840, v24
    v_add_u32 v24, v24, v25
    s_lshl_b32 m0, s60, 10
    s_nop 0
    buffer_load_dwordx4 v24, s[56:59], s63 offen lds
K0_DS_5:
    s_mul_i32 s60, s3, 4
    s_add_u32 s60, s60, 1
    s_lshl_b32 s61, s60, 6
    v_add_u32 v23, s61, v2
    s_mov_b32 s62, 1093
    v_mul_lo_u32 v24, v23, s62
    v_lshrrev_b32 v24, 16, v24
    v_mul_u32_u24 v25, 60, v24
    v_sub_u32 v25, v23, v25
    v_mul_u32_u24 v27, 3277, v25
    v_lshrrev_b32 v27, 16, v27
    v_lshlrev_b32 v25, 4, v25
    v_mul_u32_u24 v27, 960, v27
    v_add_u32 v25, v25, v27
    v_mul_u32_u24 v24, 3840, v24
    v_add_u32 v24, v24, v25
    s_lshl_b32 m0, s60, 10
    s_nop 0
    buffer_load_dwordx4 v24, s[56:59], s63 offen lds
K0_DS_6:
    s_mul_i32 s60, s3, 4
    s_add_u32 s60, s60, 2
    s_lshl_b32 s61, s60, 6
    v_add_u32 v23, s61, v2
    s_mov_b32 s62, 1093
    v_mul_lo_u32 v24, v23, s62
    v_lshrrev_b32 v24, 16, v24
    v_mul_u32_u24 v25, 60, v24
    v_sub_u32 v25, v23, v25
    v_mul_u32_u24 v27, 3277, v25
    v_lshrrev_b32 v27, 16, v27
    v_lshlrev_b32 v25, 4, v25
    v_mul_u32_u24 v27, 960, v27
    v_add_u32 v25, v25, v27
    v_mul_u32_u24 v24, 3840, v24
    v_add_u32 v24, v24, v25
    s_lshl_b32 m0, s60, 10
    s_nop 0
    buffer_load_dwordx4 v24, s[56:59], s63 offen lds
K0_DS_7:
    s_mul_i32 s60, s3, 4
    s_add_u32 s60, s60, 3
    s_cmp_ge_u32 s60, 15
    s_cbranch_scc1 K0_DS_8
    s_lshl_b32 s61, s60, 6
    v_add_u32 v23, s61, v2
    s_mov_b32 s62, 1093
    v_mul_lo_u32 v24, v23, s62
    v_lshrrev_b32 v24, 16, v24
    v_mul_u32_u24 v25, 60, v24
    v_sub_u32 v25, v23, v25
    v_mul_u32_u24 v27, 3277, v25
    v_lshrrev_b32 v27, 16, v27
    v_lshlrev_b32 v25, 4, v25
    v_mul_u32_u24 v27, 960, v27
    v_add_u32 v25, v25, v27
    v_mul_u32_u24 v24, 3840, v24
    v_add_u32 v24, v24, v25
    s_lshl_b32 m0, s60, 10
    s_nop 0
    buffer_load_dwordx4 v24, s[56:59], s63 offen lds
K0_DS_8:
    v_bfe_u32 v10, v2, 4, 1
    v_lshlrev_b32 v10, 2, v10
    v_and_b32 v11, 3, v2
    v_add_u32 v10, v10, v11
    v_lshlrev_b32 v11, 3, v10
    v_add_u32 v12, 320, v11
    v_add_u32 v13, 592, v11
    v_cmp_lt_u32 vcc, 5, v10
    s_nop 1
    v_cndmask_b32 v12, v12, v13, vcc
    v_mov_b32 v13, 672
    v_cmp_eq_u32 vcc, 5, v10
    s_nop 1
    v_cndmask_b32 v12, v12, v13, vcc
    v_add_u32 v14, 656, v11
    v_subrev_u32 v13, 16, v11
    v_cmp_lt_u32 vcc, 1, v10
    s_nop 1
    v_cndmask_b32 v14, v14, v13, vcc
    v_mov_b32 v13, 32
    v_cmp_eq_u32 vcc, 7, v10
    s_nop 1
    v_cndmask_b32 v14, v14, v13, vcc
    s_waitcnt vmcnt(0)
    s_barrier
    s_lshl_b32 s44, s3, 1
    s_mul_i32 s45, s44, 40
    v_add_u32 v12, s45, v12
    v_add_u32 v14, s45, v14
    s_lshl_b32 s46, s42, 3
    s_add_u32 s46, s46, s44
    s_mul_i32 s46, s46, 40
    s_add_u32 s46, s46, s41
    s_lshl_b32 s46, s46, 11
    s_add_u32 s46, s46, 37748736
    v_mul_u32_u24 v26, 960, v20
    v_add_u32 v26, v26, v12
    ds_read_b64_tr_b16 v[28:29], v26 offset:0
    ds_read_b64_tr_b16 v[30:31], v26 offset:7680
    s_waitcnt lgkmcnt(0)
    buffer_store_dwordx4 v[28:31], v9, s[32:35], s46 offen offset:0 sc1
    s_nop 1
    v_mul_u32_u24 v26, 960, v20
    v_add_u32 v26, v26, v14
    ds_read_b64_tr_b16 v[28:29], v26 offset:0
    ds_read_b64_tr_b16 v[30:31], v26 offset:7680
    s_waitcnt lgkmcnt(0)
    buffer_store_dwordx4 v[28:31], v9, s[32:35], s46 offen offset:1024 sc1
    s_nop 1
    s_add_u32 s46, s46, 81920
    v_mul_u32_u24 v26, 960, v20
    v_add_u32 v26, v26, v12
    ds_read_b64_tr_b16 v[28:29], v26 offset:40
    ds_read_b64_tr_b16 v[30:31], v26 offset:7720
    s_waitcnt lgkmcnt(0)
    buffer_store_dwordx4 v[28:31], v9, s[32:35], s46 offen offset:0 sc1
    s_nop 1
    v_mul_u32_u24 v26, 960, v20
    v_add_u32 v26, v26, v14
    ds_read_b64_tr_b16 v[28:29], v26 offset:40
    ds_read_b64_tr_b16 v[30:31], v26 offset:7720
    s_waitcnt lgkmcnt(0)
    buffer_store_dwordx4 v[28:31], v9, s[32:35], s46 offen offset:1024 sc1
    s_nop 1
    s_endpgm
K0_R_GU:
    s_cmp_ge_u32 s2, 720
    s_cbranch_scc1 K0_R_WD
    s_sub_u32 s40, s2, 400
    s_lshr_b32 s41, s40, 3
    s_bfe_u32 s47, s40, 0x10002
    s_and_b32 s42, s40, 3
    s_mul_i32 s63, s41, 49152
    s_mul_i32 s43, s42, 768
    s_add_u32 s63, s63, s43
    s_cmp_eq_u32 s47, 0
    s_cselect_b32 s48, s8, s10
    s_cselect_b32 s49, s9, s11
    s_mov_b32 s56, s48
    s_mov_b32 s57, s49
    s_mov_b32 s58, 1966080
    s_mov_b32 s59, 131072
    s_mul_i32 s60, s3, 3
    s_add_u32 s60, s60, 0
    s_lshl_b32 s61, s60, 6
    v_add_u32 v23, s61, v2
    s_mov_b32 s62, 1366
    v_mul_lo_u32 v24, v23, s62
    v_lshrrev_b32 v24, 16, v24
    v_mul_u32_u24 v25, 48, v24
    v_sub_u32 v25, v23, v25
    v_lshlrev_b32 v25, 4, v25
    v_mul_u32_u24 v24, 3072, v24
    v_add_u32 v24, v24, v25
    s_lshl_b32 m0, s60, 10
    s_nop 0
    buffer_load_dwordx4 v24, s[56:59], s63 offen lds
K0_DS_9:
    s_mul_i32 s60, s3, 3
    s_add_u32 s60, s60, 1
    s_lshl_b32 s61, s60, 6
    v_add_u32 v23, s61, v2
    s_mov_b32 s62, 1366
    v_mul_lo_u32 v24, v23, s62
    v_lshrrev_b32 v24, 16, v24
    v_mul_u32_u24 v25, 48, v24
    v_sub_u32 v25, v23, v25
    v_lshlrev_b32 v25, 4, v25
    v_mul_u32_u24 v24, 3072, v24
    v_add_u32 v24, v24, v25
    s_lshl_b32 m0, s60, 10
    s_nop 0
    buffer_load_dwordx4 v24, s[56:59], s63 offen lds
K0_DS_10:
    s_mul_i32 s60, s3, 3
    s_add_u32 s60, s60, 2
    s_lshl_b32 s61, s60, 6
    v_add_u32 v23, s61, v2
    s_mov_b32 s62, 1366
    v_mul_lo_u32 v24, v23, s62
    v_lshrrev_b32 v24, 16, v24
    v_mul_u32_u24 v25, 48, v24
    v_sub_u32 v25, v23, v25
    v_lshlrev_b32 v25, 4, v25
    v_mul_u32_u24 v24, 3072, v24
    v_add_u32 v24, v24, v25
    s_lshl_b32 m0, s60, 10
    s_nop 0
    buffer_load_dwordx4 v24, s[56:59], s63 offen lds
K0_DS_11:
    s_waitcnt vmcnt(0)
    s_barrier
    s_mul_i32 s45, s3, 192
    v_add_u32 v12, s45, v21
    s_lshl_b32 s46, s42, 2
    s_add_u32 s46, s46, s3
    s_mul_i32 s46, s46, 40
    s_add_u32 s46, s46, s41
    s_mul_i32 s46, s46, 6144
    s_mul_i32 s47, s47, 3072
    s_add_u32 s46, s46, s47
    s_add_u32 s46, s46, 46137344
    v_mul_u32_u24 v26, 768, v20
    v_add_u32 v26, v26, v12
    ds_read_b64_tr_b16 v[28:29], v26 offset:0
    ds_read_b64_tr_b16 v[30:31], v26 offset:6144
    s_waitcnt lgkmcnt(0)
    buffer_store_dwordx4 v[28:31], v9, s[32:35], s46 offen offset:0 sc1
    s_nop 1
    v_mul_u32_u24 v26, 768, v20
    v_add_u32 v26, v26, v12
    ds_read_b64_tr_b16 v[28:29], v26 offset:64
    ds_read_b64_tr_b16 v[30:31], v26 offset:6208
    s_waitcnt lgkmcnt(0)
    buffer_store_dwordx4 v[28:31], v9, s[32:35], s46 offen offset:1024 sc1
    s_nop 1
    v_mul_u32_u24 v26, 768, v20
    v_add_u32 v26, v26, v12
    ds_read_b64_tr_b16 v[28:29], v26 offset:128
    ds_read_b64_tr_b16 v[30:31], v26 offset:6272
    s_waitcnt lgkmcnt(0)
    buffer_store_dwordx4 v[28:31], v9, s[32:35], s46 offen offset:2048 sc1
    s_nop 1
    s_endpgm
K0_R_WD:
    s_cmp_ge_u32 s2, 912
    s_cbranch_scc1 K0_R_WO
    s_sub_u32 s40, s2, 720
    s_lshr_b32 s41, s40, 1
    s_and_b32 s42, s40, 1
    s_mul_i32 s63, s42, 640
    s_mov_b32 s56, s12
    s_mov_b32 s57, s13
    s_mov_b32 s58, 1966080
    s_mov_b32 s59, 131072
    s_mul_i32 s60, s3, 3
    s_add_u32 s60, s60, 0
    s_lshl_b32 s61, s60, 6
    v_add_u32 v23, s61, v2
    s_mov_b32 s62, 1639
    v_mul_lo_u32 v24, v23, s62
    v_lshrrev_b32 v24, 16, v24
    v_mul_u32_u24 v25, 40, v24
    v_sub_u32 v25, v23, v25
    v_lshlrev_b32 v25, 4, v25
    s_lshl_b32 s62, s41, 4
    v_add_u32 v24, s62, v24
    v_mul_u32_u24 v24, 1280, v24
    v_add_u32 v24, v24, v25
    s_lshl_b32 m0, s60, 10
    s_nop 0
    buffer_load_dwordx4 v24, s[56:59], s63 offen lds
K0_DS_12:
    s_mul_i32 s60, s3, 3
    s_add_u32 s60, s60, 1
    s_cmp_ge_u32 s60, 10
    s_cbranch_scc1 K0_DS_13
    s_lshl_b32 s61, s60, 6
    v_add_u32 v23, s61, v2
    s_mov_b32 s62, 1639
    v_mul_lo_u32 v24, v23, s62
    v_lshrrev_b32 v24, 16, v24
    v_mul_u32_u24 v25, 40, v24
    v_sub_u32 v25, v23, v25
    v_lshlrev_b32 v25, 4, v25
    s_lshl_b32 s62, s41, 4
    v_add_u32 v24, s62, v24
    v_mul_u32_u24 v24, 1280, v24
    v_add_u32 v24, v24, v25
    s_lshl_b32 m0, s60, 10
    s_nop 0
    buffer_load_dwordx4 v24, s[56:59], s63 offen lds
K0_DS_13:
    s_mul_i32 s60, s3, 3
    s_add_u32 s60, s60, 2
    s_cmp_ge_u32 s60, 10
    s_cbranch_scc1 K0_DS_14
    s_lshl_b32 s61, s60, 6
    v_add_u32 v23, s61, v2
    s_mov_b32 s62, 1639
    v_mul_lo_u32 v24, v23, s62
    v_lshrrev_b32 v24, 16, v24
    v_mul_u32_u24 v25, 40, v24
    v_sub_u32 v25, v23, v25
    v_lshlrev_b32 v25, 4, v25
    s_lshl_b32 s62, s41, 4
    v_add_u32 v24, s62, v24
    v_mul_u32_u24 v24, 1280, v24
    v_add_u32 v24, v24, v25
    s_lshl_b32 m0, s60, 10
    s_nop 0
    buffer_load_dwordx4 v24, s[56:59], s63 offen lds
K0_DS_14:
    s_waitcnt vmcnt(0)
    s_barrier
    s_mul_i32 s45, s3, 160
    v_add_u32 v12, s45, v21
    s_lshl_b32 s46, s42, 2
    s_add_u32 s46, s46, s3
    s_mul_i32 s46, s46, 48
    s_lshr_b32 s47, s41, 1
    s_add_u32 s46, s46, s47
    s_mul_i32 s46, s46, 5120
    s_add_u32 s46, s46, 50331648
    s_and_b32 s47, s41, 1
    s_lshl_b32 s48, s47, 11
    s_add_u32 s48, s48, s46
    s_lshl_b32 s47, s47, 9
    s_add_u32 s47, s47, 4096
    s_add_u32 s47, s47, s46
    v_mul_u32_u24 v26, 640, v20
    v_add_u32 v26, v26, v12
    ds_read_b64_tr_b16 v[28:29], v26 offset:0
    ds_read_b64_tr_b16 v[30:31], v26 offset:5120
    s_waitcnt lgkmcnt(0)
    buffer_store_dwordx4 v[28:31], v9, s[32:35], s48 offen offset:0 sc1
    s_nop 1
    v_mul_u32_u24 v26, 640, v20
    v_add_u32 v26, v26, v12
    ds_read_b64_tr_b16 v[28:29], v26 offset:64
    ds_read_b64_tr_b16 v[30:31], v26 offset:5184
    s_waitcnt lgkmcnt(0)
    buffer_store_dwordx4 v[28:31], v9, s[32:35], s48 offen offset:1024 sc1
    s_nop 1
    v_mul_u32_u24 v26, 640, v20
    v_add_u32 v26, v26, v12
    ds_read_b64_tr_b16 v[28:29], v26 offset:128
    ds_read_b64_tr_b16 v[30:31], v26 offset:5248
    s_waitcnt lgkmcnt(0)
    s_mov_b32 exec_lo, 0xffff
    s_mov_b32 exec_hi, 0xffff
    buffer_store_dwordx4 v[28:31], v22, s[32:35], s47 offen offset:0 sc1
    s_mov_b64 exec, -1
    s_nop 1
    s_endpgm
K0_R_WO:
    s_sub_u32 s40, s2, 912
    s_lshr_b32 s41, s40, 1
    s_and_b32 s42, s40, 1
    s_mul_i32 s63, s42, 640
    s_mov_b32 s56, s6
    s_mov_b32 s57, s7
    s_mov_b32 s58, 819200
    s_mov_b32 s59, 131072
    s_mul_i32 s60, s3, 3
    s_add_u32 s60, s60, 0
    s_lshl_b32 s61, s60, 6
    v_add_u32 v23, s61, v2
    s_mov_b32 s62, 1639
    v_mul_lo_u32 v24, v23, s62
    v_lshrrev_b32 v24, 16, v24
    v_mul_u32_u24 v25, 40, v24
    v_sub_u32 v25, v23, v25
    v_lshlrev_b32 v25, 4, v25
    s_cmp_ge_u32 s41, 32
    s_cbranch_scc1 K0_WOL_16
    s_mul_i32 s62, s41, 20
    v_add_u32 v24, s62, v24
    s_branch K0_WOE_17
K0_WOL_16:
    s_sub_u32 s62, s41, 32
    s_mul_i32 s62, s62, 80
    s_add_u32 s62, s62, 16
    v_bfe_u32 v27, v24, 2, 1
    v_mul_u32_u24 v27, 40, v27
    v_lshrrev_b32 v19, 3, v24
    v_mul_u32_u24 v19, 20, v19
    v_and_b32 v24, 3, v24
    v_add_u32 v24, v24, v27
    v_add_u32 v24, v24, v19
    v_add_u32 v24, s62, v24
K0_WOE_17:
    v_mul_u32_u24 v24, 1280, v24
    v_add_u32 v24, v24, v25
    s_lshl_b32 m0, s60, 10
    s_nop 0
    buffer_load_dwordx4 v24, s[56:59], s63 offen lds
K0_DS_15:
    s_mul_i32 s60, s3, 3
    s_add_u32 s60, s60, 1
    s_cmp_ge_u32 s60, 10
    s_cbranch_scc1 K0_DS_18
    s_lshl_b32 s61, s60, 6
    v_add_u32 v23, s61, v2
    s_mov_b32 s62, 1639
    v_mul_lo_u32 v24, v23, s62
    v_lshrrev_b32 v24, 16, v24
    v_mul_u32_u24 v25, 40, v24
    v_sub_u32 v25, v23, v25
    v_lshlrev_b32 v25, 4, v25
    s_cmp_ge_u32 s41, 32
    s_cbranch_scc1 K0_WOL_19
    s_mul_i32 s62, s41, 20
    v_add_u32 v24, s62, v24
    s_branch K0_WOE_20
K0_WOL_19:
    s_sub_u32 s62, s41, 32
    s_mul_i32 s62, s62, 80
    s_add_u32 s62, s62, 16
    v_bfe_u32 v27, v24, 2, 1
    v_mul_u32_u24 v27, 40, v27
    v_lshrrev_b32 v19, 3, v24
    v_mul_u32_u24 v19, 20, v19
    v_and_b32 v24, 3, v24
    v_add_u32 v24, v24, v27
    v_add_u32 v24, v24, v19
    v_add_u32 v24, s62, v24
K0_WOE_20:
    v_mul_u32_u24 v24, 1280, v24
    v_add_u32 v24, v24, v25
    s_lshl_b32 m0, s60, 10
    s_nop 0
    buffer_load_dwordx4 v24, s[56:59], s63 offen lds
K0_DS_18:
    s_mul_i32 s60, s3, 3
    s_add_u32 s60, s60, 2
    s_cmp_ge_u32 s60, 10
    s_cbranch_scc1 K0_DS_21
    s_lshl_b32 s61, s60, 6
    v_add_u32 v23, s61, v2
    s_mov_b32 s62, 1639
    v_mul_lo_u32 v24, v23, s62
    v_lshrrev_b32 v24, 16, v24
    v_mul_u32_u24 v25, 40, v24
    v_sub_u32 v25, v23, v25
    v_lshlrev_b32 v25, 4, v25
    s_cmp_ge_u32 s41, 32
    s_cbranch_scc1 K0_WOL_22
    s_mul_i32 s62, s41, 20
    v_add_u32 v24, s62, v24
    s_branch K0_WOE_23
K0_WOL_22:
    s_sub_u32 s62, s41, 32
    s_mul_i32 s62, s62, 80
    s_add_u32 s62, s62, 16
    v_bfe_u32 v27, v24, 2, 1
    v_mul_u32_u24 v27, 40, v27
    v_lshrrev_b32 v19, 3, v24
    v_mul_u32_u24 v19, 20, v19
    v_and_b32 v24, 3, v24
    v_add_u32 v24, v24, v27
    v_add_u32 v24, v24, v19
    v_add_u32 v24, s62, v24
K0_WOE_23:
    v_mul_u32_u24 v24, 1280, v24
    v_add_u32 v24, v24, v25
    s_lshl_b32 m0, s60, 10
    s_nop 0
    buffer_load_dwordx4 v24, s[56:59], s63 offen lds
K0_DS_21:
    s_waitcnt vmcnt(0)
    s_barrier
    s_mul_i32 s45, s3, 160
    v_add_u32 v12, s45, v21
    s_lshl_b32 s46, s42, 2
    s_add_u32 s46, s46, s3
    s_mul_i32 s46, s46, 20
    s_lshr_b32 s47, s41, 1
    s_add_u32 s46, s46, s47
    s_mul_i32 s46, s46, 5120
    s_add_u32 s46, s46, 41943040
    s_and_b32 s47, s41, 1
    s_lshl_b32 s48, s47, 11
    s_add_u32 s48, s48, s46
    s_lshl_b32 s47, s47, 9
    s_add_u32 s47, s47, 4096
    s_add_u32 s47, s47, s46
    v_mul_u32_u24 v26, 640, v20
    v_add_u32 v26, v26, v12
    ds_read_b64_tr_b16 v[28:29], v26 offset:0
    ds_read_b64_tr_b16 v[30:31], v26 offset:5120
    s_waitcnt lgkmcnt(0)
    buffer_store_dwordx4 v[28:31], v9, s[32:35], s48 offen offset:0 sc1
    s_nop 1
    v_mul_u32_u24 v26, 640, v20
    v_add_u32 v26, v26, v12
    ds_read_b64_tr_b16 v[28:29], v26 offset:64
    ds_read_b64_tr_b16 v[30:31], v26 offset:5184
    s_waitcnt lgkmcnt(0)
    buffer_store_dwordx4 v[28:31], v9, s[32:35], s48 offen offset:1024 sc1
    s_nop 1
    v_mul_u32_u24 v26, 640, v20
    v_add_u32 v26, v26, v12
    ds_read_b64_tr_b16 v[28:29], v26 offset:128
    ds_read_b64_tr_b16 v[30:31], v26 offset:5248
    s_waitcnt lgkmcnt(0)
    s_mov_b32 exec_lo, 0xffff
    s_mov_b32 exec_hi, 0xffff
    buffer_store_dwordx4 v[28:31], v22, s[32:35], s47 offen offset:0 sc1
    s_mov_b64 exec, -1
    s_nop 1
    s_endpgm
K0_END:
    s_endpgm

.globl kp_kernel
.p2align 8
.type kp_kernel,@function
kp_kernel:
    s_cmp_ge_u32 s2, 256
    s_cbranch_scc1 KP_END
    s_load_dwordx2 s[4:5], s[0:1], 88
    s_load_dwordx2 s[6:7], s[0:1], 72
    s_load_dwordx2 s[16:17], s[0:1], 0
    s_load_dwordx2 s[40:41], s[0:1], 0
    v_lshrrev_b32 v1, 6, v0
    s_nop 0
    v_readfirstlane_b32 s3, v1
    v_and_b32 v2, 63, v0
    v_lshlrev_b32 v3, 4, v2
    v_mov_b32 v18, 87056
    v_mov_b32 v20, 0
    v_mov_b32 v21, 0
    v_mov_b32 v22, 0
    v_mov_b32 v23, 0
    ds_write_b128 v18, v[20:23]
    s_and_b32 s12, s2, 7
    s_lshr_b32 s13, s2, 3
    s_mov_b32 s14, 0
    s_waitcnt lgkmcnt(0)
    s_mov_b32 s8, s4
    s_mov_b32 s9, s5
    s_mov_b32 s10, 54525952
    s_mov_b32 s11, 131072
    s_barrier
    s_cmp_ge_u32 s3, 2
    s_cbranch_scc1 H_W23_24
    s_setprio 3
    s_getreg_b32 s15, hwreg(HW_REG_XCC_ID, 0, 4)
    s_add_u32 s15, s15, 1
    v_lshrrev_b32 v5, 4, v2
    v_and_b32 v4, 15, v2
    s_lshl_b32 s19, s12, 8
    s_lshl_b32 s20, s13, 3
    s_add_u32 s19, s19, s20
    s_lshl_b32 s20, s3, 2
    s_add_u32 s19, s19, s20
    v_add_u32 v5, s19, v5
    v_lshrrev_b32 v7, 1, v4
    v_and_b32 v8, 1, v4
    s_mul_i32 s21, s3, 2560
    s_add_u32 s21, s21, 393216
    buffer_load_dwordx4 v[24:27], v3, s[8:11], s21 offen offset:0
    buffer_load_dwordx4 v[40:43], v3, s[8:11], s21 offen offset:1024
    buffer_load_dwordx4 v[56:59], v3, s[8:11], s21 offen offset:2048
    s_add_u32 s21, s21, 15360
    buffer_load_dwordx4 v[28:31], v3, s[8:11], s21 offen offset:0
    buffer_load_dwordx4 v[44:47], v3, s[8:11], s21 offen offset:1024
    buffer_load_dwordx4 v[60:63], v3, s[8:11], s21 offen offset:2048
    s_add_u32 s21, s21, 15360
    buffer_load_dwordx4 v[32:35], v3, s[8:11], s21 offen offset:0
    buffer_load_dwordx4 v[48:51], v3, s[8:11], s21 offen offset:1024
    buffer_load_dwordx4 v[64:67], v3, s[8:11], s21 offen offset:2048
    s_add_u32 s21, s21, 15360
    buffer_load_dwordx4 v[36:39], v3, s[8:11], s21 offen offset:0
    buffer_load_dwordx4 v[52:55], v3, s[8:11], s21 offen offset:1024
    buffer_load_dwordx4 v[68:71], v3, s[8:11], s21 offen offset:2048
    s_mov_b32 s24, s16
    s_mov_b32 s25, s17
    s_mov_b32 s26, 2621440
    s_mov_b32 s27, 131072
    v_mul_u32_u24 v6, 1280, v5
    v_lshl_add_u32 v6, v7, 5, v6
    v_lshl_add_u32 v6, v8, 3, v6
    buffer_load_dwordx2 v[192:193], v6, s[24:27], 0 offen offset:0
    buffer_load_dwordx2 v[194:195], v6, s[24:27], 0 offen offset:16
    buffer_load_dwordx2 v[196:197], v6, s[24:27], 0 offen offset:256
    buffer_load_dwordx2 v[198:199], v6, s[24:27], 0 offen offset:272
    buffer_load_dwordx2 v[200:201], v6, s[24:27], 0 offen offset:512
    buffer_load_dwordx2 v[202:203], v6, s[24:27], 0 offen offset:528
    buffer_load_dwordx2 v[204:205], v6, s[24:27], 0 offen offset:768
    buffer_load_dwordx2 v[206:207], v6, s[24:27], 0 offen offset:784
    buffer_load_dwordx2 v[208:209], v6, s[24:27], 0 offen offset:1024
    buffer_load_dwordx2 v[210:211], v6, s[24:27], 0 offen offset:1040
    s_waitcnt vmcnt(10)
    v_lshrrev_b32 v14, 2, v2
    v_lshlrev_b32 v14, 6, v14
    v_and_b32 v15, 1, v2
    v_lshl_add_u32 v14, v15, 5, v14
    v_bfe_u32 v15, v2, 1, 1
    v_lshl_add_u32 v14, v15, 4, v14
    s_mul_i32 s20, s3, 2560
    s_add_u32 s20, s20, 81920
    v_add_u32 v14, s20, v14
    s_cmp_eq_u32 s3, 1
    s_cselect_b32 s20, 1.0, 0
    v_mov_b32 v12, s20
    v_pk_add_f32 v[24:25], v[24:25], v[28:29]
    v_pk_add_f32 v[32:33], v[32:33], v[36:37]
    v_pk_add_f32 v[26:27], v[26:27], v[30:31]
    v_pk_add_f32 v[34:35], v[34:35], v[38:39]
    v_pk_add_f32 v[24:25], v[24:25], v[32:33]
    v_pk_add_f32 v[26:27], v[26:27], v[34:35]
    v_cvt_pk_bf16_f32 v28, v24, v25
    v_cvt_pk_bf16_f32 v29, v26, v27
    v_lshlrev_b32 v24, 16, v28
    v_and_b32 v25, 0xffff0000, v28
    v_lshlrev_b32 v26, 16, v29
    v_and_b32 v27, 0xffff0000, v29
    v_add_f32 v24, v24, v12
    v_add_f32 v25, v25, v12
    v_add_f32 v26, v26, v12
    v_add_f32 v27, v27, v12
    v_cvt_pk_bf16_f32 v28, v24, v25
    v_cvt_pk_bf16_f32 v29, v26, v27
    v_lshlrev_b32 v24, 16, v28
    v_and_b32 v25, 0xffff0000, v28
    v_lshlrev_b32 v26, 16, v29
    v_and_b32 v27, 0xffff0000, v29
    ds_write_b128 v14, v[24:27] offset:0
    v_pk_add_f32 v[40:41], v[40:41], v[44:45]
    v_pk_add_f32 v[48:49], v[48:49], v[52:53]
    v_pk_add_f32 v[42:43], v[42:43], v[46:47]
    v_pk_add_f32 v[50:51], v[50:51], v[54:55]
    v_pk_add_f32 v[40:41], v[40:41], v[48:49]
    v_pk_add_f32 v[42:43], v[42:43], v[50:51]
    v_cvt_pk_bf16_f32 v44, v40, v41
    v_cvt_pk_bf16_f32 v45, v42, v43
    v_lshlrev_b32 v40, 16, v44
    v_and_b32 v41, 0xffff0000, v44
    v_lshlrev_b32 v42, 16, v45
    v_and_b32 v43, 0xffff0000, v45
    v_add_f32 v40, v40, v12
    v_add_f32 v41, v41, v12
    v_add_f32 v42, v42, v12
    v_add_f32 v43, v43, v12
    v_cvt_pk_bf16_f32 v44, v40, v41
    v_cvt_pk_bf16_f32 v45, v42, v43
    v_lshlrev_b32 v40, 16, v44
    v_and_b32 v41, 0xffff0000, v44
    v_lshlrev_b32 v42, 16, v45
    v_and_b32 v43, 0xffff0000, v45
    ds_write_b128 v14, v[40:43] offset:1024
    v_pk_add_f32 v[56:57], v[56:57], v[60:61]
    v_pk_add_f32 v[64:65], v[64:65], v[68:69]
    v_pk_add_f32 v[58:59], v[58:59], v[62:63]
    v_pk_add_f32 v[66:67], v[66:67], v[70:71]
    v_pk_add_f32 v[56:57], v[56:57], v[64:65]
    v_pk_add_f32 v[58:59], v[58:59], v[66:67]
    v_cvt_pk_bf16_f32 v60, v56, v57
    v_cvt_pk_bf16_f32 v61, v58, v59
    v_lshlrev_b32 v56, 16, v60
    v_and_b32 v57, 0xffff0000, v60
    v_lshlrev_b32 v58, 16, v61
    v_and_b32 v59, 0xffff0000, v61
    v_add_f32 v56, v56, v12
    v_add_f32 v57, v57, v12
    v_add_f32 v58, v58, v12
    v_add_f32 v59, v59, v12
    v_cvt_pk_bf16_f32 v60, v56, v57
    v_cvt_pk_bf16_f32 v61, v58, v59
    v_lshlrev_b32 v56, 16, v60
    v_and_b32 v57, 0xffff0000, v60
    v_lshlrev_b32 v58, 16, v61
    v_and_b32 v59, 0xffff0000, v61
    s_mov_b32 exec_hi, 0
    ds_write_b128 v14, v[56:59] offset:2048
    s_mov_b64 exec, -1
    s_waitcnt lgkmcnt(0)
    v_mov_b32 v18, 87056
    v_mov_b32 v19, 1
    s_mov_b64 exec, 1
    ds_add_u32 v18, v19
    s_mov_b64 exec, -1
    s_waitcnt vmcnt(0)
    s_lshl_b32 s19, s12, 7
    s_add_u32 s19, s19, 524288
    v_and_b32 v22, 31, v2
    v_lshlrev_b32 v22, 2, v22
    v_add_u32 v22, s19, v22
    global_load_dword v20, v22, s[4:5] sc1
    v_lshlrev_b32 v124, 16, v192
    v_and_b32 v125, 0xffff0000, v192
    v_lshlrev_b32 v126, 16, v193
    v_and_b32 v127, 0xffff0000, v193
    v_lshlrev_b32 v128, 16, v194
    v_and_b32 v129, 0xffff0000, v194
    v_lshlrev_b32 v130, 16, v195
    v_and_b32 v131, 0xffff0000, v195
    v_lshlrev_b32 v132, 16, v196
    v_and_b32 v133, 0xffff0000, v196
    v_lshlrev_b32 v134, 16, v197
    v_and_b32 v135, 0xffff0000, v197
    v_lshlrev_b32 v136, 16, v198
    v_and_b32 v137, 0xffff0000, v198
    v_lshlrev_b32 v138, 16, v199
    v_and_b32 v139, 0xffff0000, v199
    v_lshlrev_b32 v140, 16, v200
    v_and_b32 v141, 0xffff0000, v200
    v_lshlrev_b32 v142, 16, v201
    v_and_b32 v143, 0xffff0000, v201
    v_lshlrev_b32 v144, 16, v202
    v_and_b32 v145, 0xffff0000, v202
    v_lshlrev_b32 v146, 16, v203
    v_and_b32 v147, 0xffff0000, v203
    v_lshlrev_b32 v148, 16, v204
    v_and_b32 v149, 0xffff0000, v204
    v_lshlrev_b32 v150, 16, v205
    v_and_b32 v151, 0xffff0000, v205
    v_lshlrev_b32 v152, 16, v206
    v_and_b32 v153, 0xffff0000, v206
    v_lshlrev_b32 v154, 16, v207
    v_and_b32 v155, 0xffff0000, v207
    v_lshlrev_b32 v156, 16, v208
    v_and_b32 v157, 0xffff0000, v208
    v_lshlrev_b32 v158, 16, v209
    v_and_b32 v159, 0xffff0000, v209
    v_lshlrev_b32 v160, 16, v210
    v_and_b32 v161, 0xffff0000, v210
    v_lshlrev_b32 v162, 16, v211
    v_and_b32 v163, 0xffff0000, v211
    v_pk_add_f32 v[12:13], v[124:125], v[126:127]
    v_pk_add_f32 v[14:15], v[128:129], v[130:131]
    v_pk_add_f32 v[12:13], v[12:13], v[132:133]
    v_pk_add_f32 v[14:15], v[14:15], v[134:135]
    v_pk_add_f32 v[12:13], v[12:13], v[136:137]
    v_pk_add_f32 v[14:15], v[14:15], v[138:139]
    v_pk_add_f32 v[12:13], v[12:13], v[140:141]
    v_pk_add_f32 v[14:15], v[14:15], v[142:143]
    v_pk_add_f32 v[12:13], v[12:13], v[144:145]
    v_pk_add_f32 v[14:15], v[14:15], v[146:147]
    v_pk_add_f32 v[12:13], v[12:13], v[148:149]
    v_pk_add_f32 v[14:15], v[14:15], v[150:151]
    v_pk_add_f32 v[12:13], v[12:13], v[152:153]
    v_pk_add_f32 v[14:15], v[14:15], v[154:155]
    v_pk_add_f32 v[12:13], v[12:13], v[156:157]
    v_pk_add_f32 v[14:15], v[14:15], v[158:159]
    v_pk_add_f32 v[12:13], v[12:13], v[160:161]
    v_pk_add_f32 v[14:15], v[14:15], v[162:163]
    v_pk_add_f32 v[12:13], v[12:13], v[14:15]
    v_add_f32 v12, v12, v13
    s_nop 1
    v_add_f32_dpp v12, v12, v12 row_ror:8 row_mask:0xf bank_mask:0xf
    s_nop 1
    v_add_f32_dpp v12, v12, v12 row_ror:4 row_mask:0xf bank_mask:0xf
    s_nop 1
    v_add_f32_dpp v12, v12, v12 row_ror:2 row_mask:0xf bank_mask:0xf
    s_nop 1
    v_add_f32_dpp v12, v12, v12 row_ror:1 row_mask:0xf bank_mask:0xf
    v_mul_f32 v12, 0xbacccccd, v12
    v_mov_b32 v13, v12
    v_pk_add_f32 v[124:125], v[124:125], v[12:13]
    v_pk_add_f32 v[126:127], v[126:127], v[12:13]
    v_pk_add_f32 v[128:129], v[128:129], v[12:13]
    v_pk_add_f32 v[130:131], v[130:131], v[12:13]
    v_pk_add_f32 v[132:133], v[132:133], v[12:13]
    v_pk_add_f32 v[134:135], v[134:135], v[12:13]
    v_pk_add_f32 v[136:137], v[136:137], v[12:13]
    v_pk_add_f32 v[138:139], v[138:139], v[12:13]
    v_pk_add_f32 v[140:141], v[140:141], v[12:13]
    v_pk_add_f32 v[142:143], v[142:143], v[12:13]
    v_pk_add_f32 v[144:145], v[144:145], v[12:13]
    v_pk_add_f32 v[146:147], v[146:147], v[12:13]
    v_pk_add_f32 v[148:149], v[148:149], v[12:13]
    v_pk_add_f32 v[150:151], v[150:151], v[12:13]
    v_pk_add_f32 v[152:153], v[152:153], v[12:13]
    v_pk_add_f32 v[154:155], v[154:155], v[12:13]
    v_pk_add_f32 v[156:157], v[156:157], v[12:13]
    v_pk_add_f32 v[158:159], v[158:159], v[12:13]
    v_pk_add_f32 v[160:161], v[160:161], v[12:13]
    v_pk_add_f32 v[162:163], v[162:163], v[12:13]
    v_pk_mul_f32 v[14:15], v[124:125], v[124:125]
    v_pk_mul_f32 v[16:17], v[126:127], v[126:127]
    v_pk_fma_f32 v[14:15], v[128:129], v[128:129], v[14:15]
    v_pk_fma_f32 v[16:17], v[130:131], v[130:131], v[16:17]
    v_pk_fma_f32 v[14:15], v[132:133], v[132:133], v[14:15]
    v_pk_fma_f32 v[16:17], v[134:135], v[134:135], v[16:17]
    v_pk_fma_f32 v[14:15], v[136:137], v[136:137], v[14:15]
    v_pk_fma_f32 v[16:17], v[138:139], v[138:139], v[16:17]
    v_pk_fma_f32 v[14:15], v[140:141], v[140:141], v[14:15]
    v_pk_fma_f32 v[16:17], v[142:143], v[142:143], v[16:17]
    v_pk_fma_f32 v[14:15], v[144:145], v[144:145], v[14:15]
    v_pk_fma_f32 v[16:17], v[146:147], v[146:147], v[16:17]
    v_pk_fma_f32 v[14:15], v[148:149], v[148:149], v[14:15]
    v_pk_fma_f32 v[16:17], v[150:151], v[150:151], v[16:17]
    v_pk_fma_f32 v[14:15], v[152:153], v[152:153], v[14:15]
    v_pk_fma_f32 v[16:17], v[154:155], v[154:155], v[16:17]
    v_pk_fma_f32 v[14:15], v[156:157], v[156:157], v[14:15]
    v_pk_fma_f32 v[16:17], v[158:159], v[158:159], v[16:17]
    v_pk_fma_f32 v[14:15], v[160:161], v[160:161], v[14:15]
    v_pk_fma_f32 v[16:17], v[162:163], v[162:163], v[16:17]
    v_pk_add_f32 v[14:15], v[14:15], v[16:17]
    v_add_f32 v14, v14, v15
    s_nop 1
    v_add_f32_dpp v14, v14, v14 row_ror:8 row_mask:0xf bank_mask:0xf
    s_nop 1
    v_add_f32_dpp v14, v14, v14 row_ror:4 row_mask:0xf bank_mask:0xf
    s_nop 1
    v_add_f32_dpp v14, v14, v14 row_ror:2 row_mask:0xf bank_mask:0xf
    s_nop 1
    v_add_f32_dpp v14, v14, v14 row_ror:1 row_mask:0xf bank_mask:0xf
    v_mov_b32 v15, 0x3727c5ac
    v_fmac_f32 v15, 0x3acccccd, v14
    v_rsq_f32 v14, v15
    s_nop 0
    v_mov_b32 v15, v14
    v_mov_b32 v18, 87056
    s_mov_b32 s18, 2000000
LSP_26:
    s_sub_u32 s18, s18, 1
    s_cmp_eq_u32 s18, 0
    s_cbranch_scc1 LSPX_27
    ds_read_b32 v19, v18
    s_waitcnt lgkmcnt(0)
    v_readfirstlane_b32 s19, v19
    s_cmp_lt_u32 s19, 2
    s_cbranch_scc1 LSP_26
LSPX_27:
    v_lshlrev_b32 v9, 5, v4
    v_add_u32 v9, 81920, v9
    ds_read_b128 v[24:27], v9 offset:2560
    ds_read_b128 v[64:67], v9 offset:0
    ds_read_b128 v[28:31], v9 offset:2576
    ds_read_b128 v[68:71], v9 offset:16
    ds_read_b128 v[32:35], v9 offset:3072
    ds_read_b128 v[72:75], v9 offset:512
    ds_read_b128 v[36:39], v9 offset:3088
    ds_read_b128 v[76:79], v9 offset:528
    ds_read_b128 v[40:43], v9 offset:3584
    ds_read_b128 v[80:83], v9 offset:1024
    ds_read_b128 v[44:47], v9 offset:3600
    ds_read_b128 v[84:87], v9 offset:1040
    ds_read_b128 v[48:51], v9 offset:4096
    ds_read_b128 v[88:91], v9 offset:1536
    ds_read_b128 v[52:55], v9 offset:4112
    ds_read_b128 v[92:95], v9 offset:1552
    ds_read_b128 v[56:59], v9 offset:4608
    ds_read_b128 v[96:99], v9 offset:2048
    ds_read_b128 v[60:63], v9 offset:4624
    ds_read_b128 v[100:103], v9 offset:2064
    v_pk_mul_f32 v[124:125], v[124:125], v[14:15]
    v_pk_mul_f32 v[126:127], v[126:127], v[14:15]
    v_pk_mul_f32 v[128:129], v[128:129], v[14:15]
    v_pk_mul_f32 v[130:131], v[130:131], v[14:15]
    v_pk_mul_f32 v[132:133], v[132:133], v[14:15]
    v_pk_mul_f32 v[134:135], v[134:135], v[14:15]
    v_pk_mul_f32 v[136:137], v[136:137], v[14:15]
    v_pk_mul_f32 v[138:139], v[138:139], v[14:15]
    v_pk_mul_f32 v[140:141], v[140:141], v[14:15]
    v_pk_mul_f32 v[142:143], v[142:143], v[14:15]
    v_pk_mul_f32 v[144:145], v[144:145], v[14:15]
    v_pk_mul_f32 v[146:147], v[146:147], v[14:15]
    v_pk_mul_f32 v[148:149], v[148:149], v[14:15]
    v_pk_mul_f32 v[150:151], v[150:151], v[14:15]
    v_pk_mul_f32 v[152:153], v[152:153], v[14:15]
    v_pk_mul_f32 v[154:155], v[154:155], v[14:15]
    v_pk_mul_f32 v[156:157], v[156:157], v[14:15]
    v_pk_mul_f32 v[158:159], v[158:159], v[14:15]
    v_pk_mul_f32 v[160:161], v[160:161], v[14:15]
    v_pk_mul_f32 v[162:163], v[162:163], v[14:15]
    s_waitcnt lgkmcnt(15)
    v_pk_fma_f32 v[124:125], v[124:125], v[24:25], v[64:65]
    v_cvt_pk_bf16_f32 v164, v124, v125
    v_pk_fma_f32 v[126:127], v[126:127], v[26:27], v[66:67]
    v_cvt_pk_bf16_f32 v165, v126, v127
    v_pk_fma_f32 v[128:129], v[128:129], v[28:29], v[68:69]
    v_cvt_pk_bf16_f32 v166, v128, v129
    v_pk_fma_f32 v[130:131], v[130:131], v[30:31], v[70:71]
    v_cvt_pk_bf16_f32 v167, v130, v131
    s_waitcnt lgkmcnt(12)
    v_pk_fma_f32 v[132:133], v[132:133], v[32:33], v[72:73]
    v_cvt_pk_bf16_f32 v168, v132, v133
    v_pk_fma_f32 v[134:135], v[134:135], v[34:35], v[74:75]
    v_cvt_pk_bf16_f32 v169, v134, v135
    v_pk_fma_f32 v[136:137], v[136:137], v[36:37], v[76:77]
    v_cvt_pk_bf16_f32 v170, v136, v137
    v_pk_fma_f32 v[138:139], v[138:139], v[38:39], v[78:79]
    v_cvt_pk_bf16_f32 v171, v138, v139
    s_waitcnt lgkmcnt(8)
    v_pk_fma_f32 v[140:141], v[140:141], v[40:41], v[80:81]
    v_cvt_pk_bf16_f32 v172, v140, v141
    v_pk_fma_f32 v[142:143], v[142:143], v[42:43], v[82:83]
    v_cvt_pk_bf16_f32 v173, v142, v143
    v_pk_fma_f32 v[144:145], v[144:145], v[44:45], v[84:85]
    v_cvt_pk_bf16_f32 v174, v144, v145
    v_pk_fma_f32 v[146:147], v[146:147], v[46:47], v[86:87]
    v_cvt_pk_bf16_f32 v175, v146, v147
    s_waitcnt lgkmcnt(4)
    v_pk_fma_f32 v[148:149], v[148:149], v[48:49], v[88:89]
    v_cvt_pk_bf16_f32 v176, v148, v149
    v_pk_fma_f32 v[150:151], v[150:151], v[50:51], v[90:91]
    v_cvt_pk_bf16_f32 v177, v150, v151
    v_pk_fma_f32 v[152:153], v[152:153], v[52:53], v[92:93]
    v_cvt_pk_bf16_f32 v178, v152, v153
    v_pk_fma_f32 v[154:155], v[154:155], v[54:55], v[94:95]
    v_cvt_pk_bf16_f32 v179, v154, v155
    s_waitcnt lgkmcnt(0)
    v_pk_fma_f32 v[156:157], v[156:157], v[56:57], v[96:97]
    v_cvt_pk_bf16_f32 v180, v156, v157
    v_pk_fma_f32 v[158:159], v[158:159], v[58:59], v[98:99]
    v_cvt_pk_bf16_f32 v181, v158, v159
    v_pk_fma_f32 v[160:161], v[160:161], v[60:61], v[100:101]
    v_cvt_pk_bf16_f32 v182, v160, v161
    v_pk_fma_f32 v[162:163], v[162:163], v[62:63], v[102:103]
    v_cvt_pk_bf16_f32 v183, v162, v163
    v_and_b32 v10, 31, v5
    v_lshlrev_b32 v10, 4, v10
    v_lshl_add_u32 v10, v7, 10, v10
    v_lshl_add_u32 v10, v8, 9, v10
    s_lshl_b32 s19, s12, 3
    s_lshr_b32 s20, s13, 2
    s_add_u32 s21, s19, s20
    s_mul_i32 s21, s21, 40960
    s_add_u32 s20, s21, 1048576
    buffer_store_dwordx4 v[164:167], v10, s[8:11], s20 offen
    s_add_u32 s20, s21, 1056768
    buffer_store_dwordx4 v[168:171], v10, s[8:11], s20 offen
    s_add_u32 s20, s21, 1064960
    buffer_store_dwordx4 v[172:175], v10, s[8:11], s20 offen
    s_add_u32 s20, s21, 1073152
    buffer_store_dwordx4 v[176:179], v10, s[8:11], s20 offen
    s_add_u32 s20, s21, 1081344
    buffer_store_dwordx4 v[180:183], v10, s[8:11], s20 offen
    s_lshl_b32 s22, s12, 7
    s_add_u32 s22, s22, 525312
    s_lshl_b32 s20, s13, 2
    s_add_u32 s20, s20, s22
    v_mov_b32 v250, s20
    v_mov_b32 v249, 1
    v_and_b32 v251, 31, v2
    v_lshlrev_b32 v251, 2, v251
    v_add_u32 v251, s22, v251
    s_mov_b32 s25, s21
    s_lshl_b32 s19, s12, 3
    s_add_u32 s20, s19, s3
    s_sub_u32 s21, 7, s3
    s_add_u32 s21, s19, s21
    s_mul_i32 s22, s20, 40960
    s_add_u32 s22, s22, 1048576
    s_mul_i32 s23, s21, 40960
    s_add_u32 s23, s23, 1048576
    s_mul_i32 s26, s13, 81920
    s_lshl_b32 s27, s3, 11
    s_add_u32 s26, s26, s27
    s_add_u32 s26, s26, 37748736
    v_add_u32 v5, 0x10000, v3
    s_waitcnt vmcnt(0)
    v_cmp_eq_u32 vcc, 0, v20
    s_cbranch_vccz H_XPO_29
    s_mov_b32 s18, 2000000
POLL_31:
    s_sub_u32 s18, s18, 1
    s_cmp_eq_u32 s18, 0
    s_cbranch_scc1 POLLX_32
    global_load_dword v20, v22, s[4:5] sc1
    s_waitcnt vmcnt(0)
    v_cmp_eq_u32 vcc, 0, v20
    s_cbranch_vccnz POLL_31
POLLX_32:
H_XPO_29:
    v_cmp_ne_u32 vcc, s15, v20
    s_cmp_eq_u64 vcc, 0
    s_cselect_b32 s14, 1, 0
    v_mov_b32 v18, 87040
    v_mov_b32 v19, s14
    ds_write_b32 v18, v19
    s_cmp_eq_u32 s14, 1
    s_cbranch_scc1 H_FS_30
    s_add_u32 s24, s25, 1048576
    buffer_store_dwordx4 v[164:167], v10, s[8:11], s24 offen sc1
    s_add_u32 s24, s25, 1056768
    buffer_store_dwordx4 v[168:171], v10, s[8:11], s24 offen sc1
    s_add_u32 s24, s25, 1064960
    buffer_store_dwordx4 v[172:175], v10, s[8:11], s24 offen sc1
    s_add_u32 s24, s25, 1073152
    buffer_store_dwordx4 v[176:179], v10, s[8:11], s24 offen sc1
    s_add_u32 s24, s25, 1081344
    buffer_store_dwordx4 v[180:183], v10, s[8:11], s24 offen sc1
    s_waitcnt vmcnt(0)
H_FS_30:
    s_waitcnt lgkmcnt(0)
    v_mov_b32 v18, 87064
    v_mov_b32 v19, 1
    s_mov_b64 exec, 1
    ds_add_u32 v18, v19
    s_mov_b64 exec, -1
    s_cmp_eq_u32 s3, 1
    s_cbranch_scc1 H_W1_33
    v_mov_b32 v18, 87060
    s_mov_b32 s18, 2000000
LSP_35:
    s_sub_u32 s18, s18, 1
    s_cmp_eq_u32 s18, 0
    s_cbranch_scc1 LSPX_36
    ds_read_b32 v19, v18
    s_waitcnt lgkmcnt(0)
    v_readfirstlane_b32 s24, v19
    s_cmp_lt_u32 s24, 1
    s_cbranch_scc1 LSP_35
LSPX_36:
    s_mov_b64 exec, 1
    s_cmp_eq_u32 s14, 0
    s_cbranch_scc1 ST_S_37
    global_store_dword v250, v249, s[4:5]
    s_branch ST_E_38
ST_S_37:
    global_store_dword v250, v249, s[4:5] sc1
ST_E_38:
    s_mov_b64 exec, -1
    s_mov_b32 s18, 2000000
    global_load_dword v252, v251, s[4:5] sc1
    s_nop 7
    global_load_dword v253, v251, s[4:5] sc1
    s_nop 7
POLL_39:
    global_load_dword v254, v251, s[4:5] sc1
    s_waitcnt vmcnt(2)
    v_cmp_eq_u32 vcc, 0, v252
    s_cbranch_vccz POLLX_40
    global_load_dword v252, v251, s[4:5] sc1
    s_waitcnt vmcnt(2)
    v_cmp_eq_u32 vcc, 0, v253
    s_cbranch_vccz POLLX_40
    global_load_dword v253, v251, s[4:5] sc1
    s_waitcnt vmcnt(2)
    v_cmp_eq_u32 vcc, 0, v254
    s_cbranch_vccz POLLX_40
    s_sub_u32 s18, s18, 1
    s_cmp_lg_u32 s18, 0
    s_cbranch_scc1 POLL_39
POLLX_40:
    s_branch H_ST_34
H_W1_33:
    v_mov_b32 v18, 87060
    v_mov_b32 v19, 1
    s_mov_b64 exec, 1
    ds_add_u32 v18, v19
    s_mov_b64 exec, -1
H_ST_34:
    s_branch H_END_25
H_W23_24:
    s_getreg_b32 s15, hwreg(HW_REG_XCC_ID, 0, 4)
    s_add_u32 s15, s15, 1
    s_cmp_lg_u32 s3, 2
    s_cbranch_scc1 H_XT_41
    s_lshl_b32 s19, s12, 7
    s_lshl_b32 s20, s13, 2
    s_add_u32 s19, s19, s20
    s_add_u32 s19, s19, 524288
    v_mov_b32 v18, s19
    v_mov_b32 v19, s15
    s_mov_b64 exec, 1
    global_store_dword v18, v19, s[4:5] sc1
    s_mov_b64 exec, -1
H_XT_41:
    s_mul_i32 s20, s12, 327680
    s_mul_i32 s21, s13, 10240
    s_add_u32 s20, s20, s21
    s_sub_u32 s21, s3, 2
    s_mul_i32 s21, s21, 5120
    s_add_u32 s20, s20, s21
    s_add_u32 s20, s20, 1048576
    v_lshlrev_b32 v9, 7, v2
    s_mov_b32 exec_lo, -1
    s_mov_b32 exec_hi, 0xff
    buffer_load_dword v255, v9, s[8:11], s20 offen
    s_mov_b64 exec, -1
    s_mul_i32 s20, s13, 81920
    s_sub_u32 s21, s3, 2
    s_lshl_b32 s21, s21, 12
    s_add_u32 s20, s20, s21
    s_add_u32 s20, s20, 37748736
    s_add_u32 m0, s21, 0
    s_nop 0
    buffer_load_dwordx4 v3, s[8:11], s20 offen offset:0 lds
    buffer_load_dwordx4 v3, s[8:11], s20 offen offset:1024 lds
    buffer_load_dwordx4 v3, s[8:11], s20 offen offset:2048 lds
    buffer_load_dwordx4 v3, s[8:11], s20 offen offset:3072 lds
    s_add_u32 s20, s20, 8192
    s_add_u32 m0, s21, 8192
    s_nop 0
    buffer_load_dwordx4 v3, s[8:11], s20 offen offset:0 lds
    buffer_load_dwordx4 v3, s[8:11], s20 offen offset:1024 lds
    buffer_load_dwordx4 v3, s[8:11], s20 offen offset:2048 lds
    buffer_load_dwordx4 v3, s[8:11], s20 offen offset:3072 lds
    s_add_u32 s20, s20, 8192
    s_add_u32 m0, s21, 16384
    s_nop 0
    buffer_load_dwordx4 v3, s[8:11], s20 offen offset:0 lds
    buffer_load_dwordx4 v3, s[8:11], s20 offen offset:1024 lds
    buffer_load_dwordx4 v3, s[8:11], s20 offen offset:2048 lds
    buffer_load_dwordx4 v3, s[8:11], s20 offen offset:3072 lds
    s_add_u32 s20, s20, 8192
    s_add_u32 m0, s21, 24576
    s_nop 0
    buffer_load_dwordx4 v3, s[8:11], s20 offen offset:0 lds
    buffer_load_dwordx4 v3, s[8:11], s20 offen offset:1024 lds
    buffer_load_dwordx4 v3, s[8:11], s20 offen offset:2048 lds
    buffer_load_dwordx4 v3, s[8:11], s20 offen offset:3072 lds
    s_add_u32 s20, s20, 8192
    s_add_u32 m0, s21, 32768
    s_nop 0
    buffer_load_dwordx4 v3, s[8:11], s20 offen offset:0 lds
    buffer_load_dwordx4 v3, s[8:11], s20 offen offset:1024 lds
    buffer_load_dwordx4 v3, s[8:11], s20 offen offset:2048 lds
    buffer_load_dwordx4 v3, s[8:11], s20 offen offset:3072 lds
    s_cmp_eq_u32 s3, 3
    s_cbranch_scc0 H_T3_42
    s_mul_i32 s20, s13, 20
    s_add_u32 s20, s20, 320
    v_add_u32 v10, s20, v2
    v_lshlrev_b32 v11, 4, v10
    s_mov_b32 s20, 393216
    buffer_load_dwordx4 v[44:47], v11, s[8:11], s20 offen
    s_mov_b32 s20, 408576
    buffer_load_dwordx4 v[48:51], v11, s[8:11], s20 offen
    s_mov_b32 s20, 423936
    buffer_load_dwordx4 v[52:55], v11, s[8:11], s20 offen
    s_mov_b32 s20, 439296
    buffer_load_dwordx4 v[56:59], v11, s[8:11], s20 offen
H_T3_42:
    s_waitcnt vmcnt(0)
    s_cmp_eq_u32 s3, 3
    s_cbranch_scc0 H_T4_43
    v_pk_add_f32 v[44:45], v[44:45], v[48:49]
    v_pk_add_f32 v[52:53], v[52:53], v[56:57]
    v_pk_add_f32 v[46:47], v[46:47], v[50:51]
    v_pk_add_f32 v[54:55], v[54:55], v[58:59]
    v_pk_add_f32 v[44:45], v[44:45], v[52:53]
    v_pk_add_f32 v[46:47], v[46:47], v[54:55]
    v_mul_u32_u24 v12, 410, v10
    v_lshrrev_b32 v12, 16, v12
    v_mul_u32_u24 v13, 160, v12
    v_sub_u32 v13, v10, v13
    v_lshrrev_b32 v14, 2, v13
    v_lshlrev_b32 v14, 5, v14
    v_and_b32 v15, 1, v13
    v_lshl_add_u32 v14, v15, 4, v14
    v_bfe_u32 v15, v13, 1, 1
    v_lshl_add_u32 v14, v15, 3, v14
    v_mul_u32_u24 v15, 1280, v12
    v_add_u32 v14, v14, v15
    v_cmp_eq_u32 vcc, 4, v12
    s_nop 1
    v_cndmask_b32_e64 v12, 0, 1.0, vcc
    v_cvt_pk_bf16_f32 v48, v44, v45
    v_cvt_pk_bf16_f32 v49, v46, v47
    v_lshlrev_b32 v44, 16, v48
    v_and_b32 v45, 0xffff0000, v48
    v_lshlrev_b32 v46, 16, v49
    v_and_b32 v47, 0xffff0000, v49
    v_add_f32 v44, v44, v12
    v_add_f32 v45, v45, v12
    v_add_f32 v46, v46, v12
    v_add_f32 v47, v47, v12
    v_cvt_pk_bf16_f32 v48, v44, v45
    v_cvt_pk_bf16_f32 v49, v46, v47
    s_lshl_b32 s20, s12, 13
    s_add_u32 s20, s20, 458752
    s_mov_b32 exec_lo, 0xfffff
    s_mov_b32 exec_hi, 0
    buffer_store_dwordx2 v[48:49], v14, s[8:11], s20 offen sc1
    s_mov_b64 exec, -1
H_T4_43:
    v_mov_b32 v18, 87064
    s_mov_b32 s18, 2000000
LSP_44:
    s_sub_u32 s18, s18, 1
    s_cmp_eq_u32 s18, 0
    s_cbranch_scc1 LSPX_45
    ds_read_b32 v19, v18
    s_waitcnt lgkmcnt(0)
    v_readfirstlane_b32 s24, v19
    s_cmp_lt_u32 s24, 1
    s_cbranch_scc1 LSP_44
LSPX_45:
    v_mov_b32 v18, 87040
    ds_read_b32 v19, v18
    s_waitcnt lgkmcnt(0)
    v_readfirstlane_b32 s14, v19
    s_lshl_b32 s19, s12, 3
    s_add_u32 s20, s19, s3
    s_sub_u32 s21, 7, s3
    s_add_u32 s21, s19, s21
    s_mul_i32 s22, s20, 40960
    s_add_u32 s22, s22, 1048576
    s_mul_i32 s23, s21, 40960
    s_add_u32 s23, s23, 1048576
    s_mul_i32 s26, s13, 81920
    s_lshl_b32 s27, s3, 11
    s_add_u32 s26, s26, s27
    s_add_u32 s26, s26, 37748736
    v_add_u32 v5, 0x10000, v3
H_END_25:
    s_setprio 0
    s_waitcnt lgkmcnt(0)
    s_barrier
    s_add_u32 s24, s22, 0
    buffer_load_dwordx4 a[0:3], v3, s[8:11], s24 offen offset:0 sc1
    buffer_load_dwordx4 a[8:11], v3, s[8:11], s24 offen offset:1024 sc1
    buffer_load_dwordx4 a[16:19], v3, s[8:11], s24 offen offset:2048 sc1
    buffer_load_dwordx4 a[24:27], v3, s[8:11], s24 offen offset:3072 sc1
    s_add_u32 s25, s23, 0
    buffer_load_dwordx4 a[4:7], v3, s[8:11], s25 offen offset:0 sc1
    buffer_load_dwordx4 a[12:15], v3, s[8:11], s25 offen offset:1024 sc1
    buffer_load_dwordx4 a[20:23], v3, s[8:11], s25 offen offset:2048 sc1
    buffer_load_dwordx4 a[28:31], v3, s[8:11], s25 offen offset:3072 sc1
    s_add_u32 s24, s22, 4096
    buffer_load_dwordx4 a[32:35], v3, s[8:11], s24 offen offset:0 sc1
    buffer_load_dwordx4 a[40:43], v3, s[8:11], s24 offen offset:1024 sc1
    buffer_load_dwordx4 a[48:51], v3, s[8:11], s24 offen offset:2048 sc1
    buffer_load_dwordx4 a[56:59], v3, s[8:11], s24 offen offset:3072 sc1
    s_add_u32 s25, s23, 4096
    buffer_load_dwordx4 a[36:39], v3, s[8:11], s25 offen offset:0 sc1
    buffer_load_dwordx4 a[44:47], v3, s[8:11], s25 offen offset:1024 sc1
    buffer_load_dwordx4 a[52:55], v3, s[8:11], s25 offen offset:2048 sc1
    buffer_load_dwordx4 a[60:63], v3, s[8:11], s25 offen offset:3072 sc1
    s_add_u32 s24, s22, 8192
    buffer_load_dwordx4 a[64:67], v3, s[8:11], s24 offen offset:0 sc1
    buffer_load_dwordx4 a[72:75], v3, s[8:11], s24 offen offset:1024 sc1
    buffer_load_dwordx4 a[80:83], v3, s[8:11], s24 offen offset:2048 sc1
    buffer_load_dwordx4 a[88:91], v3, s[8:11], s24 offen offset:3072 sc1
    s_add_u32 s25, s23, 8192
    buffer_load_dwordx4 a[68:71], v3, s[8:11], s25 offen offset:0 sc1
    buffer_load_dwordx4 a[76:79], v3, s[8:11], s25 offen offset:1024 sc1
    buffer_load_dwordx4 a[84:87], v3, s[8:11], s25 offen offset:2048 sc1
    buffer_load_dwordx4 a[92:95], v3, s[8:11], s25 offen offset:3072 sc1
    ds_read_b128 v[16:19], v3 offset:0
    ds_read_b128 v[20:23], v3 offset:1024
    ds_read_b128 v[24:27], v3 offset:2048
    ds_read_b128 v[28:31], v3 offset:3072
    s_waitcnt vmcnt(19)
    s_waitcnt lgkmcnt(3)
    v_mfma_f32_32x32x16_bf16 v[40:55], v[16:19], a[0:3], 0
    ds_read_b128 v[32:35], v3 offset:4096
    s_nop 0
    v_mfma_f32_32x32x16_bf16 v[72:87], v[16:19], a[4:7], 0
    s_add_u32 s24, s22, 12288
    buffer_load_dwordx4 a[96:99], v3, s[8:11], s24 offen offset:0 sc1
    s_nop 0
    s_waitcnt lgkmcnt(3)
    v_mfma_f32_32x32x16_bf16 v[56:71], v[20:23], a[0:3], 0
    ds_read_b128 v[36:39], v3 offset:5120
    s_nop 0
    v_mfma_f32_32x32x16_bf16 v[88:103], v[20:23], a[4:7], 0
    buffer_load_dwordx4 a[104:107], v3, s[8:11], s24 offen offset:1024 sc1
    s_nop 0
    s_waitcnt vmcnt(20)
    s_waitcnt lgkmcnt(3)
    v_mfma_f32_32x32x16_bf16 v[40:55], v[24:27], a[8:11], v[40:55]
    ds_read_b128 v[16:19], v3 offset:6144
    s_nop 0
    v_mfma_f32_32x32x16_bf16 v[72:87], v[24:27], a[12:15], v[72:87]
    buffer_load_dwordx4 a[112:115], v3, s[8:11], s24 offen offset:2048 sc1
    s_nop 0
    s_waitcnt lgkmcnt(3)
    v_mfma_f32_32x32x16_bf16 v[56:71], v[28:31], a[8:11], v[56:71]
    ds_read_b128 v[20:23], v3 offset:7168
    s_nop 0
    v_mfma_f32_32x32x16_bf16 v[88:103], v[28:31], a[12:15], v[88:103]
    buffer_load_dwordx4 a[120:123], v3, s[8:11], s24 offen offset:3072 sc1
    s_nop 0
    s_waitcnt vmcnt(21)
    s_waitcnt lgkmcnt(3)
    v_mfma_f32_32x32x16_bf16 v[40:55], v[32:35], a[16:19], v[40:55]
    ds_read_b128 v[24:27], v3 offset:8192
    v_and_b32 v6, 31, v2
    v_lshrrev_b32 v7, 5, v2
    v_mfma_f32_32x32x16_bf16 v[72:87], v[32:35], a[20:23], v[72:87]
    s_add_u32 s25, s23, 12288
    buffer_load_dwordx4 a[100:103], v3, s[8:11], s25 offen offset:0 sc1
    v_lshlrev_b32 v8, 4, v0
    v_add_u32 v8, 134656, v8
    s_waitcnt lgkmcnt(3)
    v_mfma_f32_32x32x16_bf16 v[56:71], v[36:39], a[16:19], v[56:71]
    ds_read_b128 v[28:31], v3 offset:9216
    v_mov_b32 v12, 0
    v_mov_b32 v13, 0
    v_mfma_f32_32x32x16_bf16 v[88:103], v[36:39], a[20:23], v[88:103]
    buffer_load_dwordx4 a[108:111], v3, s[8:11], s25 offen offset:1024 sc1
    v_mov_b32 v14, 0
    v_mov_b32 v15, 0
    s_waitcnt vmcnt(22)
    s_waitcnt lgkmcnt(3)
    v_mfma_f32_32x32x16_bf16 v[40:55], v[16:19], a[24:27], v[40:55]
    ds_read_b128 v[32:35], v3 offset:10240
    s_cmp_lg_u32 s12, 0
    s_cbranch_scc1 A_NB_46
    v_mov_b32 v9, 50922
    v_cmp_gt_u32 vcc, 128, v0
    s_nop 1
    v_cndmask_b32 v12, 0, v9, vcc
    v_mov_b32 v14, v12
    A_NB_46:
    ds_write_b128 v8, v[12:15]
    v_mfma_f32_32x32x16_bf16 v[72:87], v[16:19], a[28:31], v[72:87]
    buffer_load_dwordx4 a[116:119], v3, s[8:11], s25 offen offset:2048 sc1
    v_mov_b32 v12, 0x3f803f80
    v_mov_b32 v13, 0x3f803f80
    s_waitcnt lgkmcnt(3)
    v_mfma_f32_32x32x16_bf16 v[56:71], v[20:23], a[24:27], v[56:71]
    ds_read_b128 v[36:39], v3 offset:11264
    v_mov_b32 v14, 0x3f803f80
    v_mov_b32 v15, 0x3f803f80
    v_mfma_f32_32x32x16_bf16 v[88:103], v[20:23], a[28:31], v[88:103]
    buffer_load_dwordx4 a[124:127], v3, s[8:11], s25 offen offset:3072 sc1
    v_lshlrev_b32 v8, 4, v0
    v_add_u32 v8, 159488, v8
    s_waitcnt vmcnt(19)
    s_waitcnt lgkmcnt(3)
    v_mfma_f32_32x32x16_bf16 v[40:55], v[24:27], a[32:35], v[40:55]
    ds_read_b128 v[16:19], v3 offset:12288
    ds_write_b128 v8, v[12:15]
    v_mfma_f32_32x32x16_bf16 v[72:87], v[24:27], a[36:39], v[72:87]
    s_add_u32 s24, s22, 16384
    buffer_load_dwordx4 a[128:131], v3, s[8:11], s24 offen offset:0 sc1
    s_cmp_lg_u32 s3, 0
    s_cbranch_scc1 A_NO_47
    s_mov_b64 exec, 0xffff
    ds_write_b128 v8, v[12:15] offset:4096
    s_mov_b64 exec, -1
    A_NO_47:
    s_waitcnt lgkmcnt(3)
    v_mfma_f32_32x32x16_bf16 v[56:71], v[28:31], a[32:35], v[56:71]
    ds_read_b128 v[20:23], v3 offset:13312
    s_cmp_lg_u32 s12, 0
    s_cbranch_scc1 A_NZ_48
    v_mov_b32 v12, 0
    v_mov_b32 v13, 0
    v_mov_b32 v14, 0
    v_mov_b32 v15, 0
    v_and_b32 v8, 127, v0
    v_lshlrev_b32 v8, 4, v8
    v_lshrrev_b32 v9, 7, v0
    v_mul_u32_u24 v10, 4096, v9
    v_add_u32 v10, v10, v8
    v_add_u32 v10, 114176, v10
    ds_write_b128 v10, v[12:15] offset:0
    ds_write_b128 v10, v[12:15] offset:8192
    v_mul_u32_u24 v11, 4128, v9
    v_add_u32 v11, v11, v8
    v_add_u32 v11, 138752, v11
    ds_write_b128 v11, v[12:15] offset:0
    ds_write_b128 v11, v[12:15] offset:8256
    s_cmp_ge_u32 s3, 2
    s_cbranch_scc1 A_NZ2_49
    ds_write_b128 v10, v[12:15] offset:16384
    ds_write_b128 v11, v[12:15] offset:16512
    A_NZ2_49:
    A_NZ_48:
    v_mfma_f32_32x32x16_bf16 v[88:103], v[28:31], a[36:39], v[88:103]
    buffer_load_dwordx4 a[136:139], v3, s[8:11], s24 offen offset:1024 sc1
    v_mul_u32_u24 v8, 4096, v7
    v_add_u32 v8, 114176, v8
    s_waitcnt vmcnt(20)
    s_waitcnt lgkmcnt(3)
    v_mfma_f32_32x32x16_bf16 v[40:55], v[32:35], a[40:43], v[40:55]
    ds_read_b128 v[24:27], v3 offset:14336
    v_mul_u32_u24 v9, 4128, v7
    v_add_u32 v9, 138752, v9
    v_mfma_f32_32x32x16_bf16 v[72:87], v[32:35], a[44:47], v[72:87]
    buffer_load_dwordx4 a[144:147], v3, s[8:11], s24 offen offset:2048 sc1
    v_mov_b32 v10, 130560
    v_mov_b32 v11, 155264
    s_waitcnt lgkmcnt(3)
    v_mfma_f32_32x32x16_bf16 v[56:71], v[36:39], a[40:43], v[56:71]
    ds_read_b128 v[28:31], v3 offset:15360
    v_cmp_eq_u32 vcc, 1, v7
    v_mfma_f32_32x32x16_bf16 v[88:103], v[36:39], a[44:47], v[88:103]
    buffer_load_dwordx4 a[152:155], v3, s[8:11], s24 offen offset:3072 sc1
    v_cndmask_b32 v10, v10, v11, vcc
    s_waitcnt vmcnt(21)
    s_waitcnt lgkmcnt(3)
    v_mfma_f32_32x32x16_bf16 v[40:55], v[16:19], a[48:51], v[40:55]
    ds_read_b128 v[32:35], v3 offset:16384
    s_mul_i32 s31, s12, 786432
    s_mul_i32 s29, s13, 20480
    s_add_u32 s31, s31, s29
    s_add_u32 s31, s31, 8388608
    v_mfma_f32_32x32x16_bf16 v[72:87], v[16:19], a[52:55], v[72:87]
    s_add_u32 s25, s23, 16384
    buffer_load_dwordx4 a[132:135], v3, s[8:11], s25 offen offset:0 sc1
    v_lshlrev_b32 v11, 11, v7
    v_mov_b32 v12, 8192
    s_waitcnt lgkmcnt(3)
    v_mfma_f32_32x32x16_bf16 v[56:71], v[20:23], a[48:51], v[56:71]
    ds_read_b128 v[36:39], v3 offset:17408
    v_mov_b32 v13, 18432
    v_mfma_f32_32x32x16_bf16 v[88:103], v[20:23], a[52:55], v[88:103]
    buffer_load_dwordx4 a[140:143], v3, s[8:11], s25 offen offset:1024 sc1
    v_cndmask_b32 v12, v12, v13, vcc
    s_waitcnt vmcnt(22)
    s_waitcnt lgkmcnt(3)
    v_mfma_f32_32x32x16_bf16 v[40:55], v[24:27], a[56:59], v[40:55]
    ds_read_b128 v[16:19], v3 offset:18432
    s_sub_u32 s29, s20, s19
    s_lshl_b32 s29, s29, 5
    v_add_u32 v14, s29, v6
    v_mfma_f32_32x32x16_bf16 v[72:87], v[24:27], a[60:63], v[72:87]
    buffer_load_dwordx4 a[148:151], v3, s[8:11], s25 offen offset:2048 sc1
    v_lshlrev_b32 v14, 3, v14
    s_waitcnt lgkmcnt(3)
    v_mfma_f32_32x32x16_bf16 v[56:71], v[28:31], a[56:59], v[56:71]
    ds_read_b128 v[20:23], v3 offset:19456
    s_sub_u32 s29, s21, s19
    s_lshl_b32 s29, s29, 5
    v_add_u32 v15, s29, v6
    v_mfma_f32_32x32x16_bf16 v[88:103], v[28:31], a[60:63], v[88:103]
    buffer_load_dwordx4 a[156:159], v3, s[8:11], s25 offen offset:3072 sc1
    v_lshlrev_b32 v15, 3, v15
    s_waitcnt vmcnt(19)
    s_waitcnt lgkmcnt(3)
    v_mfma_f32_32x32x16_bf16 v[40:55], v[32:35], a[64:67], v[40:55]
    ds_read_b128 v[24:27], v3 offset:20480
    v_mfma_f32_32x32x16_bf16 v[72:87], v[32:35], a[68:71], v[72:87]
    s_add_u32 m0, s27, 40960
    s_add_u32 s28, s26, 40960
    buffer_load_dwordx4 v3, s[8:11], s28 offen lds
    s_waitcnt lgkmcnt(3)
    v_mfma_f32_32x32x16_bf16 v[56:71], v[36:39], a[64:67], v[56:71]
    ds_read_b128 v[28:31], v3 offset:21504
    v_mfma_f32_32x32x16_bf16 v[88:103], v[36:39], a[68:71], v[88:103]
    buffer_load_dwordx4 v3, s[8:11], s28 offen offset:1024 lds
    s_waitcnt vmcnt(20)
    s_waitcnt lgkmcnt(3)
    v_mfma_f32_32x32x16_bf16 v[40:55], v[16:19], a[72:75], v[40:55]
    ds_read_b128 v[32:35], v3 offset:22528
    v_mfma_f32_32x32x16_bf16 v[72:87], v[16:19], a[76:79], v[72:87]
    s_add_u32 s24, s22, 20480
    buffer_load_dwordx4 a[160:163], v3, s[8:11], s24 offen offset:0 sc1
    s_waitcnt lgkmcnt(3)
    v_mfma_f32_32x32x16_bf16 v[56:71], v[20:23], a[72:75], v[56:71]
    ds_read_b128 v[36:39], v3 offset:23552
    v_mfma_f32_32x32x16_bf16 v[88:103], v[20:23], a[76:79], v[88:103]
    buffer_load_dwordx4 a[168:171], v3, s[8:11], s24 offen offset:1024 sc1
    s_waitcnt vmcnt(21)
    s_waitcnt lgkmcnt(3)
    v_mfma_f32_32x32x16_bf16 v[40:55], v[24:27], a[80:83], v[40:55]
    ds_read_b128 v[16:19], v3 offset:24576
    v_mfma_f32_32x32x16_bf16 v[72:87], v[24:27], a[84:87], v[72:87]
    buffer_load_dwordx4 a[176:179], v3, s[8:11], s24 offen offset:2048 sc1
    s_waitcnt lgkmcnt(3)
    v_mfma_f32_32x32x16_bf16 v[56:71], v[28:31], a[80:83], v[56:71]
    ds_read_b128 v[20:23], v3 offset:25600
    v_mfma_f32_32x32x16_bf16 v[88:103], v[28:31], a[84:87], v[88:103]
    buffer_load_dwordx4 a[184:187], v3, s[8:11], s24 offen offset:3072 sc1
    s_waitcnt vmcnt(22)
    s_waitcnt lgkmcnt(3)
    v_mfma_f32_32x32x16_bf16 v[40:55], v[32:35], a[88:91], v[40:55]
    ds_read_b128 v[24:27], v3 offset:26624
    v_mfma_f32_32x32x16_bf16 v[72:87], v[32:35], a[92:95], v[72:87]
    s_add_u32 s25, s23, 20480
    buffer_load_dwordx4 a[164:167], v3, s[8:11], s25 offen offset:0 sc1
    s_waitcnt lgkmcnt(3)
    v_mfma_f32_32x32x16_bf16 v[56:71], v[36:39], a[88:91], v[56:71]
    ds_read_b128 v[28:31], v3 offset:27648
    v_mfma_f32_32x32x16_bf16 v[88:103], v[36:39], a[92:95], v[88:103]
    buffer_load_dwordx4 a[172:175], v3, s[8:11], s25 offen offset:1024 sc1
    s_waitcnt vmcnt(19)
    s_waitcnt lgkmcnt(3)
    v_mfma_f32_32x32x16_bf16 v[40:55], v[16:19], a[96:99], v[40:55]
    ds_read_b128 v[32:35], v3 offset:28672
    v_mfma_f32_32x32x16_bf16 v[72:87], v[16:19], a[100:103], v[72:87]
    buffer_load_dwordx4 a[180:183], v3, s[8:11], s25 offen offset:2048 sc1
    s_waitcnt lgkmcnt(3)
    v_mfma_f32_32x32x16_bf16 v[56:71], v[20:23], a[96:99], v[56:71]
    ds_read_b128 v[36:39], v3 offset:29696
    v_mfma_f32_32x32x16_bf16 v[88:103], v[20:23], a[100:103], v[88:103]
    buffer_load_dwordx4 a[188:191], v3, s[8:11], s25 offen offset:3072 sc1
    s_waitcnt vmcnt(20)
    s_waitcnt lgkmcnt(3)
    v_mfma_f32_32x32x16_bf16 v[40:55], v[24:27], a[104:107], v[40:55]
    ds_read_b128 v[16:19], v3 offset:30720
    v_mfma_f32_32x32x16_bf16 v[72:87], v[24:27], a[108:111], v[72:87]
    s_add_u32 m0, s27, 49152
    s_add_u32 s28, s26, 49152
    buffer_load_dwordx4 v3, s[8:11], s28 offen lds
    s_waitcnt lgkmcnt(3)
    v_mfma_f32_32x32x16_bf16 v[56:71], v[28:31], a[104:107], v[56:71]
    ds_read_b128 v[20:23], v3 offset:31744
    v_mfma_f32_32x32x16_bf16 v[88:103], v[28:31], a[108:111], v[88:103]
    buffer_load_dwordx4 v3, s[8:11], s28 offen offset:1024 lds
    s_waitcnt vmcnt(21)
    s_waitcnt lgkmcnt(3)
    v_mfma_f32_32x32x16_bf16 v[40:55], v[32:35], a[112:115], v[40:55]
    ds_read_b128 v[24:27], v3 offset:32768
    v_mfma_f32_32x32x16_bf16 v[72:87], v[32:35], a[116:119], v[72:87]
    s_add_u32 s24, s22, 24576
    buffer_load_dwordx4 a[192:195], v3, s[8:11], s24 offen offset:0 sc1
    s_waitcnt lgkmcnt(3)
    v_mfma_f32_32x32x16_bf16 v[56:71], v[36:39], a[112:115], v[56:71]
    ds_read_b128 v[28:31], v3 offset:33792
    v_mfma_f32_32x32x16_bf16 v[88:103], v[36:39], a[116:119], v[88:103]
    buffer_load_dwordx4 a[200:203], v3, s[8:11], s24 offen offset:1024 sc1
    s_waitcnt vmcnt(22)
    s_waitcnt lgkmcnt(3)
    v_mfma_f32_32x32x16_bf16 v[40:55], v[16:19], a[120:123], v[40:55]
    ds_read_b128 v[32:35], v3 offset:34816
    v_mfma_f32_32x32x16_bf16 v[72:87], v[16:19], a[124:127], v[72:87]
    buffer_load_dwordx4 a[208:211], v3, s[8:11], s24 offen offset:2048 sc1
    s_waitcnt lgkmcnt(3)
    v_mfma_f32_32x32x16_bf16 v[56:71], v[20:23], a[120:123], v[56:71]
    ds_read_b128 v[36:39], v3 offset:35840
    v_mfma_f32_32x32x16_bf16 v[88:103], v[20:23], a[124:127], v[88:103]
    buffer_load_dwordx4 a[216:219], v3, s[8:11], s24 offen offset:3072 sc1
    s_waitcnt vmcnt(19)
    s_waitcnt lgkmcnt(3)
    v_mfma_f32_32x32x16_bf16 v[40:55], v[24:27], a[128:131], v[40:55]
    ds_read_b128 v[16:19], v3 offset:36864
    v_mfma_f32_32x32x16_bf16 v[72:87], v[24:27], a[132:135], v[72:87]
    s_add_u32 s25, s23, 24576
    buffer_load_dwordx4 a[196:199], v3, s[8:11], s25 offen offset:0 sc1
    s_waitcnt lgkmcnt(3)
    v_mfma_f32_32x32x16_bf16 v[56:71], v[28:31], a[128:131], v[56:71]
    ds_read_b128 v[20:23], v3 offset:37888
    v_mfma_f32_32x32x16_bf16 v[88:103], v[28:31], a[132:135], v[88:103]
    buffer_load_dwordx4 a[204:207], v3, s[8:11], s25 offen offset:1024 sc1
    s_waitcnt vmcnt(20)
    s_waitcnt lgkmcnt(3)
    v_mfma_f32_32x32x16_bf16 v[40:55], v[32:35], a[136:139], v[40:55]
    ds_read_b128 v[24:27], v3 offset:38912
    v_mfma_f32_32x32x16_bf16 v[72:87], v[32:35], a[140:143], v[72:87]
    buffer_load_dwordx4 a[212:215], v3, s[8:11], s25 offen offset:2048 sc1
    s_waitcnt lgkmcnt(3)
    v_mfma_f32_32x32x16_bf16 v[56:71], v[36:39], a[136:139], v[56:71]
    ds_read_b128 v[28:31], v3 offset:39936
    v_mfma_f32_32x32x16_bf16 v[88:103], v[36:39], a[140:143], v[88:103]
    buffer_load_dwordx4 a[220:223], v3, s[8:11], s25 offen offset:3072 sc1
    s_waitcnt vmcnt(18)
    s_barrier
    s_waitcnt vmcnt(21)
    s_waitcnt lgkmcnt(3)
    v_mfma_f32_32x32x16_bf16 v[40:55], v[16:19], a[144:147], v[40:55]
    ds_read_b128 v[32:35], v3 offset:40960
    v_mfma_f32_32x32x16_bf16 v[72:87], v[16:19], a[148:151], v[72:87]
    s_add_u32 m0, s27, 57344
    s_add_u32 s28, s26, 57344
    buffer_load_dwordx4 v3, s[8:11], s28 offen lds
    s_waitcnt lgkmcnt(3)
    v_mfma_f32_32x32x16_bf16 v[56:71], v[20:23], a[144:147], v[56:71]
    ds_read_b128 v[36:39], v3 offset:41984
    v_mfma_f32_32x32x16_bf16 v[88:103], v[20:23], a[148:151], v[88:103]
    buffer_load_dwordx4 v3, s[8:11], s28 offen offset:1024 lds
    s_waitcnt vmcnt(22)
    s_waitcnt lgkmcnt(3)
    v_mfma_f32_32x32x16_bf16 v[40:55], v[24:27], a[152:155], v[40:55]
    ds_read_b128 v[16:19], v3 offset:43008
    v_mfma_f32_32x32x16_bf16 v[72:87], v[24:27], a[156:159], v[72:87]
    s_add_u32 s24, s22, 28672
    buffer_load_dwordx4 a[224:227], v3, s[8:11], s24 offen offset:0 sc1
    s_waitcnt lgkmcnt(3)
    v_mfma_f32_32x32x16_bf16 v[56:71], v[28:31], a[152:155], v[56:71]
    ds_read_b128 v[20:23], v3 offset:44032
    v_mfma_f32_32x32x16_bf16 v[88:103], v[28:31], a[156:159], v[88:103]
    buffer_load_dwordx4 a[232:235], v3, s[8:11], s24 offen offset:1024 sc1
    s_waitcnt vmcnt(17)
    s_waitcnt lgkmcnt(3)
    v_mfma_f32_32x32x16_bf16 v[40:55], v[32:35], a[160:163], v[40:55]
    ds_read_b128 v[24:27], v3 offset:45056
    v_mfma_f32_32x32x16_bf16 v[72:87], v[32:35], a[164:167], v[72:87]
    buffer_load_dwordx4 a[240:243], v3, s[8:11], s24 offen offset:2048 sc1
    s_waitcnt lgkmcnt(3)
    v_mfma_f32_32x32x16_bf16 v[56:71], v[36:39], a[160:163], v[56:71]
    ds_read_b128 v[28:31], v3 offset:46080
    v_mfma_f32_32x32x16_bf16 v[88:103], v[36:39], a[164:167], v[88:103]
    buffer_load_dwordx4 a[248:251], v3, s[8:11], s24 offen offset:3072 sc1
    s_waitcnt vmcnt(18)
    s_waitcnt lgkmcnt(3)
    v_mfma_f32_32x32x16_bf16 v[40:55], v[16:19], a[168:171], v[40:55]
    ds_read_b128 v[32:35], v3 offset:47104
    v_mfma_f32_32x32x16_bf16 v[72:87], v[16:19], a[172:175], v[72:87]
    s_add_u32 s25, s23, 28672
    buffer_load_dwordx4 a[228:231], v3, s[8:11], s25 offen offset:0 sc1
    s_waitcnt lgkmcnt(3)
    v_mfma_f32_32x32x16_bf16 v[56:71], v[20:23], a[168:171], v[56:71]
    ds_read_b128 v[36:39], v3 offset:48128
    v_mfma_f32_32x32x16_bf16 v[88:103], v[20:23], a[172:175], v[88:103]
    buffer_load_dwordx4 a[236:239], v3, s[8:11], s25 offen offset:1024 sc1
    s_waitcnt vmcnt(16)
    s_barrier
    s_waitcnt vmcnt(19)
    s_waitcnt lgkmcnt(3)
    v_mfma_f32_32x32x16_bf16 v[40:55], v[24:27], a[176:179], v[40:55]
    ds_read_b128 v[16:19], v3 offset:49152
    v_mfma_f32_32x32x16_bf16 v[72:87], v[24:27], a[180:183], v[72:87]
    buffer_load_dwordx4 a[244:247], v3, s[8:11], s25 offen offset:2048 sc1
    s_waitcnt lgkmcnt(3)
    v_mfma_f32_32x32x16_bf16 v[56:71], v[28:31], a[176:179], v[56:71]
    ds_read_b128 v[20:23], v3 offset:50176
    v_mfma_f32_32x32x16_bf16 v[88:103], v[28:31], a[180:183], v[88:103]
    buffer_load_dwordx4 a[252:255], v3, s[8:11], s25 offen offset:3072 sc1
    s_waitcnt vmcnt(20)
    s_waitcnt lgkmcnt(3)
    v_mfma_f32_32x32x16_bf16 v[40:55], v[32:35], a[184:187], v[40:55]
    ds_read_b128 v[24:27], v3 offset:51200
    v_mfma_f32_32x32x16_bf16 v[72:87], v[32:35], a[188:191], v[72:87]
    s_add_u32 m0, s27, 65536
    s_add_u32 s28, s26, 65536
    buffer_load_dwordx4 v3, s[8:11], s28 offen lds
    s_waitcnt lgkmcnt(3)
    v_mfma_f32_32x32x16_bf16 v[56:71], v[36:39], a[184:187], v[56:71]
    ds_read_b128 v[28:31], v3 offset:52224
    v_mfma_f32_32x32x16_bf16 v[88:103], v[36:39], a[188:191], v[88:103]
    buffer_load_dwordx4 v3, s[8:11], s28 offen offset:1024 lds
    s_waitcnt vmcnt(15)
    s_waitcnt lgkmcnt(3)
    v_mfma_f32_32x32x16_bf16 v[40:55], v[16:19], a[192:195], v[40:55]
    ds_read_b128 v[32:35], v3 offset:53248
    v_mfma_f32_32x32x16_bf16 v[72:87], v[16:19], a[196:199], v[72:87]
    s_add_u32 s24, s22, 32768
    buffer_load_dwordx4 a[0:3], v3, s[8:11], s24 offen offset:0 sc1
    s_waitcnt lgkmcnt(3)
    v_mfma_f32_32x32x16_bf16 v[56:71], v[20:23], a[192:195], v[56:71]
    ds_read_b128 v[36:39], v3 offset:54272
    v_mfma_f32_32x32x16_bf16 v[88:103], v[20:23], a[196:199], v[88:103]
    buffer_load_dwordx4 a[8:11], v3, s[8:11], s24 offen offset:1024 sc1
    s_waitcnt vmcnt(16)
    s_waitcnt lgkmcnt(3)
    v_mfma_f32_32x32x16_bf16 v[40:55], v[24:27], a[200:203], v[40:55]
    ds_read_b128 v[16:19], v3 offset:55296
    v_mfma_f32_32x32x16_bf16 v[72:87], v[24:27], a[204:207], v[72:87]
    buffer_load_dwordx4 a[16:19], v3, s[8:11], s24 offen offset:2048 sc1
    s_waitcnt lgkmcnt(3)
    v_mfma_f32_32x32x16_bf16 v[56:71], v[28:31], a[200:203], v[56:71]
    ds_read_b128 v[20:23], v3 offset:56320
    v_mfma_f32_32x32x16_bf16 v[88:103], v[28:31], a[204:207], v[88:103]
    buffer_load_dwordx4 a[24:27], v3, s[8:11], s24 offen offset:3072 sc1
    s_waitcnt vmcnt(14)
    s_barrier
    s_waitcnt vmcnt(17)
    s_waitcnt lgkmcnt(3)
    v_mfma_f32_32x32x16_bf16 v[40:55], v[32:35], a[208:211], v[40:55]
    ds_read_b128 v[24:27], v3 offset:57344
    v_mfma_f32_32x32x16_bf16 v[72:87], v[32:35], a[212:215], v[72:87]
    s_add_u32 s25, s23, 32768
    buffer_load_dwordx4 a[4:7], v3, s[8:11], s25 offen offset:0 sc1
    s_waitcnt lgkmcnt(3)
    v_mfma_f32_32x32x16_bf16 v[56:71], v[36:39], a[208:211], v[56:71]
    ds_read_b128 v[28:31], v3 offset:58368
    v_mfma_f32_32x32x16_bf16 v[88:103], v[36:39], a[212:215], v[88:103]
    buffer_load_dwordx4 a[12:15], v3, s[8:11], s25 offen offset:1024 sc1
    s_waitcnt vmcnt(18)
    s_waitcnt lgkmcnt(3)
    v_mfma_f32_32x32x16_bf16 v[40:55], v[16:19], a[216:219], v[40:55]
    ds_read_b128 v[32:35], v3 offset:59392
    v_mfma_f32_32x32x16_bf16 v[72:87], v[16:19], a[220:223], v[72:87]
    buffer_load_dwordx4 a[20:23], v3, s[8:11], s25 offen offset:2048 sc1
    s_waitcnt lgkmcnt(3)
    v_mfma_f32_32x32x16_bf16 v[56:71], v[20:23], a[216:219], v[56:71]
    ds_read_b128 v[36:39], v3 offset:60416
    v_mfma_f32_32x32x16_bf16 v[88:103], v[20:23], a[220:223], v[88:103]
    buffer_load_dwordx4 a[28:31], v3, s[8:11], s25 offen offset:3072 sc1
    s_waitcnt vmcnt(13)
    s_waitcnt lgkmcnt(3)
    v_mfma_f32_32x32x16_bf16 v[40:55], v[24:27], a[224:227], v[40:55]
    ds_read_b128 v[16:19], v3 offset:61440
    v_mfma_f32_32x32x16_bf16 v[72:87], v[24:27], a[228:231], v[72:87]
    s_add_u32 m0, s27, 73728
    s_add_u32 s28, s26, 73728
    buffer_load_dwordx4 v3, s[8:11], s28 offen lds
    s_waitcnt lgkmcnt(3)
    v_mfma_f32_32x32x16_bf16 v[56:71], v[28:31], a[224:227], v[56:71]
    ds_read_b128 v[20:23], v3 offset:62464
    v_mfma_f32_32x32x16_bf16 v[88:103], v[28:31], a[228:231], v[88:103]
    buffer_load_dwordx4 v3, s[8:11], s28 offen offset:1024 lds
    s_waitcnt vmcnt(14)
    s_waitcnt lgkmcnt(3)
    v_mfma_f32_32x32x16_bf16 v[40:55], v[32:35], a[232:235], v[40:55]
    ds_read_b128 v[24:27], v3 offset:63488
    v_mfma_f32_32x32x16_bf16 v[72:87], v[32:35], a[236:239], v[72:87]
    s_add_u32 s24, s22, 36864
    buffer_load_dwordx4 a[32:35], v3, s[8:11], s24 offen offset:0 sc1
    s_waitcnt lgkmcnt(3)
    v_mfma_f32_32x32x16_bf16 v[56:71], v[36:39], a[232:235], v[56:71]
    ds_read_b128 v[28:31], v3 offset:64512
    v_mfma_f32_32x32x16_bf16 v[88:103], v[36:39], a[236:239], v[88:103]
    buffer_load_dwordx4 a[40:43], v3, s[8:11], s24 offen offset:1024 sc1
    s_waitcnt vmcnt(12)
    s_barrier
    s_waitcnt vmcnt(15)
    s_waitcnt lgkmcnt(3)
    v_mfma_f32_32x32x16_bf16 v[40:55], v[16:19], a[240:243], v[40:55]
    ds_read_b128 v[32:35], v5 offset:0
    v_mfma_f32_32x32x16_bf16 v[72:87], v[16:19], a[244:247], v[72:87]
    buffer_load_dwordx4 a[48:51], v3, s[8:11], s24 offen offset:2048 sc1
    s_waitcnt lgkmcnt(3)
    v_mfma_f32_32x32x16_bf16 v[56:71], v[20:23], a[240:243], v[56:71]
    ds_read_b128 v[36:39], v5 offset:1024
    v_mfma_f32_32x32x16_bf16 v[88:103], v[20:23], a[244:247], v[88:103]
    buffer_load_dwordx4 a[56:59], v3, s[8:11], s24 offen offset:3072 sc1
    s_waitcnt vmcnt(16)
    s_waitcnt lgkmcnt(3)
    v_mfma_f32_32x32x16_bf16 v[40:55], v[24:27], a[248:251], v[40:55]
    ds_read_b128 v[16:19], v5 offset:2048
    v_mfma_f32_32x32x16_bf16 v[72:87], v[24:27], a[252:255], v[72:87]
    s_add_u32 s25, s23, 36864
    buffer_load_dwordx4 a[36:39], v3, s[8:11], s25 offen offset:0 sc1
    s_waitcnt lgkmcnt(3)
    v_mfma_f32_32x32x16_bf16 v[56:71], v[28:31], a[248:251], v[56:71]
    ds_read_b128 v[20:23], v5 offset:3072
    v_mfma_f32_32x32x16_bf16 v[88:103], v[28:31], a[252:255], v[88:103]
    buffer_load_dwordx4 a[44:47], v3, s[8:11], s25 offen offset:1024 sc1
    s_waitcnt vmcnt(11)
    s_waitcnt lgkmcnt(3)
    v_mfma_f32_32x32x16_bf16 v[40:55], v[32:35], a[0:3], v[40:55]
    ds_read_b128 v[24:27], v5 offset:4096
    v_mfma_f32_32x32x16_bf16 v[72:87], v[32:35], a[4:7], v[72:87]
    buffer_load_dwordx4 a[52:55], v3, s[8:11], s25 offen offset:2048 sc1
    s_waitcnt lgkmcnt(3)
    v_mfma_f32_32x32x16_bf16 v[56:71], v[36:39], a[0:3], v[56:71]
    ds_read_b128 v[28:31], v5 offset:5120
    v_mfma_f32_32x32x16_bf16 v[88:103], v[36:39], a[4:7], v[88:103]
    buffer_load_dwordx4 a[60:63], v3, s[8:11], s25 offen offset:3072 sc1
    s_waitcnt vmcnt(12)
    s_waitcnt lgkmcnt(3)
    v_mfma_f32_32x32x16_bf16 v[40:55], v[16:19], a[8:11], v[40:55]
    ds_read_b128 v[32:35], v5 offset:6144
    v_mfma_f32_32x32x16_bf16 v[72:87], v[16:19], a[12:15], v[72:87]
    s_waitcnt lgkmcnt(3)
    v_mfma_f32_32x32x16_bf16 v[56:71], v[20:23], a[8:11], v[56:71]
    ds_read_b128 v[36:39], v5 offset:7168
    v_mfma_f32_32x32x16_bf16 v[88:103], v[20:23], a[12:15], v[88:103]
    s_waitcnt vmcnt(8)
    s_barrier
    s_waitcnt vmcnt(11)
    s_waitcnt lgkmcnt(3)
    v_mfma_f32_32x32x16_bf16 v[40:55], v[24:27], a[16:19], v[40:55]
    ds_read_b128 v[16:19], v5 offset:8192
    v_mfma_f32_32x32x16_bf16 v[72:87], v[24:27], a[20:23], v[72:87]
    s_waitcnt lgkmcnt(3)
    v_mfma_f32_32x32x16_bf16 v[56:71], v[28:31], a[16:19], v[56:71]
    ds_read_b128 v[20:23], v5 offset:9216
    v_mfma_f32_32x32x16_bf16 v[88:103], v[28:31], a[20:23], v[88:103]
    s_waitcnt vmcnt(10)
    s_waitcnt lgkmcnt(3)
    v_mfma_f32_32x32x16_bf16 v[40:55], v[32:35], a[24:27], v[40:55]
    ds_read_b128 v[24:27], v5 offset:10240
    v_mfma_f32_32x32x16_bf16 v[72:87], v[32:35], a[28:31], v[72:87]
    s_waitcnt lgkmcnt(3)
    v_mfma_f32_32x32x16_bf16 v[56:71], v[36:39], a[24:27], v[56:71]
    ds_read_b128 v[28:31], v5 offset:11264
    v_mfma_f32_32x32x16_bf16 v[88:103], v[36:39], a[28:31], v[88:103]
    s_waitcnt vmcnt(3)
    s_waitcnt lgkmcnt(3)
    v_mfma_f32_32x32x16_bf16 v[40:55], v[16:19], a[32:35], v[40:55]
    ds_read_b128 v[32:35], v5 offset:12288
    v_mfma_f32_32x32x16_bf16 v[72:87], v[16:19], a[36:39], v[72:87]
    s_waitcnt lgkmcnt(3)
    v_mfma_f32_32x32x16_bf16 v[56:71], v[20:23], a[32:35], v[56:71]
    ds_read_b128 v[36:39], v5 offset:13312
    v_mfma_f32_32x32x16_bf16 v[88:103], v[20:23], a[36:39], v[88:103]
    s_waitcnt vmcnt(2)
    s_waitcnt lgkmcnt(3)
    v_mfma_f32_32x32x16_bf16 v[40:55], v[24:27], a[40:43], v[40:55]
    ds_read_b128 v[16:19], v5 offset:14336
    v_mfma_f32_32x32x16_bf16 v[72:87], v[24:27], a[44:47], v[72:87]
    s_waitcnt lgkmcnt(3)
    v_mfma_f32_32x32x16_bf16 v[56:71], v[28:31], a[40:43], v[56:71]
    ds_read_b128 v[20:23], v5 offset:15360
    v_mfma_f32_32x32x16_bf16 v[88:103], v[28:31], a[44:47], v[88:103]
    s_waitcnt vmcnt(1)
    s_waitcnt lgkmcnt(3)
    v_mfma_f32_32x32x16_bf16 v[40:55], v[32:35], a[48:51], v[40:55]
    v_mfma_f32_32x32x16_bf16 v[72:87], v[32:35], a[52:55], v[72:87]
    s_waitcnt lgkmcnt(2)
    v_mfma_f32_32x32x16_bf16 v[56:71], v[36:39], a[48:51], v[56:71]
    v_mfma_f32_32x32x16_bf16 v[88:103], v[36:39], a[52:55], v[88:103]
    s_waitcnt vmcnt(0)
    s_waitcnt lgkmcnt(1)
    v_mfma_f32_32x32x16_bf16 v[40:55], v[16:19], a[56:59], v[40:55]
    v_mfma_f32_32x32x16_bf16 v[72:87], v[16:19], a[60:63], v[72:87]
    s_waitcnt lgkmcnt(0)
    v_mfma_f32_32x32x16_bf16 v[56:71], v[20:23], a[56:59], v[56:71]
    v_mfma_f32_32x32x16_bf16 v[88:103], v[20:23], a[60:63], v[88:103]
    s_nop 7
    v_cvt_pk_bf16_f32 v120, v40, v41
    v_cvt_pk_bf16_f32 v121, v42, v43
    v_cvt_pk_bf16_f32 v122, v44, v45
    v_cvt_pk_bf16_f32 v123, v46, v47
    v_cvt_pk_bf16_f32 v124, v48, v49
    v_cvt_pk_bf16_f32 v125, v50, v51
    v_cvt_pk_bf16_f32 v126, v52, v53
    v_cvt_pk_bf16_f32 v127, v54, v55
    v_cvt_pk_bf16_f32 v128, v56, v57
    v_cvt_pk_bf16_f32 v129, v58, v59
    s_cmp_eq_u32 s12, 7
    s_cbranch_scc1 A_NS_50
    v_add_u32 v21, v11, v14
    v_add_u32 v22, v12, v14
    buffer_store_dwordx2 v[120:121], v21, s[8:11], s31 offen sc1
    s_add_u32 s25, s31, 4096
    buffer_store_dwordx2 v[122:123], v21, s[8:11], s25 offen sc1
    buffer_store_dwordx2 v[124:125], v22, s[8:11], s31 offen sc1
    s_add_u32 s25, s31, 10240
    buffer_store_dwordx2 v[126:127], v21, s[8:11], s25 offen sc1
    s_add_u32 s25, s31, 14336
    buffer_store_dwordx2 v[128:129], v21, s[8:11], s25 offen sc1
A_NS_50:
    v_cvt_pk_bf16_f32 v130, v72, v73
    v_cvt_pk_bf16_f32 v131, v74, v75
    v_cvt_pk_bf16_f32 v132, v76, v77
    v_cvt_pk_bf16_f32 v133, v78, v79
    v_cvt_pk_bf16_f32 v134, v80, v81
    v_cvt_pk_bf16_f32 v135, v82, v83
    v_cvt_pk_bf16_f32 v136, v84, v85
    v_cvt_pk_bf16_f32 v137, v86, v87
    v_cvt_pk_bf16_f32 v138, v88, v89
    v_cvt_pk_bf16_f32 v139, v90, v91
    s_cmp_eq_u32 s12, 7
    s_cbranch_scc1 A_NS_51
    v_add_u32 v21, v11, v15
    v_add_u32 v22, v12, v15
    buffer_store_dwordx2 v[130:131], v21, s[8:11], s31 offen sc1
    s_add_u32 s25, s31, 4096
    buffer_store_dwordx2 v[132:133], v21, s[8:11], s25 offen sc1
    buffer_store_dwordx2 v[134:135], v22, s[8:11], s31 offen sc1
    s_add_u32 s25, s31, 10240
    buffer_store_dwordx2 v[136:137], v21, s[8:11], s25 offen sc1
    s_add_u32 s25, s31, 14336
    buffer_store_dwordx2 v[138:139], v21, s[8:11], s25 offen sc1
A_NS_51:
    s_mov_b32 s24, s31
    v_cmp_eq_u32 vcc, 1, v7
    v_add_u32 v20, 2048, v14
    v_add_u32 v21, v8, v20
    ds_write_b64 v21, v[120:121]
    ds_write_b64 v21, v[122:123] offset:8192
    v_add_u32 v22, v10, v20
    ds_write_b64 v22, v[124:125]
    v_add_u32 v23, v9, v20
    ds_write_b64 v23, v[126:127]
    ds_write_b64 v23, v[128:129] offset:8256
    v_cvt_pk_bf16_f32 v224, v60, v61
    v_cvt_pk_bf16_f32 v225, v62, v63
    v_cvt_pk_bf16_f32 v226, v64, v65
    v_cvt_pk_bf16_f32 v227, v66, v67
    v_cvt_pk_bf16_f32 v228, v68, v69
    v_cvt_pk_bf16_f32 v229, v70, v71
    v_mov_b32 v21, 0x3f80
    v_cndmask_b32 v228, v228, v21, vcc
    v_cndmask_b32_e64 v229, v229, 0, vcc
    v_mov_b32 v230, 0
    v_mov_b32 v231, 0
    v_add_u32 v20, 2048, v15
    v_add_u32 v21, v8, v20
    ds_write_b64 v21, v[130:131]
    ds_write_b64 v21, v[132:133] offset:8192
    v_add_u32 v22, v10, v20
    ds_write_b64 v22, v[134:135]
    v_add_u32 v23, v9, v20
    ds_write_b64 v23, v[136:137]
    ds_write_b64 v23, v[138:139] offset:8256
    v_cvt_pk_bf16_f32 v232, v92, v93
    v_cvt_pk_bf16_f32 v233, v94, v95
    v_cvt_pk_bf16_f32 v234, v96, v97
    v_cvt_pk_bf16_f32 v235, v98, v99
    v_cvt_pk_bf16_f32 v236, v100, v101
    v_cvt_pk_bf16_f32 v237, v102, v103
    v_mov_b32 v21, 0x3f80
    v_cndmask_b32 v236, v236, v21, vcc
    v_cndmask_b32_e64 v237, v237, 0, vcc
    v_mov_b32 v238, 0
    v_mov_b32 v239, 0
    s_waitcnt lgkmcnt(0)
    s_barrier
    s_mov_b32 s28, 0x3ea52b5c
    s_mov_b32 s29, 0x3ea52b5c
    v_and_b32 v6, 31, v2
    v_lshrrev_b32 v7, 5, v2
    v_lshlrev_b32 v9, 3, v6
    v_lshl_add_u32 v9, v7, 12, v9
    v_add_u32 v9, 114176, v9
    s_lshl_b32 s19, s3, 8
    s_sub_u32 s20, 7, s3
    s_lshl_b32 s20, s20, 8
    v_add_u32 v16, s19, v9
    v_add_u32 v18, s20, v9
    v_accvgpr_write_b32 a38, 0
    v_accvgpr_write_b32 a39, 0
    v_accvgpr_write_b32 a46, 0
    v_accvgpr_write_b32 a47, 0
    v_accvgpr_write_b32 a54, 0
    v_accvgpr_write_b32 a55, 0
    v_bfe_u32 v10, v2, 4, 1
    v_lshlrev_b32 v10, 2, v10
    v_and_b32 v11, 3, v2
    v_add_u32 v10, v10, v11
    v_mul_u32_u24 v11, 4128, v10
    v_add_u32 v11, 138752, v11
    v_lshlrev_b32 v12, 5, v10
    v_add_u32 v12, 159488, v12
    v_cmp_gt_u32 vcc, 5, v10
    v_lshlrev_b32 v13, 2, v7
    v_sub_u32 v13, v6, v13
    v_cndmask_b32 v10, v12, v11, vcc
    v_bfe_u32 v11, v2, 2, 2
    v_lshl_add_u32 v11, v7, 2, v11
    v_lshl_add_u32 v10, v11, 3, v10
    v_add_u32 v17, s19, v10
    v_add_u32 v19, s20, v10
    v_mov_b32 v220, 0xc6ea6000
    s_cmp_eq_u32 s3, 1
    s_cbranch_scc1 AT_W1_54
    s_cmp_eq_u32 s3, 2
    s_cbranch_scc1 AT_W2_55
    s_cmp_eq_u32 s3, 3
    s_cbranch_scc1 AT_W3_56
    ds_read_b64 a[32:33], v18 offset:256
    ds_read_b64 a[34:35], v18 offset:8448
    ds_read_b64 a[36:37], v18 offset:16640
    ds_read_b64 a[40:41], v18 offset:512
    ds_read_b64 a[42:43], v18 offset:8704
    ds_read_b64 a[44:45], v18 offset:16896
    ds_read_b64 a[48:49], v18 offset:768
    ds_read_b64 a[50:51], v18 offset:8960
    ds_read_b64 a[52:53], v18 offset:17152
    s_waitcnt lgkmcnt(6)
    v_mfma_f32_32x32x16_bf16 v[92:107], a[32:35], v[232:235], 0
    v_cmp_gt_i32 vcc, 0, v13
    v_cmp_gt_i32 s[20:21], 1, v13
    v_cmp_gt_i32 s[22:23], 2, v13
    v_cndmask_b32_e64 v28, v220, 0, vcc
    v_cndmask_b32_e64 v44, 0, v220, vcc
    v_mfma_f32_32x32x16_bf16 v[92:107], a[36:39], v[236:239], v[92:107]
    v_cmp_gt_i32 vcc, 3, v13
    v_cndmask_b32_e64 v29, v220, 0, s[20:21]
    v_cndmask_b32_e64 v45, 0, v220, s[20:21]
    v_cmp_gt_i32 s[20:21], 8, v13
    v_cndmask_b32_e64 v30, v220, 0, s[22:23]
    v_cndmask_b32_e64 v46, 0, v220, s[22:23]
    ds_read_b64 a[32:33], v18 offset:1024
    ds_read_b64 a[34:35], v18 offset:9216
    ds_read_b64 a[36:37], v18 offset:17408
    s_waitcnt lgkmcnt(6)
    v_mfma_f32_32x32x16_bf16 v[108:123], a[40:43], v[232:235], 0
    v_cmp_gt_i32 s[22:23], 9, v13
    v_cndmask_b32_e64 v31, v220, 0, vcc
    v_cndmask_b32_e64 v47, 0, v220, vcc
    v_cmp_gt_i32 vcc, 10, v13
    v_cndmask_b32_e64 v32, v220, 0, s[20:21]
    v_mfma_f32_32x32x16_bf16 v[108:123], a[44:47], v[236:239], v[108:123]
    v_cndmask_b32_e64 v48, 0, v220, s[20:21]
    v_cmp_gt_i32 s[20:21], 11, v13
    v_cndmask_b32_e64 v33, v220, 0, s[22:23]
    v_cndmask_b32_e64 v49, 0, v220, s[22:23]
    v_cmp_gt_i32 s[22:23], 16, v13
    v_cndmask_b32_e64 v34, v220, 0, vcc
    ds_read_b64 a[40:41], v18 offset:1280
    ds_read_b64 a[42:43], v18 offset:9472
    ds_read_b64 a[44:45], v18 offset:17664
    s_waitcnt lgkmcnt(6)
    v_mfma_f32_32x32x16_bf16 v[124:139], a[48:51], v[232:235], 0
    v_cndmask_b32_e64 v50, 0, v220, vcc
    v_cmp_gt_i32 vcc, 17, v13
    v_cndmask_b32_e64 v35, v220, 0, s[20:21]
    v_cndmask_b32_e64 v51, 0, v220, s[20:21]
    v_cmp_gt_i32 s[20:21], 18, v13
    v_mfma_f32_32x32x16_bf16 v[124:139], a[52:55], v[236:239], v[124:139]
    v_cndmask_b32_e64 v36, v220, 0, s[22:23]
    v_cndmask_b32_e64 v52, 0, v220, s[22:23]
    v_cmp_gt_i32 s[22:23], 19, v13
    v_cndmask_b32_e64 v37, v220, 0, vcc
    v_cndmask_b32_e64 v53, 0, v220, vcc
    v_cmp_gt_i32 vcc, 24, v13
    ds_read_b64 a[48:49], v18 offset:1536
    ds_read_b64 a[50:51], v18 offset:9728
    ds_read_b64 a[52:53], v18 offset:17920
    s_waitcnt lgkmcnt(6)
    v_mfma_f32_32x32x16_bf16 v[140:155], a[32:35], v[232:235], 0
    v_cndmask_b32_e64 v38, v220, 0, s[20:21]
    v_cndmask_b32_e64 v54, 0, v220, s[20:21]
    v_cmp_gt_i32 s[20:21], 25, v13
    v_cndmask_b32_e64 v39, v220, 0, s[22:23]
    v_cndmask_b32_e64 v55, 0, v220, s[22:23]
    v_mfma_f32_32x32x16_bf16 v[140:155], a[36:39], v[236:239], v[140:155]
    v_cmp_gt_i32 s[22:23], 26, v13
    v_cndmask_b32_e64 v40, v220, 0, vcc
    v_cndmask_b32_e64 v56, 0, v220, vcc
    v_cmp_gt_i32 vcc, 27, v13
    v_cndmask_b32_e64 v41, v220, 0, s[20:21]
    v_cndmask_b32_e64 v57, 0, v220, s[20:21]
    ds_read_b64 a[32:33], v18 offset:1792
    ds_read_b64 a[34:35], v18 offset:9984
    ds_read_b64 a[36:37], v18 offset:18176
    s_waitcnt lgkmcnt(6)
    v_mfma_f32_32x32x16_bf16 v[156:171], a[40:43], v[232:235], 0
    v_cndmask_b32_e64 v42, v220, 0, s[22:23]
    v_cndmask_b32_e64 v58, 0, v220, s[22:23]
    v_cndmask_b32_e64 v43, v220, 0, vcc
    v_cndmask_b32_e64 v59, 0, v220, vcc
    v_max3_f32 v22, v92, v93, v94
    v_mfma_f32_32x32x16_bf16 v[156:171], a[44:47], v[236:239], v[156:171]
    v_max3_f32 v23, v95, v96, v97
    v_max3_f32 v22, v22, v98, v99
    v_max3_f32 v23, v23, v100, v101
    v_max3_f32 v22, v22, v102, v103
    v_max3_f32 v23, v23, v104, v105
    v_max3_f32 v22, v22, v106, v107
    ds_read_b64 a[40:41], v16 offset:2048
    ds_read_b64 a[42:43], v16 offset:10240
    ds_read_b64 a[44:45], v16 offset:18432
    s_waitcnt lgkmcnt(6)
    v_mfma_f32_32x32x16_bf16 v[172:187], a[48:51], v[232:235], 0
    v_max3_f32 v22, v22, v108, v109
    v_max3_f32 v23, v23, v110, v111
    v_max3_f32 v22, v22, v112, v113
    v_max3_f32 v23, v23, v114, v115
    v_max3_f32 v22, v22, v116, v117
    v_mfma_f32_32x32x16_bf16 v[172:187], a[52:55], v[236:239], v[172:187]
    v_max3_f32 v23, v23, v118, v119
    v_max3_f32 v22, v22, v120, v121
    v_max3_f32 v23, v23, v122, v123
    v_max3_f32 v22, v22, v124, v125
    v_max3_f32 v23, v23, v126, v127
    v_max3_f32 v22, v22, v128, v129
    ds_read_b64 a[48:49], v18 offset:2048
    ds_read_b64 a[50:51], v18 offset:10240
    ds_read_b64 a[52:53], v18 offset:18432
    s_waitcnt lgkmcnt(6)
    v_mfma_f32_32x32x16_bf16 v[188:203], a[32:35], v[232:235], 0
    v_max3_f32 v23, v23, v130, v131
    v_max3_f32 v22, v22, v132, v133
    v_max3_f32 v23, v23, v134, v135
    v_max3_f32 v22, v22, v136, v137
    v_max3_f32 v23, v23, v138, v139
    v_mfma_f32_32x32x16_bf16 v[188:203], a[36:39], v[236:239], v[188:203]
    v_max3_f32 v22, v22, v140, v141
    v_max3_f32 v23, v23, v142, v143
    v_max3_f32 v22, v22, v144, v145
    v_max3_f32 v23, v23, v146, v147
    v_max3_f32 v22, v22, v148, v149
    v_max3_f32 v23, v23, v150, v151
    s_waitcnt lgkmcnt(3)
    v_mfma_f32_32x32x16_bf16 v[76:91], a[40:43], v[224:227], v[44:59]
    v_max3_f32 v22, v22, v152, v153
    v_max3_f32 v23, v23, v154, v155
    v_max3_f32 v22, v22, v156, v157
    v_max3_f32 v23, v23, v158, v159
    v_max3_f32 v22, v22, v160, v161
    v_mfma_f32_32x32x16_bf16 v[76:91], a[44:47], v[228:231], v[76:91]
    v_max3_f32 v23, v23, v162, v163
    v_max3_f32 v22, v22, v164, v165
    v_max3_f32 v23, v23, v166, v167
    v_max3_f32 v22, v22, v168, v169
    v_max3_f32 v23, v23, v170, v171
    v_max3_f32 v22, v22, v172, v173
    s_waitcnt lgkmcnt(0)
    v_mfma_f32_32x32x16_bf16 v[204:219], a[48:51], v[232:235], v[44:59]
    v_max3_f32 v23, v23, v174, v175
    v_max3_f32 v22, v22, v176, v177
    v_max3_f32 v23, v23, v178, v179
    v_max3_f32 v22, v22, v180, v181
    v_max3_f32 v23, v23, v182, v183
    v_mfma_f32_32x32x16_bf16 v[204:219], a[52:55], v[236:239], v[204:219]
    v_max3_f32 v22, v22, v184, v185
    v_max3_f32 v23, v23, v186, v187
    v_max3_f32 v22, v22, v188, v189
    v_max3_f32 v23, v23, v190, v191
    v_max3_f32 v22, v22, v192, v193
    v_max3_f32 v23, v23, v194, v195
    ds_read_b64_tr_b16 a[56:57], v17 offset:2048
    ds_read_b64_tr_b16 a[58:59], v17 offset:2112
    ds_read_b64_tr_b16 a[60:61], v17 offset:2176
    ds_read_b64_tr_b16 a[62:63], v17 offset:2240
    v_max3_f32 v22, v22, v196, v197
    v_max3_f32 v23, v23, v198, v199
    v_max3_f32 v22, v22, v200, v201
    v_max3_f32 v23, v23, v202, v203
    v_max3_f32 v20, v76, v77, v78
    v_max3_f32 v21, v79, v80, v81
    v_max3_f32 v20, v20, v82, v83
    v_max3_f32 v21, v21, v84, v85
    v_max3_f32 v20, v20, v86, v87
    v_max3_f32 v21, v21, v88, v89
    v_max3_f32 v20, v20, v90, v91
    v_max3_f32 v22, v22, v204, v205
    v_max3_f32 v23, v23, v206, v207
    v_max3_f32 v22, v22, v208, v209
    v_max3_f32 v23, v23, v210, v211
    v_max3_f32 v22, v22, v212, v213
    v_max3_f32 v23, v23, v214, v215
    v_max3_f32 v22, v22, v216, v217
    v_max3_f32 v23, v23, v218, v219
    v_max_f32 v20, v20, v21
    v_mov_b32 v21, v20
    s_nop 1
    v_permlane32_swap_b32 v20, v21
    v_max_f32 v20, v20, v21
    v_mov_b32 v252, v20
    v_mul_f32 v24, 0xbea52b5c, v20
    v_mov_b32 v25, v24
    v_max_f32 v22, v22, v23
    v_mov_b32 v23, v22
    s_nop 1
    v_permlane32_swap_b32 v22, v23
    v_max_f32 v22, v22, v23
    v_mov_b32 v253, v22
    v_mul_f32 v26, 0xbea52b5c, v22
    v_mov_b32 v27, v26
    s_waitcnt vmcnt(0)
    s_barrier
    s_lshl_b32 s19, s12, 7
    s_add_u32 s19, s19, 526336
    s_lshl_b32 s20, s13, 2
    s_add_u32 s20, s20, s19
    v_mov_b32 v221, s20
    v_mov_b32 v222, 1
    s_mov_b64 exec, 1
    global_store_dword v221, v222, s[4:5] sc1
    s_mov_b64 exec, -1
    s_cmp_eq_u32 s12, 0
    s_cselect_b32 s21, 0, 128
    s_sub_u32 s20, s20, s21
    v_and_b32 v221, 31, v2
    v_lshlrev_b32 v221, 2, v221
    v_add_u32 v221, s19, v221
    v_mov_b32 v222, s20
    v_cmp_lt_u32 vcc, 31, v2
    s_nop 1
    v_cndmask_b32 v221, v221, v222, vcc
    ds_read_b64_tr_b16 a[64:65], v19 offset:256
    ds_read_b64_tr_b16 a[66:67], v19 offset:320
    ds_read_b64_tr_b16 a[68:69], v19 offset:384
    ds_read_b64_tr_b16 a[70:71], v19 offset:448
    v_pk_fma_f32 v[76:77], v[76:77], s[28:29], v[24:25]
    v_pk_fma_f32 v[78:79], v[78:79], s[28:29], v[24:25]
    v_pk_fma_f32 v[80:81], v[80:81], s[28:29], v[24:25]
    v_pk_fma_f32 v[82:83], v[82:83], s[28:29], v[24:25]
    v_pk_fma_f32 v[84:85], v[84:85], s[28:29], v[24:25]
    v_pk_fma_f32 v[86:87], v[86:87], s[28:29], v[24:25]
    v_pk_fma_f32 v[88:89], v[88:89], s[28:29], v[24:25]
    v_pk_fma_f32 v[90:91], v[90:91], s[28:29], v[24:25]
    v_exp_f32 v76, v76
    v_exp_f32 v77, v77
    v_exp_f32 v78, v78
    v_exp_f32 v79, v79
    v_exp_f32 v80, v80
    v_exp_f32 v81, v81
    v_exp_f32 v82, v82
    v_exp_f32 v83, v83
    v_exp_f32 v84, v84
    v_exp_f32 v85, v85
    v_exp_f32 v86, v86
    v_exp_f32 v87, v87
    v_exp_f32 v88, v88
    v_exp_f32 v89, v89
    v_exp_f32 v90, v90
    v_exp_f32 v91, v91
    v_cvt_pk_bf16_f32 v60, v76, v77
    v_cvt_pk_bf16_f32 v61, v78, v79
    v_cvt_pk_bf16_f32 v62, v80, v81
    v_cvt_pk_bf16_f32 v63, v82, v83
    v_cvt_pk_bf16_f32 v64, v84, v85
    v_cvt_pk_bf16_f32 v65, v86, v87
    v_cvt_pk_bf16_f32 v66, v88, v89
    v_cvt_pk_bf16_f32 v67, v90, v91
    s_lshl_b32 s19, s12, 3
    s_add_u32 s20, s19, s3
    s_sub_u32 s21, 7, s3
    s_add_u32 s21, s21, s19
    s_mul_i32 s20, s20, 40960
    s_mul_i32 s21, s21, 40960
    s_lshl_b32 s22, s13, 10
    s_add_u32 s22, s22, 1048576
    s_add_u32 s36, s20, s22
    s_add_u32 s37, s21, s22
    s_lshr_b32 s23, s13, 2
    s_add_u32 s23, s23, 32
    s_lshl_b32 s23, s23, 10
    s_bfe_u32 s22, s13, 0x10001
    s_lshl_b32 s22, s22, 9
    s_add_u32 s23, s23, s22
    s_and_b32 s22, s13, 1
    s_lshl_b32 s22, s22, 3
    s_add_u32 s23, s23, s22
    s_add_u32 s23, s23, 1048576
    s_add_u32 s38, s20, s23
    s_add_u32 s39, s21, s23
    s_lshr_b32 s26, s13, 2
    s_mul_i32 s26, s26, 102400
    s_mul_i32 s27, s3, 25600
    s_add_u32 s26, s26, s27
    s_add_u32 s26, s26, 41943040
    s_add_u32 s19, s12, 7
    s_and_b32 s19, s19, 7
    s_mul_i32 s19, s19, 786432
    s_add_u32 s19, s19, 8388608
    s_mul_i32 s20, s13, 24576
    s_mul_i32 s21, s3, 6144
    s_add_u32 s20, s20, s21
    s_add_u32 s20, s20, s19
    s_lshl_b32 s21, s13, 12
    s_lshl_b32 s22, s3, 10
    s_add_u32 s21, s21, s22
    s_add_u32 s21, s21, s19
    s_add_u32 s21, s21, 655360
    s_cmp_eq_u32 s12, 0
    s_cselect_b32 s16, s20, s21
    s_cselect_b32 s25, 48, 8
    s_lshl_b32 s22, s12, 15
    s_lshl_b32 s23, s13, 10
    s_add_u32 s22, s22, s23
    s_lshl_b32 s23, s3, 8
    s_add_u32 s22, s22, s23
    s_add_u32 s17, s22, 65536
    v_lshlrev_b32 v4, 7, v2
    s_mov_b32 s32, s40
    s_mov_b32 s33, s41
    s_mov_b32 s34, 2621440
    s_mov_b32 s35, 0x20000
    s_lshl_b32 s19, s12, 8
    s_and_b32 s20, s13, 3
    s_lshl_b32 s20, s20, 6
    s_add_u32 s19, s19, s20
    s_and_b32 s20, s3, 1
    s_lshl_b32 s20, s20, 5
    s_add_u32 s19, s19, s20
    v_and_b32 v8, 31, v2
    v_add_u32 v8, s19, v8
    v_mul_u32_u24 v8, 1280, v8
    v_lshrrev_b32 v14, 5, v2
    v_lshl_add_u32 v8, v14, 3, v8
    s_lshr_b32 s19, s13, 2
    s_mul_i32 s19, s19, 5
    s_lshr_b32 s20, s3, 1
    s_mul_i32 s20, s20, 3
    s_add_u32 s19, s19, s20
    s_lshl_b32 s43, s19, 5
    s_lshl_b32 s30, s12, 13
    s_add_u32 s30, s30, s43
    s_add_u32 s30, s30, 458752
    v_lshlrev_b32 v15, 4, v14
    ds_read_b64_tr_b16 a[72:73], v19 offset:512
    ds_read_b64_tr_b16 a[74:75], v19 offset:576
    ds_read_b64_tr_b16 a[76:77], v19 offset:640
    ds_read_b64_tr_b16 a[78:79], v19 offset:704
    v_pk_fma_f32 v[92:93], v[92:93], s[28:29], v[26:27]
    v_pk_fma_f32 v[94:95], v[94:95], s[28:29], v[26:27]
    v_pk_fma_f32 v[96:97], v[96:97], s[28:29], v[26:27]
    s_waitcnt lgkmcnt(8)
    v_mfma_f32_32x32x16_bf16 a[80:95], a[56:59], v[60:63], 0
    v_pk_fma_f32 v[98:99], v[98:99], s[28:29], v[26:27]
    v_pk_fma_f32 v[100:101], v[100:101], s[28:29], v[26:27]
    v_pk_fma_f32 v[102:103], v[102:103], s[28:29], v[26:27]
    v_pk_fma_f32 v[104:105], v[104:105], s[28:29], v[26:27]
    v_pk_fma_f32 v[106:107], v[106:107], s[28:29], v[26:27]
    v_exp_f32 v92, v92
    v_exp_f32 v93, v93
    v_exp_f32 v94, v94
    v_exp_f32 v95, v95
    v_exp_f32 v96, v96
    v_exp_f32 v97, v97
    v_exp_f32 v98, v98
    v_exp_f32 v99, v99
    v_exp_f32 v100, v100
    v_mfma_f32_32x32x16_bf16 a[80:95], a[60:63], v[64:67], a[80:95]
    v_exp_f32 v101, v101
    v_exp_f32 v102, v102
    v_exp_f32 v103, v103
    v_exp_f32 v104, v104
    v_exp_f32 v105, v105
    v_exp_f32 v106, v106
    v_exp_f32 v107, v107
    v_cvt_pk_bf16_f32 v68, v92, v93
    v_cvt_pk_bf16_f32 v69, v94, v95
    v_cvt_pk_bf16_f32 v70, v96, v97
    v_cvt_pk_bf16_f32 v71, v98, v99
    v_cvt_pk_bf16_f32 v72, v100, v101
    v_cvt_pk_bf16_f32 v73, v102, v103
    v_cvt_pk_bf16_f32 v74, v104, v105
    v_cvt_pk_bf16_f32 v75, v106, v107
    ds_read_b64_tr_b16 a[56:57], v19 offset:768
    ds_read_b64_tr_b16 a[58:59], v19 offset:832
    ds_read_b64_tr_b16 a[60:61], v19 offset:896
    ds_read_b64_tr_b16 a[62:63], v19 offset:960
    v_pk_fma_f32 v[108:109], v[108:109], s[28:29], v[26:27]
    v_pk_fma_f32 v[110:111], v[110:111], s[28:29], v[26:27]
    v_pk_fma_f32 v[112:113], v[112:113], s[28:29], v[26:27]
    s_waitcnt lgkmcnt(8)
    v_mfma_f32_32x32x16_bf16 a[96:111], a[64:67], v[68:71], 0
    v_pk_fma_f32 v[114:115], v[114:115], s[28:29], v[26:27]
    v_pk_fma_f32 v[116:117], v[116:117], s[28:29], v[26:27]
    v_pk_fma_f32 v[118:119], v[118:119], s[28:29], v[26:27]
    v_pk_fma_f32 v[120:121], v[120:121], s[28:29], v[26:27]
    v_pk_fma_f32 v[122:123], v[122:123], s[28:29], v[26:27]
    v_exp_f32 v108, v108
    v_exp_f32 v109, v109
    v_exp_f32 v110, v110
    v_exp_f32 v111, v111
    v_exp_f32 v112, v112
    v_exp_f32 v113, v113
    v_exp_f32 v114, v114
    v_exp_f32 v115, v115
    v_exp_f32 v116, v116
    v_mfma_f32_32x32x16_bf16 a[96:111], a[68:71], v[72:75], a[96:111]
    v_exp_f32 v117, v117
    v_exp_f32 v118, v118
    v_exp_f32 v119, v119
    v_exp_f32 v120, v120
    v_exp_f32 v121, v121
    v_exp_f32 v122, v122
    v_exp_f32 v123, v123
    v_cvt_pk_bf16_f32 v60, v108, v109
    v_cvt_pk_bf16_f32 v61, v110, v111
    v_cvt_pk_bf16_f32 v62, v112, v113
    v_cvt_pk_bf16_f32 v63, v114, v115
    v_cvt_pk_bf16_f32 v64, v116, v117
    v_cvt_pk_bf16_f32 v65, v118, v119
    v_cvt_pk_bf16_f32 v66, v120, v121
    v_cvt_pk_bf16_f32 v67, v122, v123
    ds_read_b64_tr_b16 a[64:65], v19 offset:1024
    ds_read_b64_tr_b16 a[66:67], v19 offset:1088
    ds_read_b64_tr_b16 a[68:69], v19 offset:1152
    ds_read_b64_tr_b16 a[70:71], v19 offset:1216
    v_pk_fma_f32 v[124:125], v[124:125], s[28:29], v[26:27]
    v_pk_fma_f32 v[126:127], v[126:127], s[28:29], v[26:27]
    v_pk_fma_f32 v[128:129], v[128:129], s[28:29], v[26:27]
    s_waitcnt lgkmcnt(8)
    v_mfma_f32_32x32x16_bf16 a[96:111], a[72:75], v[60:63], a[96:111]
    v_pk_fma_f32 v[130:131], v[130:131], s[28:29], v[26:27]
    v_pk_fma_f32 v[132:133], v[132:133], s[28:29], v[26:27]
    v_pk_fma_f32 v[134:135], v[134:135], s[28:29], v[26:27]
    v_pk_fma_f32 v[136:137], v[136:137], s[28:29], v[26:27]
    v_pk_fma_f32 v[138:139], v[138:139], s[28:29], v[26:27]
    v_exp_f32 v124, v124
    v_exp_f32 v125, v125
    v_exp_f32 v126, v126
    v_exp_f32 v127, v127
    v_exp_f32 v128, v128
    v_exp_f32 v129, v129
    v_exp_f32 v130, v130
    v_exp_f32 v131, v131
    v_exp_f32 v132, v132
    v_mfma_f32_32x32x16_bf16 a[96:111], a[76:79], v[64:67], a[96:111]
    v_exp_f32 v133, v133
    v_exp_f32 v134, v134
    v_exp_f32 v135, v135
    v_exp_f32 v136, v136
    v_exp_f32 v137, v137
    v_exp_f32 v138, v138
    v_exp_f32 v139, v139
    v_cvt_pk_bf16_f32 v68, v124, v125
    v_cvt_pk_bf16_f32 v69, v126, v127
    v_cvt_pk_bf16_f32 v70, v128, v129
    v_cvt_pk_bf16_f32 v71, v130, v131
    v_cvt_pk_bf16_f32 v72, v132, v133
    v_cvt_pk_bf16_f32 v73, v134, v135
    v_cvt_pk_bf16_f32 v74, v136, v137
    v_cvt_pk_bf16_f32 v75, v138, v139
    ds_read_b64_tr_b16 a[72:73], v19 offset:1280
    ds_read_b64_tr_b16 a[74:75], v19 offset:1344
    ds_read_b64_tr_b16 a[76:77], v19 offset:1408
    ds_read_b64_tr_b16 a[78:79], v19 offset:1472
    v_pk_fma_f32 v[140:141], v[140:141], s[28:29], v[26:27]
    v_pk_fma_f32 v[142:143], v[142:143], s[28:29], v[26:27]
    v_pk_fma_f32 v[144:145], v[144:145], s[28:29], v[26:27]
    s_waitcnt lgkmcnt(8)
    v_mfma_f32_32x32x16_bf16 a[96:111], a[56:59], v[68:71], a[96:111]
    v_pk_fma_f32 v[146:147], v[146:147], s[28:29], v[26:27]
    v_pk_fma_f32 v[148:149], v[148:149], s[28:29], v[26:27]
    v_pk_fma_f32 v[150:151], v[150:151], s[28:29], v[26:27]
    v_pk_fma_f32 v[152:153], v[152:153], s[28:29], v[26:27]
    v_pk_fma_f32 v[154:155], v[154:155], s[28:29], v[26:27]
    v_exp_f32 v140, v140
    v_exp_f32 v141, v141
    v_exp_f32 v142, v142
    v_exp_f32 v143, v143
    v_exp_f32 v144, v144
    v_exp_f32 v145, v145
    v_exp_f32 v146, v146
    v_exp_f32 v147, v147
    v_exp_f32 v148, v148
    v_mfma_f32_32x32x16_bf16 a[96:111], a[60:63], v[72:75], a[96:111]
    v_exp_f32 v149, v149
    v_exp_f32 v150, v150
    v_exp_f32 v151, v151
    v_exp_f32 v152, v152
    v_exp_f32 v153, v153
    v_exp_f32 v154, v154
    v_exp_f32 v155, v155
    v_cvt_pk_bf16_f32 v60, v140, v141
    v_cvt_pk_bf16_f32 v61, v142, v143
    v_cvt_pk_bf16_f32 v62, v144, v145
    v_cvt_pk_bf16_f32 v63, v146, v147
    v_cvt_pk_bf16_f32 v64, v148, v149
    v_cvt_pk_bf16_f32 v65, v150, v151
    v_cvt_pk_bf16_f32 v66, v152, v153
    v_cvt_pk_bf16_f32 v67, v154, v155
    global_load_dword v222, v221, s[4:5] sc1
    ds_read_b64_tr_b16 a[56:57], v19 offset:1536
    ds_read_b64_tr_b16 a[58:59], v19 offset:1600
    ds_read_b64_tr_b16 a[60:61], v19 offset:1664
    ds_read_b64_tr_b16 a[62:63], v19 offset:1728
    v_pk_fma_f32 v[156:157], v[156:157], s[28:29], v[26:27]
    v_pk_fma_f32 v[158:159], v[158:159], s[28:29], v[26:27]
    v_pk_fma_f32 v[160:161], v[160:161], s[28:29], v[26:27]
    s_waitcnt lgkmcnt(8)
    v_mfma_f32_32x32x16_bf16 a[96:111], a[64:67], v[60:63], a[96:111]
    v_pk_fma_f32 v[162:163], v[162:163], s[28:29], v[26:27]
    v_pk_fma_f32 v[164:165], v[164:165], s[28:29], v[26:27]
    v_pk_fma_f32 v[166:167], v[166:167], s[28:29], v[26:27]
    v_pk_fma_f32 v[168:169], v[168:169], s[28:29], v[26:27]
    v_pk_fma_f32 v[170:171], v[170:171], s[28:29], v[26:27]
    v_exp_f32 v156, v156
    v_exp_f32 v157, v157
    v_exp_f32 v158, v158
    v_exp_f32 v159, v159
    v_exp_f32 v160, v160
    v_exp_f32 v161, v161
    v_exp_f32 v162, v162
    v_exp_f32 v163, v163
    v_exp_f32 v164, v164
    v_mfma_f32_32x32x16_bf16 a[96:111], a[68:71], v[64:67], a[96:111]
    v_exp_f32 v165, v165
    v_exp_f32 v166, v166
    v_exp_f32 v167, v167
    v_exp_f32 v168, v168
    v_exp_f32 v169, v169
    v_exp_f32 v170, v170
    v_exp_f32 v171, v171
    v_cvt_pk_bf16_f32 v68, v156, v157
    v_cvt_pk_bf16_f32 v69, v158, v159
    v_cvt_pk_bf16_f32 v70, v160, v161
    v_cvt_pk_bf16_f32 v71, v162, v163
    v_cvt_pk_bf16_f32 v72, v164, v165
    v_cvt_pk_bf16_f32 v73, v166, v167
    v_cvt_pk_bf16_f32 v74, v168, v169
    v_cvt_pk_bf16_f32 v75, v170, v171
    s_mov_b32 s18, 2000000
    s_waitcnt vmcnt(0)
    v_cmp_eq_u32 vcc, 0, v222
    s_cbranch_vccz AT_PX_58
    global_load_dword v20, v221, s[4:5] sc1
    s_sleep 2
    global_load_dword v21, v221, s[4:5] sc1
    s_sleep 2
AT_P_57:
    global_load_dword v22, v221, s[4:5] sc1
    s_waitcnt vmcnt(2)
    v_cmp_eq_u32 vcc, 0, v20
    s_cbranch_vccz AT_PX_58
    global_load_dword v20, v221, s[4:5] sc1
    s_waitcnt vmcnt(2)
    v_cmp_eq_u32 vcc, 0, v21
    s_cbranch_vccz AT_PX_58
    global_load_dword v21, v221, s[4:5] sc1
    s_waitcnt vmcnt(2)
    v_cmp_eq_u32 vcc, 0, v22
    s_cbranch_vccz AT_PX_58
    s_sub_u32 s18, s18, 1
    s_cmp_lg_u32 s18, 0
    s_cbranch_scc1 AT_P_57
AT_PX_58:
    s_barrier
    s_cmp_eq_u32 s12, 0
    s_cbranch_scc1 AT_NH_59
    s_sub_u32 s22, s24, 786432
    s_mov_b32 m0, 114176
    s_nop 0
    buffer_load_dwordx4 v3, s[8:11], s22 offen sc1 lds
    s_mov_b32 m0, 115200
    s_add_u32 s22, s22, 1024
    buffer_load_dwordx4 v3, s[8:11], s22 offen sc1 lds
    s_mov_b32 m0, 118272
    s_add_u32 s22, s22, 1024
    buffer_load_dwordx4 v3, s[8:11], s22 offen sc1 lds
    s_mov_b32 m0, 119296
    s_add_u32 s22, s22, 1024
    buffer_load_dwordx4 v3, s[8:11], s22 offen sc1 lds
    s_mov_b32 m0, 122368
    s_add_u32 s22, s22, 1024
    buffer_load_dwordx4 v3, s[8:11], s22 offen sc1 lds
AT_NH_59:
    ds_read_b64_tr_b16 a[64:65], v19 offset:1792
    ds_read_b64_tr_b16 a[66:67], v19 offset:1856
    ds_read_b64_tr_b16 a[68:69], v19 offset:1920
    ds_read_b64_tr_b16 a[70:71], v19 offset:1984
    v_pk_fma_f32 v[172:173], v[172:173], s[28:29], v[26:27]
    v_pk_fma_f32 v[174:175], v[174:175], s[28:29], v[26:27]
    v_pk_fma_f32 v[176:177], v[176:177], s[28:29], v[26:27]
    s_waitcnt lgkmcnt(8)
    v_mfma_f32_32x32x16_bf16 a[96:111], a[72:75], v[68:71], a[96:111]
    v_pk_fma_f32 v[178:179], v[178:179], s[28:29], v[26:27]
    v_pk_fma_f32 v[180:181], v[180:181], s[28:29], v[26:27]
    v_pk_fma_f32 v[182:183], v[182:183], s[28:29], v[26:27]
    v_pk_fma_f32 v[184:185], v[184:185], s[28:29], v[26:27]
    v_pk_fma_f32 v[186:187], v[186:187], s[28:29], v[26:27]
    v_exp_f32 v172, v172
    v_exp_f32 v173, v173
    v_exp_f32 v174, v174
    v_exp_f32 v175, v175
    v_exp_f32 v176, v176
    v_exp_f32 v177, v177
    v_exp_f32 v178, v178
    v_exp_f32 v179, v179
    v_exp_f32 v180, v180
    v_mfma_f32_32x32x16_bf16 a[96:111], a[76:79], v[72:75], a[96:111]
    v_exp_f32 v181, v181
    v_exp_f32 v182, v182
    v_exp_f32 v183, v183
    v_exp_f32 v184, v184
    v_exp_f32 v185, v185
    v_exp_f32 v186, v186
    v_exp_f32 v187, v187
    v_cvt_pk_bf16_f32 v60, v172, v173
    v_cvt_pk_bf16_f32 v61, v174, v175
    v_cvt_pk_bf16_f32 v62, v176, v177
    v_cvt_pk_bf16_f32 v63, v178, v179
    v_cvt_pk_bf16_f32 v64, v180, v181
    v_cvt_pk_bf16_f32 v65, v182, v183
    v_cvt_pk_bf16_f32 v66, v184, v185
    v_cvt_pk_bf16_f32 v67, v186, v187
    ds_read_b64_tr_b16 a[72:73], v19 offset:2048
    ds_read_b64_tr_b16 a[74:75], v19 offset:2112
    ds_read_b64_tr_b16 a[76:77], v19 offset:2176
    ds_read_b64_tr_b16 a[78:79], v19 offset:2240
    v_pk_fma_f32 v[188:189], v[188:189], s[28:29], v[26:27]
    v_pk_fma_f32 v[190:191], v[190:191], s[28:29], v[26:27]
    v_pk_fma_f32 v[192:193], v[192:193], s[28:29], v[26:27]
    s_waitcnt lgkmcnt(8)
    v_mfma_f32_32x32x16_bf16 a[96:111], a[56:59], v[60:63], a[96:111]
    v_pk_fma_f32 v[194:195], v[194:195], s[28:29], v[26:27]
    v_pk_fma_f32 v[196:197], v[196:197], s[28:29], v[26:27]
    v_pk_fma_f32 v[198:199], v[198:199], s[28:29], v[26:27]
    v_pk_fma_f32 v[200:201], v[200:201], s[28:29], v[26:27]
    v_pk_fma_f32 v[202:203], v[202:203], s[28:29], v[26:27]
    v_exp_f32 v188, v188
    v_exp_f32 v189, v189
    v_exp_f32 v190, v190
    v_exp_f32 v191, v191
    v_exp_f32 v192, v192
    v_exp_f32 v193, v193
    v_exp_f32 v194, v194
    v_exp_f32 v195, v195
    v_exp_f32 v196, v196
    v_mfma_f32_32x32x16_bf16 a[96:111], a[60:63], v[64:67], a[96:111]
    v_exp_f32 v197, v197
    v_exp_f32 v198, v198
    v_exp_f32 v199, v199
    v_exp_f32 v200, v200
    v_exp_f32 v201, v201
    v_exp_f32 v202, v202
    v_exp_f32 v203, v203
    v_cvt_pk_bf16_f32 v68, v188, v189
    v_cvt_pk_bf16_f32 v69, v190, v191
    v_cvt_pk_bf16_f32 v70, v192, v193
    v_cvt_pk_bf16_f32 v71, v194, v195
    v_cvt_pk_bf16_f32 v72, v196, v197
    v_cvt_pk_bf16_f32 v73, v198, v199
    v_cvt_pk_bf16_f32 v74, v200, v201
    v_cvt_pk_bf16_f32 v75, v202, v203
    v_pk_fma_f32 v[204:205], v[204:205], s[28:29], v[26:27]
    v_pk_fma_f32 v[206:207], v[206:207], s[28:29], v[26:27]
    v_pk_fma_f32 v[208:209], v[208:209], s[28:29], v[26:27]
    s_waitcnt lgkmcnt(4)
    v_mfma_f32_32x32x16_bf16 a[96:111], a[64:67], v[68:71], a[96:111]
    v_pk_fma_f32 v[210:211], v[210:211], s[28:29], v[26:27]
    v_pk_fma_f32 v[212:213], v[212:213], s[28:29], v[26:27]
    v_pk_fma_f32 v[214:215], v[214:215], s[28:29], v[26:27]
    v_pk_fma_f32 v[216:217], v[216:217], s[28:29], v[26:27]
    v_pk_fma_f32 v[218:219], v[218:219], s[28:29], v[26:27]
    v_exp_f32 v204, v204
    v_exp_f32 v205, v205
    v_exp_f32 v206, v206
    v_exp_f32 v207, v207
    v_exp_f32 v208, v208
    v_exp_f32 v209, v209
    v_exp_f32 v210, v210
    v_exp_f32 v211, v211
    v_exp_f32 v212, v212
    v_mfma_f32_32x32x16_bf16 a[96:111], a[68:71], v[72:75], a[96:111]
    v_exp_f32 v213, v213
    v_exp_f32 v214, v214
    v_exp_f32 v215, v215
    v_exp_f32 v216, v216
    v_exp_f32 v217, v217
    v_exp_f32 v218, v218
    v_exp_f32 v219, v219
    v_cvt_pk_bf16_f32 v60, v204, v205
    v_cvt_pk_bf16_f32 v61, v206, v207
    v_cvt_pk_bf16_f32 v62, v208, v209
    v_cvt_pk_bf16_f32 v63, v210, v211
    v_cvt_pk_bf16_f32 v64, v212, v213
    v_cvt_pk_bf16_f32 v65, v214, v215
    v_cvt_pk_bf16_f32 v66, v216, v217
    v_cvt_pk_bf16_f32 v67, v218, v219
    s_waitcnt lgkmcnt(0)
    v_mfma_f32_32x32x16_bf16 a[96:111], a[72:75], v[60:63], a[96:111]
    v_mfma_f32_32x32x16_bf16 a[96:111], a[76:79], v[64:67], a[96:111]
    s_add_u32 m0, s27, 0
    s_nop 0
    buffer_load_dwordx4 v3, s[8:11], s26 offen offset:0 lds
    buffer_load_dwordx4 v3, s[8:11], s26 offen offset:1024 lds
    buffer_load_dwordx4 v3, s[8:11], s26 offen offset:2048 lds
    buffer_load_dwordx4 v3, s[8:11], s26 offen offset:3072 lds
    s_add_u32 m0, s27, 4096
    s_add_u32 s26, s26, 4096
    buffer_load_dwordx4 v3, s[8:11], s26 offen offset:0 lds
    buffer_load_dwordx4 v3, s[8:11], s26 offen offset:1024 lds
    buffer_load_dwordx4 v3, s[8:11], s26 offen offset:2048 lds
    buffer_load_dwordx4 v3, s[8:11], s26 offen offset:3072 lds
    s_add_u32 m0, s27, 8192
    s_add_u32 s26, s26, 4096
    buffer_load_dwordx4 v3, s[8:11], s26 offen offset:0 lds
    buffer_load_dwordx4 v3, s[8:11], s26 offen offset:1024 lds
    buffer_load_dwordx4 v3, s[8:11], s26 offen offset:2048 lds
    buffer_load_dwordx4 v3, s[8:11], s26 offen offset:3072 lds
    s_waitcnt vmcnt(12) lgkmcnt(0)
    s_barrier
    ds_read_b64 a[32:33], v16 offset:0
    ds_read_b64 a[34:35], v16 offset:8192
    ds_read_b64 a[36:37], v16 offset:16384
    ds_read_b64 a[40:41], v16 offset:256
    ds_read_b64 a[42:43], v16 offset:8448
    ds_read_b64 a[44:45], v16 offset:16640
    ds_read_b64 a[48:49], v16 offset:512
    ds_read_b64 a[50:51], v16 offset:8704
    ds_read_b64 a[52:53], v16 offset:16896
    s_waitcnt lgkmcnt(6)
    v_mfma_f32_32x32x16_bf16 v[76:91], a[32:35], v[224:227], v[28:43]
    v_mfma_f32_32x32x16_bf16 v[76:91], a[36:39], v[228:231], v[76:91]
    ds_read_b64 a[32:33], v16 offset:768
    ds_read_b64 a[34:35], v16 offset:8960
    ds_read_b64 a[36:37], v16 offset:17152
    s_waitcnt lgkmcnt(6)
    v_mfma_f32_32x32x16_bf16 v[92:107], a[40:43], v[224:227], 0
    v_mfma_f32_32x32x16_bf16 v[92:107], a[44:47], v[228:231], v[92:107]
    ds_read_b64 a[40:41], v16 offset:1024
    ds_read_b64 a[42:43], v16 offset:9216
    ds_read_b64 a[44:45], v16 offset:17408
    s_waitcnt lgkmcnt(6)
    v_mfma_f32_32x32x16_bf16 v[108:123], a[48:51], v[224:227], 0
    v_mfma_f32_32x32x16_bf16 v[108:123], a[52:55], v[228:231], v[108:123]
    v_max3_f32 v20, v76, v77, v78
    v_max3_f32 v21, v79, v80, v81
    v_max3_f32 v20, v20, v82, v83
    v_max3_f32 v21, v21, v84, v85
    v_max3_f32 v20, v20, v86, v87
    v_max3_f32 v21, v21, v88, v89
    ds_read_b64 a[48:49], v16 offset:1280
    s_add_u32 m0, s27, 12288
    s_add_u32 s26, s26, 4096
    buffer_load_dwordx4 v3, s[8:11], s26 offen offset:0 lds
    ds_read_b64 a[50:51], v16 offset:9472
    ds_read_b64 a[52:53], v16 offset:17664
    s_waitcnt lgkmcnt(6)
    v_mfma_f32_32x32x16_bf16 v[124:139], a[32:35], v[224:227], 0
    v_max3_f32 v20, v20, v90, v91
    v_mfma_f32_32x32x16_bf16 v[124:139], a[36:39], v[228:231], v[124:139]
    v_max3_f32 v20, v20, v92, v93
    s_add_u32 s31, s30, 2560
    buffer_load_dwordx4 a[156:159], v15, s[8:11], s31 offen offset:0 sc1
    v_max3_f32 v21, v21, v94, v95
    v_max3_f32 v20, v20, v96, v97
    v_max3_f32 v21, v21, v98, v99
    v_max3_f32 v20, v20, v100, v101
    v_max3_f32 v21, v21, v102, v103
    ds_read_b64 a[32:33], v16 offset:1536
    ds_read_b64 a[34:35], v16 offset:9728
    ds_read_b64 a[36:37], v16 offset:17920
    s_waitcnt lgkmcnt(6)
    v_mfma_f32_32x32x16_bf16 v[140:155], a[40:43], v[224:227], 0
    v_max3_f32 v20, v20, v104, v105
    v_max3_f32 v21, v21, v106, v107
    v_mfma_f32_32x32x16_bf16 v[140:155], a[44:47], v[228:231], v[140:155]
    v_max3_f32 v20, v20, v108, v109
    v_max3_f32 v21, v21, v110, v111
    v_max3_f32 v20, v20, v112, v113
    v_max3_f32 v21, v21, v114, v115
    v_max3_f32 v20, v20, v116, v117
    v_max3_f32 v21, v21, v118, v119
    ds_read_b64 a[40:41], v16 offset:1792
    ds_read_b64 a[42:43], v16 offset:9984
    ds_read_b64 a[44:45], v16 offset:18176
    s_waitcnt lgkmcnt(6)
    v_mfma_f32_32x32x16_bf16 v[156:171], a[48:51], v[224:227], 0
    s_add_u32 s31, s30, 2560
    buffer_load_dwordx4 a[160:163], v15, s[8:11], s31 offen offset:32 sc1
    v_max3_f32 v20, v20, v120, v121
    v_max3_f32 v21, v21, v122, v123
    v_mfma_f32_32x32x16_bf16 v[156:171], a[52:55], v[228:231], v[156:171]
    v_max3_f32 v20, v20, v124, v125
    v_max3_f32 v21, v21, v126, v127
    buffer_load_dwordx4 v3, s[8:11], s26 offen offset:1024 lds
    v_max3_f32 v20, v20, v128, v129
    v_max3_f32 v21, v21, v130, v131
    v_max3_f32 v20, v20, v132, v133
    v_max3_f32 v21, v21, v134, v135
    ds_read_b64 a[48:49], v18 offset:0
    ds_read_b64 a[50:51], v18 offset:8192
    ds_read_b64 a[52:53], v18 offset:16384
    s_waitcnt lgkmcnt(6)
    v_mfma_f32_32x32x16_bf16 v[172:187], a[32:35], v[224:227], 0
    v_max3_f32 v20, v20, v136, v137
    v_max3_f32 v21, v21, v138, v139
    v_mfma_f32_32x32x16_bf16 v[172:187], a[36:39], v[228:231], v[172:187]
    v_max3_f32 v20, v20, v140, v141
    v_max3_f32 v21, v21, v142, v143
    v_max3_f32 v20, v20, v144, v145
    v_max3_f32 v21, v21, v146, v147
    v_max3_f32 v20, v20, v148, v149
    v_max3_f32 v21, v21, v150, v151
    s_waitcnt lgkmcnt(3)
    v_mfma_f32_32x32x16_bf16 v[188:203], a[40:43], v[224:227], 0
    s_add_u32 s31, s30, 2560
    buffer_load_dwordx4 a[164:167], v15, s[8:11], s31 offen offset:64 sc1
    v_max3_f32 v20, v20, v152, v153
    v_max3_f32 v21, v21, v154, v155
    v_mfma_f32_32x32x16_bf16 v[188:203], a[44:47], v[228:231], v[188:203]
    v_max3_f32 v20, v20, v156, v157
    v_max3_f32 v21, v21, v158, v159
    v_max3_f32 v20, v20, v160, v161
    v_max3_f32 v21, v21, v162, v163
    v_max3_f32 v20, v20, v164, v165
    v_max3_f32 v21, v21, v166, v167
    s_waitcnt lgkmcnt(0)
    v_mfma_f32_32x32x16_bf16 v[204:219], a[48:51], v[232:235], v[28:43]
    v_max3_f32 v20, v20, v168, v169
    v_max3_f32 v21, v21, v170, v171
    v_mfma_f32_32x32x16_bf16 v[204:219], a[52:55], v[236:239], v[204:219]
    v_max3_f32 v20, v20, v172, v173
    v_max3_f32 v21, v21, v174, v175
    buffer_load_dwordx4 v3, s[8:11], s26 offen offset:2048 lds
    v_max3_f32 v20, v20, v176, v177
    v_max3_f32 v21, v21, v178, v179
    v_max3_f32 v20, v20, v180, v181
    v_max3_f32 v21, v21, v182, v183
    ds_read_b64_tr_b16 a[56:57], v17 offset:0
    ds_read_b64_tr_b16 a[58:59], v17 offset:64
    ds_read_b64_tr_b16 a[60:61], v17 offset:128
    ds_read_b64_tr_b16 a[62:63], v17 offset:192
    v_max3_f32 v20, v20, v184, v185
    s_add_u32 s31, s30, 5120
    buffer_load_dwordx4 a[168:171], v15, s[8:11], s31 offen offset:0 sc1
    v_max3_f32 v21, v21, v186, v187
    v_max3_f32 v20, v20, v188, v189
    v_max3_f32 v21, v21, v190, v191
    v_max3_f32 v20, v20, v192, v193
    v_max3_f32 v21, v21, v194, v195
    v_max3_f32 v20, v20, v196, v197
    v_max3_f32 v21, v21, v198, v199
    v_max3_f32 v20, v20, v200, v201
    v_max3_f32 v21, v21, v202, v203
    v_max3_f32 v22, v204, v205, v206
    v_max3_f32 v23, v207, v208, v209
    v_max3_f32 v22, v22, v210, v211
    v_max3_f32 v23, v23, v212, v213
    v_max3_f32 v22, v22, v214, v215
    v_max3_f32 v23, v23, v216, v217
    v_max3_f32 v22, v22, v218, v219
    v_max_f32 v20, v20, v21
    v_mov_b32 v21, v20
    s_nop 1
    v_permlane32_swap_b32 v20, v21
    v_max_f32 v20, v20, v21
    v_max_f32 v20, v20, v252
    v_sub_f32 v21, v252, v20
    v_mul_f32 v21, s28, v21
    v_exp_f32 v222, v21
    s_add_u32 s31, s30, 5120
    buffer_load_dwordx4 a[172:175], v15, s[8:11], s31 offen offset:32 sc1
    v_mul_f32 v24, 0xbea52b5c, v20
    v_mov_b32 v25, v24
    buffer_load_dwordx4 v3, s[8:11], s26 offen offset:3072 lds
    v_max_f32 v22, v22, v23
    v_mov_b32 v23, v22
    s_nop 1
    v_permlane32_swap_b32 v22, v23
    v_max_f32 v22, v22, v23
    v_max_f32 v22, v22, v253
    v_sub_f32 v23, v253, v22
    v_mul_f32 v23, s28, v23
    v_exp_f32 v223, v23
    v_mul_f32 v26, 0xbea52b5c, v22
    v_mov_b32 v27, v26
    ds_read_b64_tr_b16 a[64:65], v17 offset:256
    ds_read_b64_tr_b16 a[66:67], v17 offset:320
    ds_read_b64_tr_b16 a[68:69], v17 offset:384
    ds_read_b64_tr_b16 a[70:71], v17 offset:448
    v_pk_fma_f32 v[76:77], v[76:77], s[28:29], v[24:25]
    v_pk_fma_f32 v[78:79], v[78:79], s[28:29], v[24:25]
    v_pk_fma_f32 v[80:81], v[80:81], s[28:29], v[24:25]
    v_pk_fma_f32 v[82:83], v[82:83], s[28:29], v[24:25]
    v_pk_fma_f32 v[84:85], v[84:85], s[28:29], v[24:25]
    v_pk_fma_f32 v[86:87], v[86:87], s[28:29], v[24:25]
    v_pk_fma_f32 v[88:89], v[88:89], s[28:29], v[24:25]
    v_pk_fma_f32 v[90:91], v[90:91], s[28:29], v[24:25]
    v_exp_f32 v76, v76
    s_add_u32 s31, s30, 5120
    buffer_load_dwordx4 a[176:179], v15, s[8:11], s31 offen offset:64 sc1
    v_exp_f32 v77, v77
    v_exp_f32 v78, v78
    v_exp_f32 v79, v79
    v_exp_f32 v80, v80
    v_exp_f32 v81, v81
    v_exp_f32 v82, v82
    v_exp_f32 v83, v83
    v_exp_f32 v84, v84
    v_exp_f32 v85, v85
    v_exp_f32 v86, v86
    v_exp_f32 v87, v87
    v_exp_f32 v88, v88
    v_exp_f32 v89, v89
    s_add_u32 m0, s27, 16384
    s_add_u32 s26, s26, 4096
    buffer_load_dwordx4 v3, s[8:11], s26 offen offset:0 lds
    v_exp_f32 v90, v90
    v_exp_f32 v91, v91
    v_cvt_pk_bf16_f32 v60, v76, v77
    v_cvt_pk_bf16_f32 v61, v78, v79
    v_cvt_pk_bf16_f32 v62, v80, v81
    v_cvt_pk_bf16_f32 v63, v82, v83
    v_cvt_pk_bf16_f32 v64, v84, v85
    v_cvt_pk_bf16_f32 v65, v86, v87
    v_cvt_pk_bf16_f32 v66, v88, v89
    v_cvt_pk_bf16_f32 v67, v90, v91
    ds_read_b64_tr_b16 a[72:73], v17 offset:512
    ds_read_b64_tr_b16 a[74:75], v17 offset:576
    s_add_u32 s31, s30, 3840
    buffer_load_dwordx4 a[180:183], v15, s[8:11], s31 offen offset:0 sc1
    s_bfm_b64 exec, s25, 0
    buffer_load_dword v255, v4, s[8:11], s16 offen
    s_mov_b64 exec, 3
    buffer_load_dword v255, v4, s[8:11], s17 offen
    s_mov_b64 exec, -1
    ds_read_b64_tr_b16 a[76:77], v17 offset:640
    ds_read_b64_tr_b16 a[78:79], v17 offset:704
    v_pk_fma_f32 v[92:93], v[92:93], s[28:29], v[24:25]
    v_pk_fma_f32 v[94:95], v[94:95], s[28:29], v[24:25]
    v_pk_fma_f32 v[96:97], v[96:97], s[28:29], v[24:25]
    s_waitcnt lgkmcnt(8)
    v_mfma_f32_32x32x16_bf16 a[112:127], a[56:59], v[60:63], 0
    v_pk_fma_f32 v[98:99], v[98:99], s[28:29], v[24:25]
    v_pk_fma_f32 v[100:101], v[100:101], s[28:29], v[24:25]
    v_pk_fma_f32 v[102:103], v[102:103], s[28:29], v[24:25]
    v_pk_fma_f32 v[104:105], v[104:105], s[28:29], v[24:25]
    v_pk_fma_f32 v[106:107], v[106:107], s[28:29], v[24:25]
    v_exp_f32 v92, v92
    v_exp_f32 v93, v93
    v_exp_f32 v94, v94
    v_exp_f32 v95, v95
    v_exp_f32 v96, v96
    v_exp_f32 v97, v97
    v_exp_f32 v98, v98
    v_exp_f32 v99, v99
    v_exp_f32 v100, v100
    v_mfma_f32_32x32x16_bf16 a[112:127], a[60:63], v[64:67], a[112:127]
    v_exp_f32 v101, v101
    buffer_load_dwordx4 v3, s[8:11], s26 offen offset:1024 lds
    v_exp_f32 v102, v102
    s_add_u32 s31, s30, 3840
    buffer_load_dwordx4 a[184:187], v15, s[8:11], s31 offen offset:32 sc1
    v_exp_f32 v103, v103
    v_exp_f32 v104, v104
    v_exp_f32 v105, v105
    v_exp_f32 v106, v106
    v_exp_f32 v107, v107
    v_cvt_pk_bf16_f32 v68, v92, v93
    v_cvt_pk_bf16_f32 v69, v94, v95
    v_cvt_pk_bf16_f32 v70, v96, v97
    v_cvt_pk_bf16_f32 v71, v98, v99
    v_cvt_pk_bf16_f32 v72, v100, v101
    v_cvt_pk_bf16_f32 v73, v102, v103
    v_cvt_pk_bf16_f32 v74, v104, v105
    v_cvt_pk_bf16_f32 v75, v106, v107
    ds_read_b64_tr_b16 a[56:57], v17 offset:768
    ds_read_b64_tr_b16 a[58:59], v17 offset:832
    ds_read_b64_tr_b16 a[60:61], v17 offset:896
    ds_read_b64_tr_b16 a[62:63], v17 offset:960
    v_pk_fma_f32 v[108:109], v[108:109], s[28:29], v[24:25]
    v_pk_fma_f32 v[110:111], v[110:111], s[28:29], v[24:25]
    v_pk_fma_f32 v[112:113], v[112:113], s[28:29], v[24:25]
    s_waitcnt lgkmcnt(8)
    v_mfma_f32_32x32x16_bf16 a[112:127], a[64:67], v[68:71], a[112:127]
    v_pk_fma_f32 v[114:115], v[114:115], s[28:29], v[24:25]
    v_pk_fma_f32 v[116:117], v[116:117], s[28:29], v[24:25]
    v_pk_fma_f32 v[118:119], v[118:119], s[28:29], v[24:25]
    s_add_u32 s31, s30, 3840
    buffer_load_dwordx4 a[188:191], v15, s[8:11], s31 offen offset:64 sc1
    v_pk_fma_f32 v[120:121], v[120:121], s[28:29], v[24:25]
    v_pk_fma_f32 v[122:123], v[122:123], s[28:29], v[24:25]
    v_exp_f32 v108, v108
    v_exp_f32 v109, v109
    v_exp_f32 v110, v110
    v_exp_f32 v111, v111
    v_exp_f32 v112, v112
    v_exp_f32 v113, v113
    v_exp_f32 v114, v114
    v_exp_f32 v115, v115
    buffer_load_dwordx4 v3, s[8:11], s26 offen offset:2048 lds
    v_exp_f32 v116, v116
    v_mfma_f32_32x32x16_bf16 a[112:127], a[68:71], v[72:75], a[112:127]
    v_exp_f32 v117, v117
    v_exp_f32 v118, v118
    v_exp_f32 v119, v119
    v_exp_f32 v120, v120
    v_exp_f32 v121, v121
    v_exp_f32 v122, v122
    v_exp_f32 v123, v123
    v_cvt_pk_bf16_f32 v60, v108, v109
    v_cvt_pk_bf16_f32 v61, v110, v111
    v_cvt_pk_bf16_f32 v62, v112, v113
    v_cvt_pk_bf16_f32 v63, v114, v115
    v_cvt_pk_bf16_f32 v64, v116, v117
    v_cvt_pk_bf16_f32 v65, v118, v119
    buffer_load_dwordx2 a[144:145], v8, s[32:35], s43 offen offset:0
    v_cvt_pk_bf16_f32 v66, v120, v121
    v_cvt_pk_bf16_f32 v67, v122, v123
    ds_read_b64_tr_b16 a[64:65], v17 offset:1024
    ds_read_b64_tr_b16 a[66:67], v17 offset:1088
    ds_read_b64_tr_b16 a[68:69], v17 offset:1152
    ds_read_b64_tr_b16 a[70:71], v17 offset:1216
    v_pk_fma_f32 v[124:125], v[124:125], s[28:29], v[24:25]
    v_pk_fma_f32 v[126:127], v[126:127], s[28:29], v[24:25]
    v_pk_fma_f32 v[128:129], v[128:129], s[28:29], v[24:25]
    s_waitcnt lgkmcnt(8)
    v_mfma_f32_32x32x16_bf16 a[112:127], a[72:75], v[60:63], a[112:127]
    v_pk_fma_f32 v[130:131], v[130:131], s[28:29], v[24:25]
    v_pk_fma_f32 v[132:133], v[132:133], s[28:29], v[24:25]
    v_pk_fma_f32 v[134:135], v[134:135], s[28:29], v[24:25]
    v_pk_fma_f32 v[136:137], v[136:137], s[28:29], v[24:25]
    v_pk_fma_f32 v[138:139], v[138:139], s[28:29], v[24:25]
    v_exp_f32 v124, v124
    v_exp_f32 v125, v125
    v_exp_f32 v126, v126
    v_exp_f32 v127, v127
    v_exp_f32 v128, v128
    buffer_load_dwordx4 v3, s[8:11], s26 offen offset:3072 lds
    v_exp_f32 v129, v129
    v_exp_f32 v130, v130
    v_exp_f32 v131, v131
    buffer_load_dwordx2 a[146:147], v8, s[32:35], s43 offen offset:16
    v_exp_f32 v132, v132
    v_mfma_f32_32x32x16_bf16 a[112:127], a[76:79], v[64:67], a[112:127]
    v_exp_f32 v133, v133
    v_exp_f32 v134, v134
    v_exp_f32 v135, v135
    v_exp_f32 v136, v136
    v_exp_f32 v137, v137
    v_exp_f32 v138, v138
    v_exp_f32 v139, v139
    v_cvt_pk_bf16_f32 v68, v124, v125
    v_cvt_pk_bf16_f32 v69, v126, v127
    v_cvt_pk_bf16_f32 v70, v128, v129
    v_cvt_pk_bf16_f32 v71, v130, v131
    v_cvt_pk_bf16_f32 v72, v132, v133
    v_cvt_pk_bf16_f32 v73, v134, v135
    v_cvt_pk_bf16_f32 v74, v136, v137
    v_cvt_pk_bf16_f32 v75, v138, v139
    ds_read_b64_tr_b16 a[72:73], v17 offset:1280
    ds_read_b64_tr_b16 a[74:75], v17 offset:1344
    ds_read_b64_tr_b16 a[76:77], v17 offset:1408
    ds_read_b64_tr_b16 a[78:79], v17 offset:1472
    v_pk_fma_f32 v[140:141], v[140:141], s[28:29], v[24:25]
    v_pk_fma_f32 v[142:143], v[142:143], s[28:29], v[24:25]
    v_pk_fma_f32 v[144:145], v[144:145], s[28:29], v[24:25]
    s_waitcnt lgkmcnt(8)
    buffer_load_dwordx2 a[148:149], v8, s[32:35], s43 offen offset:32
    v_mfma_f32_32x32x16_bf16 a[112:127], a[56:59], v[68:71], a[112:127]
    v_pk_fma_f32 v[146:147], v[146:147], s[28:29], v[24:25]
    v_pk_fma_f32 v[148:149], v[148:149], s[28:29], v[24:25]
    v_pk_fma_f32 v[150:151], v[150:151], s[28:29], v[24:25]
    v_pk_fma_f32 v[152:153], v[152:153], s[28:29], v[24:25]
    v_pk_fma_f32 v[154:155], v[154:155], s[28:29], v[24:25]
    v_exp_f32 v140, v140
    s_add_u32 m0, s27, 20480
    s_add_u32 s26, s26, 4096
    buffer_load_dwordx4 v3, s[8:11], s26 offen offset:0 lds
    v_exp_f32 v141, v141
    v_exp_f32 v142, v142
    v_exp_f32 v143, v143
    v_exp_f32 v144, v144
    v_exp_f32 v145, v145
    v_exp_f32 v146, v146
    v_exp_f32 v147, v147
    v_exp_f32 v148, v148
    v_mfma_f32_32x32x16_bf16 a[112:127], a[60:63], v[72:75], a[112:127]
    v_exp_f32 v149, v149
    v_exp_f32 v150, v150
    v_exp_f32 v151, v151
    v_exp_f32 v152, v152
    v_exp_f32 v153, v153
    v_exp_f32 v154, v154
    v_exp_f32 v155, v155
    v_cvt_pk_bf16_f32 v60, v140, v141
    v_cvt_pk_bf16_f32 v61, v142, v143
    buffer_load_dwordx2 a[150:151], v8, s[32:35], s43 offen offset:48
    v_cvt_pk_bf16_f32 v62, v144, v145
    v_cvt_pk_bf16_f32 v63, v146, v147
    v_cvt_pk_bf16_f32 v64, v148, v149
    v_cvt_pk_bf16_f32 v65, v150, v151
    v_cvt_pk_bf16_f32 v66, v152, v153
    v_cvt_pk_bf16_f32 v67, v154, v155
    ds_read_b64_tr_b16 a[56:57], v17 offset:1536
    ds_read_b64_tr_b16 a[58:59], v17 offset:1600
    ds_read_b64_tr_b16 a[60:61], v17 offset:1664
    ds_read_b64_tr_b16 a[62:63], v17 offset:1728
    v_pk_fma_f32 v[156:157], v[156:157], s[28:29], v[24:25]
    v_pk_fma_f32 v[158:159], v[158:159], s[28:29], v[24:25]
    v_pk_fma_f32 v[160:161], v[160:161], s[28:29], v[24:25]
    s_waitcnt lgkmcnt(8)
    v_mfma_f32_32x32x16_bf16 a[112:127], a[64:67], v[60:63], a[112:127]
    v_pk_fma_f32 v[162:163], v[162:163], s[28:29], v[24:25]
    v_pk_fma_f32 v[164:165], v[164:165], s[28:29], v[24:25]
    v_pk_fma_f32 v[166:167], v[166:167], s[28:29], v[24:25]
    buffer_load_dwordx4 v3, s[8:11], s26 offen offset:1024 lds
    v_pk_fma_f32 v[168:169], v[168:169], s[28:29], v[24:25]
    v_pk_fma_f32 v[170:171], v[170:171], s[28:29], v[24:25]
    v_exp_f32 v156, v156
    v_exp_f32 v157, v157
    v_exp_f32 v158, v158
    v_exp_f32 v159, v159
    buffer_load_dwordx2 a[152:153], v8, s[32:35], s43 offen offset:64
    v_exp_f32 v160, v160
    v_exp_f32 v161, v161
    v_exp_f32 v162, v162
    v_exp_f32 v163, v163
    v_exp_f32 v164, v164
    v_mfma_f32_32x32x16_bf16 a[112:127], a[68:71], v[64:67], a[112:127]
    v_exp_f32 v165, v165
    v_exp_f32 v166, v166
    v_exp_f32 v167, v167
    v_exp_f32 v168, v168
    v_exp_f32 v169, v169
    v_exp_f32 v170, v170
    v_exp_f32 v171, v171
    v_cvt_pk_bf16_f32 v68, v156, v157
    v_cvt_pk_bf16_f32 v69, v158, v159
    v_cvt_pk_bf16_f32 v70, v160, v161
    v_cvt_pk_bf16_f32 v71, v162, v163
    v_cvt_pk_bf16_f32 v72, v164, v165
    v_cvt_pk_bf16_f32 v73, v166, v167
    v_cvt_pk_bf16_f32 v74, v168, v169
    v_cvt_pk_bf16_f32 v75, v170, v171
    ds_read_b64_tr_b16 a[64:65], v17 offset:1792
    ds_read_b64_tr_b16 a[66:67], v17 offset:1856
    ds_read_b64_tr_b16 a[68:69], v17 offset:1920
    ds_read_b64_tr_b16 a[70:71], v17 offset:1984
    buffer_load_dwordx2 a[154:155], v8, s[32:35], s43 offen offset:80
    v_pk_fma_f32 v[172:173], v[172:173], s[28:29], v[24:25]
    v_pk_fma_f32 v[174:175], v[174:175], s[28:29], v[24:25]
    v_pk_fma_f32 v[176:177], v[176:177], s[28:29], v[24:25]
    s_waitcnt lgkmcnt(8)
    buffer_load_dwordx4 v3, s[8:11], s26 offen offset:2048 lds
    v_mfma_f32_32x32x16_bf16 a[112:127], a[72:75], v[68:71], a[112:127]
    v_pk_fma_f32 v[178:179], v[178:179], s[28:29], v[24:25]
    v_pk_fma_f32 v[180:181], v[180:181], s[28:29], v[24:25]
    v_pk_fma_f32 v[182:183], v[182:183], s[28:29], v[24:25]
    v_pk_fma_f32 v[184:185], v[184:185], s[28:29], v[24:25]
    v_pk_fma_f32 v[186:187], v[186:187], s[28:29], v[24:25]
    v_exp_f32 v172, v172
    v_exp_f32 v173, v173
    v_exp_f32 v174, v174
    v_exp_f32 v175, v175
    v_exp_f32 v176, v176
    v_exp_f32 v177, v177
    v_exp_f32 v178, v178
    v_exp_f32 v179, v179
    v_exp_f32 v180, v180
    v_mfma_f32_32x32x16_bf16 a[112:127], a[76:79], v[72:75], a[112:127]
    v_exp_f32 v181, v181
    v_exp_f32 v182, v182
    v_exp_f32 v183, v183
    v_exp_f32 v184, v184
    v_exp_f32 v185, v185
    v_exp_f32 v186, v186
    v_exp_f32 v187, v187
    v_cvt_pk_bf16_f32 v60, v172, v173
    v_cvt_pk_bf16_f32 v61, v174, v175
    v_cvt_pk_bf16_f32 v62, v176, v177
    v_cvt_pk_bf16_f32 v63, v178, v179
    v_cvt_pk_bf16_f32 v64, v180, v181
    v_cvt_pk_bf16_f32 v65, v182, v183
    v_cvt_pk_bf16_f32 v66, v184, v185
    v_cvt_pk_bf16_f32 v67, v186, v187
    ds_read_b64_tr_b16 a[72:73], v19 offset:0
    ds_read_b64_tr_b16 a[74:75], v19 offset:64
    ds_read_b64_tr_b16 a[76:77], v19 offset:128
    ds_read_b64_tr_b16 a[78:79], v19 offset:192
    v_pk_fma_f32 v[188:189], v[188:189], s[28:29], v[24:25]
    buffer_load_dwordx4 v3, s[8:11], s26 offen offset:3072 lds
    v_pk_fma_f32 v[190:191], v[190:191], s[28:29], v[24:25]
    v_pk_fma_f32 v[192:193], v[192:193], s[28:29], v[24:25]
    s_waitcnt lgkmcnt(8)
    v_mfma_f32_32x32x16_bf16 a[112:127], a[56:59], v[60:63], a[112:127]
    v_pk_fma_f32 v[194:195], v[194:195], s[28:29], v[24:25]
    v_pk_fma_f32 v[196:197], v[196:197], s[28:29], v[24:25]
    v_pk_fma_f32 v[198:199], v[198:199], s[28:29], v[24:25]
    v_pk_fma_f32 v[200:201], v[200:201], s[28:29], v[24:25]
    v_pk_fma_f32 v[202:203], v[202:203], s[28:29], v[24:25]
    v_exp_f32 v188, v188
    v_exp_f32 v189, v189
    v_exp_f32 v190, v190
    v_exp_f32 v191, v191
    v_exp_f32 v192, v192
    v_exp_f32 v193, v193
    v_exp_f32 v194, v194
    v_exp_f32 v195, v195
    v_exp_f32 v196, v196
    v_mfma_f32_32x32x16_bf16 a[112:127], a[60:63], v[64:67], a[112:127]
    v_exp_f32 v197, v197
    v_exp_f32 v198, v198
    v_exp_f32 v199, v199
    v_exp_f32 v200, v200
    v_exp_f32 v201, v201
    v_exp_f32 v202, v202
    v_exp_f32 v203, v203
    v_cvt_pk_bf16_f32 v68, v188, v189
    v_cvt_pk_bf16_f32 v69, v190, v191
    v_cvt_pk_bf16_f32 v70, v192, v193
    v_cvt_pk_bf16_f32 v71, v194, v195
    v_cvt_pk_bf16_f32 v72, v196, v197
    v_cvt_pk_bf16_f32 v73, v198, v199
    v_cvt_pk_bf16_f32 v74, v200, v201
    v_cvt_pk_bf16_f32 v75, v202, v203
    v_pk_fma_f32 v[204:205], v[204:205], s[28:29], v[26:27]
    v_pk_fma_f32 v[206:207], v[206:207], s[28:29], v[26:27]
    s_add_u32 m0, s27, 24576
    s_add_u32 s26, s26, 4096
    buffer_load_dwordx4 v3, s[8:11], s26 offen offset:0 lds
    v_pk_fma_f32 v[208:209], v[208:209], s[28:29], v[26:27]
    s_waitcnt lgkmcnt(4)
    v_mfma_f32_32x32x16_bf16 a[112:127], a[64:67], v[68:71], a[112:127]
    v_pk_fma_f32 v[210:211], v[210:211], s[28:29], v[26:27]
    v_pk_fma_f32 v[212:213], v[212:213], s[28:29], v[26:27]
    v_pk_fma_f32 v[214:215], v[214:215], s[28:29], v[26:27]
    v_pk_fma_f32 v[216:217], v[216:217], s[28:29], v[26:27]
    v_pk_fma_f32 v[218:219], v[218:219], s[28:29], v[26:27]
    v_exp_f32 v204, v204
    v_exp_f32 v205, v205
    v_exp_f32 v206, v206
    v_exp_f32 v207, v207
    v_exp_f32 v208, v208
    v_exp_f32 v209, v209
    v_exp_f32 v210, v210
    v_exp_f32 v211, v211
    v_exp_f32 v212, v212
    v_mfma_f32_32x32x16_bf16 a[112:127], a[68:71], v[72:75], a[112:127]
    v_exp_f32 v213, v213
    v_exp_f32 v214, v214
    v_exp_f32 v215, v215
    v_exp_f32 v216, v216
    v_exp_f32 v217, v217
    v_exp_f32 v218, v218
    v_exp_f32 v219, v219
    v_cvt_pk_bf16_f32 v60, v204, v205
    v_cvt_pk_bf16_f32 v61, v206, v207
    v_cvt_pk_bf16_f32 v62, v208, v209
    v_cvt_pk_bf16_f32 v63, v210, v211
    v_cvt_pk_bf16_f32 v64, v212, v213
    v_cvt_pk_bf16_f32 v65, v214, v215
    v_cvt_pk_bf16_f32 v66, v216, v217
    v_cvt_pk_bf16_f32 v67, v218, v219
    s_waitcnt lgkmcnt(0)
    v_mfma_f32_32x32x16_bf16 a[128:143], a[72:75], v[60:63], 0
    v_mfma_f32_32x32x16_bf16 a[128:143], a[76:79], v[64:67], a[128:143]
    v_accvgpr_read_b32 v20, a88
    v_accvgpr_read_b32 v21, a120
    v_fma_f32 v20, v20, v222, v21
    v_mov_b32 v21, v20
    s_nop 1
    v_permlane32_swap_b32 v20, v21
    v_rcp_f32 v21, v21
    s_nop 0
    v_mul_f32 v222, v222, v21
    v_accvgpr_read_b32 v22, a112
    v_accvgpr_read_b32 v23, a113
    v_accvgpr_read_b32 v9, a80
    v_accvgpr_read_b32 v10, a81
    v_mul_f32 v22, v22, v21
    v_mul_f32 v23, v23, v21
    v_fma_f32 v22, v9, v222, v22
    v_fma_f32 v23, v10, v222, v23
    v_cvt_pk_bf16_f32 v240, v22, v23
    v_accvgpr_read_b32 v22, a114
    v_accvgpr_read_b32 v23, a115
    v_accvgpr_read_b32 v9, a82
    v_accvgpr_read_b32 v10, a83
    v_mul_f32 v22, v22, v21
    v_mul_f32 v23, v23, v21
    v_fma_f32 v22, v9, v222, v22
    v_fma_f32 v23, v10, v222, v23
    v_cvt_pk_bf16_f32 v241, v22, v23
    v_accvgpr_read_b32 v22, a116
    v_accvgpr_read_b32 v23, a117
    v_accvgpr_read_b32 v9, a84
    v_accvgpr_read_b32 v10, a85
    v_mul_f32 v22, v22, v21
    v_mul_f32 v23, v23, v21
    v_fma_f32 v22, v9, v222, v22
    v_fma_f32 v23, v10, v222, v23
    v_cvt_pk_bf16_f32 v242, v22, v23
    v_accvgpr_read_b32 v22, a118
    v_accvgpr_read_b32 v23, a119
    v_accvgpr_read_b32 v9, a86
    v_accvgpr_read_b32 v10, a87
    v_mul_f32 v22, v22, v21
    v_mul_f32 v23, v23, v21
    v_fma_f32 v22, v9, v222, v22
    v_fma_f32 v23, v10, v222, v23
    v_cvt_pk_bf16_f32 v243, v22, v23
    v_accvgpr_read_b32 v22, a120
    v_accvgpr_read_b32 v23, a121
    v_accvgpr_read_b32 v9, a88
    v_accvgpr_read_b32 v10, a89
    v_mul_f32 v22, v22, v21
    v_mul_f32 v23, v23, v21
    v_fma_f32 v22, v9, v222, v22
    v_fma_f32 v23, v10, v222, v23
    v_cvt_pk_bf16_f32 v244, v22, v23
    v_accvgpr_read_b32 v22, a122
    v_accvgpr_read_b32 v23, a123
    v_accvgpr_read_b32 v9, a90
    v_accvgpr_read_b32 v10, a91
    v_mul_f32 v22, v22, v21
    v_mul_f32 v23, v23, v21
    v_fma_f32 v22, v9, v222, v22
    v_fma_f32 v23, v10, v222, v23
    v_cvt_pk_bf16_f32 v245, v22, v23
    v_accvgpr_read_b32 v20, a104
    v_accvgpr_read_b32 v21, a136
    v_fma_f32 v20, v20, v223, v21
    v_mov_b32 v21, v20
    s_nop 1
    v_permlane32_swap_b32 v20, v21
    v_rcp_f32 v21, v21
    s_nop 0
    v_mul_f32 v223, v223, v21
    v_accvgpr_read_b32 v22, a128
    v_accvgpr_read_b32 v23, a129
    v_accvgpr_read_b32 v9, a96
    v_accvgpr_read_b32 v10, a97
    v_mul_f32 v22, v22, v21
    v_mul_f32 v23, v23, v21
    v_fma_f32 v22, v9, v223, v22
    v_fma_f32 v23, v10, v223, v23
    v_cvt_pk_bf16_f32 v246, v22, v23
    v_accvgpr_read_b32 v22, a130
    v_accvgpr_read_b32 v23, a131
    v_accvgpr_read_b32 v9, a98
    v_accvgpr_read_b32 v10, a99
    v_mul_f32 v22, v22, v21
    v_mul_f32 v23, v23, v21
    v_fma_f32 v22, v9, v223, v22
    v_fma_f32 v23, v10, v223, v23
    v_cvt_pk_bf16_f32 v247, v22, v23
    v_accvgpr_read_b32 v22, a132
    v_accvgpr_read_b32 v23, a133
    v_accvgpr_read_b32 v9, a100
    v_accvgpr_read_b32 v10, a101
    v_mul_f32 v22, v22, v21
    v_mul_f32 v23, v23, v21
    v_fma_f32 v22, v9, v223, v22
    v_fma_f32 v23, v10, v223, v23
    v_cvt_pk_bf16_f32 v248, v22, v23
    v_accvgpr_read_b32 v22, a134
    v_accvgpr_read_b32 v23, a135
    v_accvgpr_read_b32 v9, a102
    v_accvgpr_read_b32 v10, a103
    v_mul_f32 v22, v22, v21
    v_mul_f32 v23, v23, v21
    v_fma_f32 v22, v9, v223, v22
    v_fma_f32 v23, v10, v223, v23
    v_cvt_pk_bf16_f32 v249, v22, v23
    v_accvgpr_read_b32 v22, a136
    v_accvgpr_read_b32 v23, a137
    v_accvgpr_read_b32 v9, a104
    v_accvgpr_read_b32 v10, a105
    v_mul_f32 v22, v22, v21
    v_mul_f32 v23, v23, v21
    v_fma_f32 v22, v9, v223, v22
    v_fma_f32 v23, v10, v223, v23
    v_cvt_pk_bf16_f32 v250, v22, v23
    v_accvgpr_read_b32 v22, a138
    v_accvgpr_read_b32 v23, a139
    v_accvgpr_read_b32 v9, a106
    v_accvgpr_read_b32 v10, a107
    v_mul_f32 v22, v22, v21
    v_mul_f32 v23, v23, v21
    v_fma_f32 v22, v9, v223, v22
    v_fma_f32 v23, v10, v223, v23
    v_cvt_pk_bf16_f32 v251, v22, v23
    s_branch AT_END_52
AT_W1_54:
    ds_read_b64 a[32:33], v16 offset:1792
    ds_read_b64 a[34:35], v16 offset:9984
    ds_read_b64 a[36:37], v16 offset:18176
    ds_read_b64 a[40:41], v18 offset:512
    ds_read_b64 a[42:43], v18 offset:8704
    ds_read_b64 a[44:45], v18 offset:16896
    ds_read_b64 a[48:49], v18 offset:768
    ds_read_b64 a[50:51], v18 offset:8960
    ds_read_b64 a[52:53], v18 offset:17152
    s_waitcnt lgkmcnt(6)
    v_mfma_f32_32x32x16_bf16 v[76:91], a[32:35], v[224:227], 0
    v_cmp_gt_i32 vcc, 0, v13
    v_cmp_gt_i32 s[20:21], 1, v13
    v_cmp_gt_i32 s[22:23], 2, v13
    v_cndmask_b32_e64 v28, v220, 0, vcc
    v_cndmask_b32_e64 v44, 0, v220, vcc
    v_mfma_f32_32x32x16_bf16 v[76:91], a[36:39], v[228:231], v[76:91]
    v_cmp_gt_i32 vcc, 3, v13
    v_cndmask_b32_e64 v29, v220, 0, s[20:21]
    v_cndmask_b32_e64 v45, 0, v220, s[20:21]
    v_cmp_gt_i32 s[20:21], 8, v13
    v_cndmask_b32_e64 v30, v220, 0, s[22:23]
    v_cndmask_b32_e64 v46, 0, v220, s[22:23]
    ds_read_b64 a[32:33], v18 offset:1024
    ds_read_b64 a[34:35], v18 offset:9216
    ds_read_b64 a[36:37], v18 offset:17408
    s_waitcnt lgkmcnt(6)
    v_mfma_f32_32x32x16_bf16 v[108:123], a[40:43], v[232:235], 0
    v_cmp_gt_i32 s[22:23], 9, v13
    v_cndmask_b32_e64 v31, v220, 0, vcc
    v_cndmask_b32_e64 v47, 0, v220, vcc
    v_cmp_gt_i32 vcc, 10, v13
    v_cndmask_b32_e64 v32, v220, 0, s[20:21]
    v_mfma_f32_32x32x16_bf16 v[108:123], a[44:47], v[236:239], v[108:123]
    v_cndmask_b32_e64 v48, 0, v220, s[20:21]
    v_cmp_gt_i32 s[20:21], 11, v13
    v_cndmask_b32_e64 v33, v220, 0, s[22:23]
    v_cndmask_b32_e64 v49, 0, v220, s[22:23]
    v_cmp_gt_i32 s[22:23], 16, v13
    v_cndmask_b32_e64 v34, v220, 0, vcc
    ds_read_b64 a[40:41], v18 offset:1280
    ds_read_b64 a[42:43], v18 offset:9472
    ds_read_b64 a[44:45], v18 offset:17664
    s_waitcnt lgkmcnt(6)
    v_mfma_f32_32x32x16_bf16 v[124:139], a[48:51], v[232:235], 0
    v_cndmask_b32_e64 v50, 0, v220, vcc
    v_cmp_gt_i32 vcc, 17, v13
    v_cndmask_b32_e64 v35, v220, 0, s[20:21]
    v_cndmask_b32_e64 v51, 0, v220, s[20:21]
    v_cmp_gt_i32 s[20:21], 18, v13
    v_mfma_f32_32x32x16_bf16 v[124:139], a[52:55], v[236:239], v[124:139]
    v_cndmask_b32_e64 v36, v220, 0, s[22:23]
    v_cndmask_b32_e64 v52, 0, v220, s[22:23]
    v_cmp_gt_i32 s[22:23], 19, v13
    v_cndmask_b32_e64 v37, v220, 0, vcc
    v_cndmask_b32_e64 v53, 0, v220, vcc
    v_cmp_gt_i32 vcc, 24, v13
    ds_read_b64 a[48:49], v18 offset:1536
    ds_read_b64 a[50:51], v18 offset:9728
    ds_read_b64 a[52:53], v18 offset:17920
    s_waitcnt lgkmcnt(6)
    v_mfma_f32_32x32x16_bf16 v[140:155], a[32:35], v[232:235], 0
    v_cndmask_b32_e64 v38, v220, 0, s[20:21]
    v_cndmask_b32_e64 v54, 0, v220, s[20:21]
    v_cmp_gt_i32 s[20:21], 25, v13
    v_cndmask_b32_e64 v39, v220, 0, s[22:23]
    v_cndmask_b32_e64 v55, 0, v220, s[22:23]
    v_mfma_f32_32x32x16_bf16 v[140:155], a[36:39], v[236:239], v[140:155]
    v_cmp_gt_i32 s[22:23], 26, v13
    v_cndmask_b32_e64 v40, v220, 0, vcc
    v_cndmask_b32_e64 v56, 0, v220, vcc
    v_cmp_gt_i32 vcc, 27, v13
    v_cndmask_b32_e64 v41, v220, 0, s[20:21]
    v_cndmask_b32_e64 v57, 0, v220, s[20:21]
    ds_read_b64 a[32:33], v18 offset:1792
    ds_read_b64 a[34:35], v18 offset:9984
    ds_read_b64 a[36:37], v18 offset:18176
    s_waitcnt lgkmcnt(6)
    v_mfma_f32_32x32x16_bf16 v[156:171], a[40:43], v[232:235], 0
    v_cndmask_b32_e64 v42, v220, 0, s[22:23]
    v_cndmask_b32_e64 v58, 0, v220, s[22:23]
    v_cndmask_b32_e64 v43, v220, 0, vcc
    v_cndmask_b32_e64 v59, 0, v220, vcc
    v_max3_f32 v20, v76, v77, v78
    v_mfma_f32_32x32x16_bf16 v[156:171], a[44:47], v[236:239], v[156:171]
    v_max3_f32 v21, v79, v80, v81
    v_max3_f32 v20, v20, v82, v83
    v_max3_f32 v21, v21, v84, v85
    v_max3_f32 v20, v20, v86, v87
    v_max3_f32 v21, v21, v88, v89
    v_max3_f32 v20, v20, v90, v91
    ds_read_b64 a[40:41], v16 offset:2048
    ds_read_b64 a[42:43], v16 offset:10240
    ds_read_b64 a[44:45], v16 offset:18432
    s_waitcnt lgkmcnt(6)
    v_mfma_f32_32x32x16_bf16 v[172:187], a[48:51], v[232:235], 0
    v_max3_f32 v22, v108, v109, v110
    v_max3_f32 v23, v111, v112, v113
    v_max3_f32 v22, v22, v114, v115
    v_max3_f32 v23, v23, v116, v117
    v_max3_f32 v22, v22, v118, v119
    v_mfma_f32_32x32x16_bf16 v[172:187], a[52:55], v[236:239], v[172:187]
    v_max3_f32 v23, v23, v120, v121
    v_max3_f32 v22, v22, v122, v123
    v_max3_f32 v22, v22, v124, v125
    v_max3_f32 v23, v23, v126, v127
    v_max3_f32 v22, v22, v128, v129
    v_max3_f32 v23, v23, v130, v131
    ds_read_b64 a[48:49], v18 offset:2048
    ds_read_b64 a[50:51], v18 offset:10240
    ds_read_b64 a[52:53], v18 offset:18432
    s_waitcnt lgkmcnt(6)
    v_mfma_f32_32x32x16_bf16 v[188:203], a[32:35], v[232:235], 0
    v_max3_f32 v22, v22, v132, v133
    v_max3_f32 v23, v23, v134, v135
    v_max3_f32 v22, v22, v136, v137
    v_max3_f32 v23, v23, v138, v139
    v_max3_f32 v22, v22, v140, v141
    v_mfma_f32_32x32x16_bf16 v[188:203], a[36:39], v[236:239], v[188:203]
    v_max3_f32 v23, v23, v142, v143
    v_max3_f32 v22, v22, v144, v145
    v_max3_f32 v23, v23, v146, v147
    v_max3_f32 v22, v22, v148, v149
    v_max3_f32 v23, v23, v150, v151
    v_max3_f32 v22, v22, v152, v153
    s_waitcnt lgkmcnt(3)
    v_mfma_f32_32x32x16_bf16 v[92:107], a[40:43], v[224:227], v[44:59]
    v_max3_f32 v23, v23, v154, v155
    v_max3_f32 v22, v22, v156, v157
    v_max3_f32 v23, v23, v158, v159
    v_max3_f32 v22, v22, v160, v161
    v_max3_f32 v23, v23, v162, v163
    v_mfma_f32_32x32x16_bf16 v[92:107], a[44:47], v[228:231], v[92:107]
    v_max3_f32 v22, v22, v164, v165
    v_max3_f32 v23, v23, v166, v167
    v_max3_f32 v22, v22, v168, v169
    v_max3_f32 v23, v23, v170, v171
    v_max3_f32 v22, v22, v172, v173
    v_max3_f32 v23, v23, v174, v175
    s_waitcnt lgkmcnt(0)
    v_mfma_f32_32x32x16_bf16 v[204:219], a[48:51], v[232:235], v[44:59]
    v_max3_f32 v22, v22, v176, v177
    v_max3_f32 v23, v23, v178, v179
    v_max3_f32 v22, v22, v180, v181
    v_max3_f32 v23, v23, v182, v183
    v_max3_f32 v22, v22, v184, v185
    v_mfma_f32_32x32x16_bf16 v[204:219], a[52:55], v[236:239], v[204:219]
    v_max3_f32 v23, v23, v186, v187
    v_max3_f32 v22, v22, v188, v189
    v_max3_f32 v23, v23, v190, v191
    v_max3_f32 v22, v22, v192, v193
    v_max3_f32 v23, v23, v194, v195
    v_max3_f32 v22, v22, v196, v197
    ds_read_b64_tr_b16 a[56:57], v17 offset:1792
    ds_read_b64_tr_b16 a[58:59], v17 offset:1856
    ds_read_b64_tr_b16 a[60:61], v17 offset:1920
    ds_read_b64_tr_b16 a[62:63], v17 offset:1984
    v_max3_f32 v23, v23, v198, v199
    v_max3_f32 v22, v22, v200, v201
    v_max3_f32 v23, v23, v202, v203
    v_max3_f32 v20, v20, v92, v93
    v_max3_f32 v21, v21, v94, v95
    v_max3_f32 v20, v20, v96, v97
    v_max3_f32 v21, v21, v98, v99
    v_max3_f32 v20, v20, v100, v101
    v_max3_f32 v21, v21, v102, v103
    v_max3_f32 v20, v20, v104, v105
    v_max3_f32 v21, v21, v106, v107
    v_max3_f32 v22, v22, v204, v205
    v_max3_f32 v23, v23, v206, v207
    v_max3_f32 v22, v22, v208, v209
    v_max3_f32 v23, v23, v210, v211
    v_max3_f32 v22, v22, v212, v213
    v_max3_f32 v23, v23, v214, v215
    v_max3_f32 v22, v22, v216, v217
    v_max3_f32 v23, v23, v218, v219
    v_max_f32 v20, v20, v21
    v_mov_b32 v21, v20
    s_nop 1
    v_permlane32_swap_b32 v20, v21
    v_max_f32 v20, v20, v21
    v_mov_b32 v252, v20
    v_mul_f32 v24, 0xbea52b5c, v20
    v_mov_b32 v25, v24
    v_max_f32 v22, v22, v23
    v_mov_b32 v23, v22
    s_nop 1
    v_permlane32_swap_b32 v22, v23
    v_max_f32 v22, v22, v23
    v_mov_b32 v253, v22
    v_mul_f32 v26, 0xbea52b5c, v22
    v_mov_b32 v27, v26
    s_waitcnt vmcnt(0)
    s_barrier
    ds_read_b64_tr_b16 a[64:65], v17 offset:2048
    ds_read_b64_tr_b16 a[66:67], v17 offset:2112
    ds_read_b64_tr_b16 a[68:69], v17 offset:2176
    ds_read_b64_tr_b16 a[70:71], v17 offset:2240
    v_pk_fma_f32 v[76:77], v[76:77], s[28:29], v[24:25]
    v_pk_fma_f32 v[78:79], v[78:79], s[28:29], v[24:25]
    v_pk_fma_f32 v[80:81], v[80:81], s[28:29], v[24:25]
    v_pk_fma_f32 v[82:83], v[82:83], s[28:29], v[24:25]
    v_pk_fma_f32 v[84:85], v[84:85], s[28:29], v[24:25]
    v_pk_fma_f32 v[86:87], v[86:87], s[28:29], v[24:25]
    v_pk_fma_f32 v[88:89], v[88:89], s[28:29], v[24:25]
    v_pk_fma_f32 v[90:91], v[90:91], s[28:29], v[24:25]
    v_exp_f32 v76, v76
    v_exp_f32 v77, v77
    v_exp_f32 v78, v78
    v_exp_f32 v79, v79
    v_exp_f32 v80, v80
    v_exp_f32 v81, v81
    v_exp_f32 v82, v82
    v_exp_f32 v83, v83
    v_exp_f32 v84, v84
    v_exp_f32 v85, v85
    v_exp_f32 v86, v86
    v_exp_f32 v87, v87
    v_exp_f32 v88, v88
    v_exp_f32 v89, v89
    v_exp_f32 v90, v90
    v_exp_f32 v91, v91
    v_cvt_pk_bf16_f32 v60, v76, v77
    v_cvt_pk_bf16_f32 v61, v78, v79
    v_cvt_pk_bf16_f32 v62, v80, v81
    v_cvt_pk_bf16_f32 v63, v82, v83
    v_cvt_pk_bf16_f32 v64, v84, v85
    v_cvt_pk_bf16_f32 v65, v86, v87
    v_cvt_pk_bf16_f32 v66, v88, v89
    v_cvt_pk_bf16_f32 v67, v90, v91
    s_lshl_b32 s19, s12, 3
    s_add_u32 s20, s19, s3
    s_sub_u32 s21, 7, s3
    s_add_u32 s21, s21, s19
    s_mul_i32 s20, s20, 40960
    s_mul_i32 s21, s21, 40960
    s_lshl_b32 s22, s13, 10
    s_add_u32 s22, s22, 1048576
    s_add_u32 s36, s20, s22
    s_add_u32 s37, s21, s22
    s_lshr_b32 s23, s13, 2
    s_add_u32 s23, s23, 32
    s_lshl_b32 s23, s23, 10
    s_bfe_u32 s22, s13, 0x10001
    s_lshl_b32 s22, s22, 9
    s_add_u32 s23, s23, s22
    s_and_b32 s22, s13, 1
    s_lshl_b32 s22, s22, 3
    s_add_u32 s23, s23, s22
    s_add_u32 s23, s23, 1048576
    s_add_u32 s38, s20, s23
    s_add_u32 s39, s21, s23
    s_lshr_b32 s26, s13, 2
    s_mul_i32 s26, s26, 102400
    s_mul_i32 s27, s3, 25600
    s_add_u32 s26, s26, s27
    s_add_u32 s26, s26, 41943040
    s_add_u32 s19, s12, 7
    s_and_b32 s19, s19, 7
    s_mul_i32 s19, s19, 786432
    s_add_u32 s19, s19, 8388608
    s_mul_i32 s20, s13, 24576
    s_mul_i32 s21, s3, 6144
    s_add_u32 s20, s20, s21
    s_add_u32 s20, s20, s19
    s_lshl_b32 s21, s13, 12
    s_lshl_b32 s22, s3, 10
    s_add_u32 s21, s21, s22
    s_add_u32 s21, s21, s19
    s_add_u32 s21, s21, 655360
    s_cmp_eq_u32 s12, 0
    s_cselect_b32 s16, s20, s21
    s_cselect_b32 s25, 48, 8
    s_lshl_b32 s22, s12, 15
    s_lshl_b32 s23, s13, 10
    s_add_u32 s22, s22, s23
    s_lshl_b32 s23, s3, 8
    s_add_u32 s22, s22, s23
    s_add_u32 s17, s22, 65536
    v_lshlrev_b32 v4, 7, v2
    s_mov_b32 s32, s40
    s_mov_b32 s33, s41
    s_mov_b32 s34, 2621440
    s_mov_b32 s35, 0x20000
    s_lshl_b32 s19, s12, 8
    s_and_b32 s20, s13, 3
    s_lshl_b32 s20, s20, 6
    s_add_u32 s19, s19, s20
    s_and_b32 s20, s3, 1
    s_lshl_b32 s20, s20, 5
    s_add_u32 s19, s19, s20
    v_and_b32 v8, 31, v2
    v_add_u32 v8, s19, v8
    v_mul_u32_u24 v8, 1280, v8
    v_lshrrev_b32 v14, 5, v2
    v_lshl_add_u32 v8, v14, 3, v8
    s_lshr_b32 s19, s13, 2
    s_mul_i32 s19, s19, 5
    s_lshr_b32 s20, s3, 1
    s_mul_i32 s20, s20, 3
    s_add_u32 s19, s19, s20
    s_lshl_b32 s43, s19, 5
    s_lshl_b32 s30, s12, 13
    s_add_u32 s30, s30, s43
    s_add_u32 s30, s30, 458752
    v_lshlrev_b32 v15, 4, v14
    ds_read_b64_tr_b16 a[72:73], v19 offset:512
    ds_read_b64_tr_b16 a[74:75], v19 offset:576
    ds_read_b64_tr_b16 a[76:77], v19 offset:640
    ds_read_b64_tr_b16 a[78:79], v19 offset:704
    v_pk_fma_f32 v[92:93], v[92:93], s[28:29], v[24:25]
    v_pk_fma_f32 v[94:95], v[94:95], s[28:29], v[24:25]
    v_pk_fma_f32 v[96:97], v[96:97], s[28:29], v[24:25]
    s_waitcnt lgkmcnt(8)
    v_mfma_f32_32x32x16_bf16 a[80:95], a[56:59], v[60:63], 0
    v_pk_fma_f32 v[98:99], v[98:99], s[28:29], v[24:25]
    v_pk_fma_f32 v[100:101], v[100:101], s[28:29], v[24:25]
    v_pk_fma_f32 v[102:103], v[102:103], s[28:29], v[24:25]
    v_pk_fma_f32 v[104:105], v[104:105], s[28:29], v[24:25]
    v_pk_fma_f32 v[106:107], v[106:107], s[28:29], v[24:25]
    v_exp_f32 v92, v92
    v_exp_f32 v93, v93
    v_exp_f32 v94, v94
    v_exp_f32 v95, v95
    v_exp_f32 v96, v96
    v_exp_f32 v97, v97
    v_exp_f32 v98, v98
    v_exp_f32 v99, v99
    v_exp_f32 v100, v100
    v_mfma_f32_32x32x16_bf16 a[80:95], a[60:63], v[64:67], a[80:95]
    v_exp_f32 v101, v101
    v_exp_f32 v102, v102
    v_exp_f32 v103, v103
    v_exp_f32 v104, v104
    v_exp_f32 v105, v105
    v_exp_f32 v106, v106
    v_exp_f32 v107, v107
    v_cvt_pk_bf16_f32 v68, v92, v93
    v_cvt_pk_bf16_f32 v69, v94, v95
    v_cvt_pk_bf16_f32 v70, v96, v97
    v_cvt_pk_bf16_f32 v71, v98, v99
    v_cvt_pk_bf16_f32 v72, v100, v101
    v_cvt_pk_bf16_f32 v73, v102, v103
    v_cvt_pk_bf16_f32 v74, v104, v105
    v_cvt_pk_bf16_f32 v75, v106, v107
    ds_read_b64_tr_b16 a[56:57], v19 offset:768
    ds_read_b64_tr_b16 a[58:59], v19 offset:832
    ds_read_b64_tr_b16 a[60:61], v19 offset:896
    ds_read_b64_tr_b16 a[62:63], v19 offset:960
    v_pk_fma_f32 v[108:109], v[108:109], s[28:29], v[26:27]
    v_pk_fma_f32 v[110:111], v[110:111], s[28:29], v[26:27]
    v_pk_fma_f32 v[112:113], v[112:113], s[28:29], v[26:27]
    s_waitcnt lgkmcnt(8)
    v_mfma_f32_32x32x16_bf16 a[80:95], a[64:67], v[68:71], a[80:95]
    v_pk_fma_f32 v[114:115], v[114:115], s[28:29], v[26:27]
    v_pk_fma_f32 v[116:117], v[116:117], s[28:29], v[26:27]
    v_pk_fma_f32 v[118:119], v[118:119], s[28:29], v[26:27]
    v_pk_fma_f32 v[120:121], v[120:121], s[28:29], v[26:27]
    v_pk_fma_f32 v[122:123], v[122:123], s[28:29], v[26:27]
    v_exp_f32 v108, v108
    v_exp_f32 v109, v109
    v_exp_f32 v110, v110
    v_exp_f32 v111, v111
    v_exp_f32 v112, v112
    v_exp_f32 v113, v113
    v_exp_f32 v114, v114
    v_exp_f32 v115, v115
    v_exp_f32 v116, v116
    v_mfma_f32_32x32x16_bf16 a[80:95], a[68:71], v[72:75], a[80:95]
    v_exp_f32 v117, v117
    v_exp_f32 v118, v118
    v_exp_f32 v119, v119
    v_exp_f32 v120, v120
    v_exp_f32 v121, v121
    v_exp_f32 v122, v122
    v_exp_f32 v123, v123
    v_cvt_pk_bf16_f32 v60, v108, v109
    v_cvt_pk_bf16_f32 v61, v110, v111
    v_cvt_pk_bf16_f32 v62, v112, v113
    v_cvt_pk_bf16_f32 v63, v114, v115
    v_cvt_pk_bf16_f32 v64, v116, v117
    v_cvt_pk_bf16_f32 v65, v118, v119
    v_cvt_pk_bf16_f32 v66, v120, v121
    v_cvt_pk_bf16_f32 v67, v122, v123
    ds_read_b64_tr_b16 a[64:65], v19 offset:1024
    ds_read_b64_tr_b16 a[66:67], v19 offset:1088
    ds_read_b64_tr_b16 a[68:69], v19 offset:1152
    ds_read_b64_tr_b16 a[70:71], v19 offset:1216
    v_pk_fma_f32 v[124:125], v[124:125], s[28:29], v[26:27]
    v_pk_fma_f32 v[126:127], v[126:127], s[28:29], v[26:27]
    v_pk_fma_f32 v[128:129], v[128:129], s[28:29], v[26:27]
    s_waitcnt lgkmcnt(8)
    v_mfma_f32_32x32x16_bf16 a[96:111], a[72:75], v[60:63], 0
    v_pk_fma_f32 v[130:131], v[130:131], s[28:29], v[26:27]
    v_pk_fma_f32 v[132:133], v[132:133], s[28:29], v[26:27]
    v_pk_fma_f32 v[134:135], v[134:135], s[28:29], v[26:27]
    v_pk_fma_f32 v[136:137], v[136:137], s[28:29], v[26:27]
    v_pk_fma_f32 v[138:139], v[138:139], s[28:29], v[26:27]
    v_exp_f32 v124, v124
    v_exp_f32 v125, v125
    v_exp_f32 v126, v126
    v_exp_f32 v127, v127
    v_exp_f32 v128, v128
    v_exp_f32 v129, v129
    v_exp_f32 v130, v130
    v_exp_f32 v131, v131
    v_exp_f32 v132, v132
    v_mfma_f32_32x32x16_bf16 a[96:111], a[76:79], v[64:67], a[96:111]
    v_exp_f32 v133, v133
    v_exp_f32 v134, v134
    v_exp_f32 v135, v135
    v_exp_f32 v136, v136
    v_exp_f32 v137, v137
    v_exp_f32 v138, v138
    v_exp_f32 v139, v139
    v_cvt_pk_bf16_f32 v68, v124, v125
    v_cvt_pk_bf16_f32 v69, v126, v127
    v_cvt_pk_bf16_f32 v70, v128, v129
    v_cvt_pk_bf16_f32 v71, v130, v131
    v_cvt_pk_bf16_f32 v72, v132, v133
    v_cvt_pk_bf16_f32 v73, v134, v135
    v_cvt_pk_bf16_f32 v74, v136, v137
    v_cvt_pk_bf16_f32 v75, v138, v139
    ds_read_b64_tr_b16 a[72:73], v19 offset:1280
    ds_read_b64_tr_b16 a[74:75], v19 offset:1344
    ds_read_b64_tr_b16 a[76:77], v19 offset:1408
    ds_read_b64_tr_b16 a[78:79], v19 offset:1472
    v_pk_fma_f32 v[140:141], v[140:141], s[28:29], v[26:27]
    v_pk_fma_f32 v[142:143], v[142:143], s[28:29], v[26:27]
    v_pk_fma_f32 v[144:145], v[144:145], s[28:29], v[26:27]
    s_waitcnt lgkmcnt(8)
    v_mfma_f32_32x32x16_bf16 a[96:111], a[56:59], v[68:71], a[96:111]
    v_pk_fma_f32 v[146:147], v[146:147], s[28:29], v[26:27]
    v_pk_fma_f32 v[148:149], v[148:149], s[28:29], v[26:27]
    v_pk_fma_f32 v[150:151], v[150:151], s[28:29], v[26:27]
    v_pk_fma_f32 v[152:153], v[152:153], s[28:29], v[26:27]
    v_pk_fma_f32 v[154:155], v[154:155], s[28:29], v[26:27]
    v_exp_f32 v140, v140
    v_exp_f32 v141, v141
    v_exp_f32 v142, v142
    v_exp_f32 v143, v143
    v_exp_f32 v144, v144
    v_exp_f32 v145, v145
    v_exp_f32 v146, v146
    v_exp_f32 v147, v147
    v_exp_f32 v148, v148
    v_mfma_f32_32x32x16_bf16 a[96:111], a[60:63], v[72:75], a[96:111]
    v_exp_f32 v149, v149
    v_exp_f32 v150, v150
    v_exp_f32 v151, v151
    v_exp_f32 v152, v152
    v_exp_f32 v153, v153
    v_exp_f32 v154, v154
    v_exp_f32 v155, v155
    v_cvt_pk_bf16_f32 v60, v140, v141
    v_cvt_pk_bf16_f32 v61, v142, v143
    v_cvt_pk_bf16_f32 v62, v144, v145
    v_cvt_pk_bf16_f32 v63, v146, v147
    v_cvt_pk_bf16_f32 v64, v148, v149
    v_cvt_pk_bf16_f32 v65, v150, v151
    v_cvt_pk_bf16_f32 v66, v152, v153
    v_cvt_pk_bf16_f32 v67, v154, v155
    ds_read_b64_tr_b16 a[56:57], v19 offset:1536
    ds_read_b64_tr_b16 a[58:59], v19 offset:1600
    ds_read_b64_tr_b16 a[60:61], v19 offset:1664
    ds_read_b64_tr_b16 a[62:63], v19 offset:1728
    v_pk_fma_f32 v[156:157], v[156:157], s[28:29], v[26:27]
    v_pk_fma_f32 v[158:159], v[158:159], s[28:29], v[26:27]
    v_pk_fma_f32 v[160:161], v[160:161], s[28:29], v[26:27]
    s_waitcnt lgkmcnt(8)
    v_mfma_f32_32x32x16_bf16 a[96:111], a[64:67], v[60:63], a[96:111]
    v_pk_fma_f32 v[162:163], v[162:163], s[28:29], v[26:27]
    v_pk_fma_f32 v[164:165], v[164:165], s[28:29], v[26:27]
    v_pk_fma_f32 v[166:167], v[166:167], s[28:29], v[26:27]
    v_pk_fma_f32 v[168:169], v[168:169], s[28:29], v[26:27]
    v_pk_fma_f32 v[170:171], v[170:171], s[28:29], v[26:27]
    v_exp_f32 v156, v156
    v_exp_f32 v157, v157
    v_exp_f32 v158, v158
    v_exp_f32 v159, v159
    v_exp_f32 v160, v160
    v_exp_f32 v161, v161
    v_exp_f32 v162, v162
    v_exp_f32 v163, v163
    v_exp_f32 v164, v164
    v_mfma_f32_32x32x16_bf16 a[96:111], a[68:71], v[64:67], a[96:111]
    v_exp_f32 v165, v165
    v_exp_f32 v166, v166
    v_exp_f32 v167, v167
    v_exp_f32 v168, v168
    v_exp_f32 v169, v169
    v_exp_f32 v170, v170
    v_exp_f32 v171, v171
    v_cvt_pk_bf16_f32 v68, v156, v157
    v_cvt_pk_bf16_f32 v69, v158, v159
    v_cvt_pk_bf16_f32 v70, v160, v161
    v_cvt_pk_bf16_f32 v71, v162, v163
    v_cvt_pk_bf16_f32 v72, v164, v165
    v_cvt_pk_bf16_f32 v73, v166, v167
    v_cvt_pk_bf16_f32 v74, v168, v169
    v_cvt_pk_bf16_f32 v75, v170, v171
    s_barrier
    s_cmp_eq_u32 s12, 0
    s_cbranch_scc1 AT_NH_60
    s_sub_u32 s22, s24, 781312
    s_mov_b32 m0, 123392
    s_nop 0
    buffer_load_dwordx4 v3, s[8:11], s22 offen sc1 lds
    s_mov_b32 m0, 126464
    s_add_u32 s22, s22, 1024
    buffer_load_dwordx4 v3, s[8:11], s22 offen sc1 lds
    s_mov_b32 m0, 127488
    s_add_u32 s22, s22, 1024
    buffer_load_dwordx4 v3, s[8:11], s22 offen sc1 lds
    s_mov_b32 m0, 130560
    s_add_u32 s22, s22, 1024
    buffer_load_dwordx4 v3, s[8:11], s22 offen sc1 lds
    s_mov_b32 m0, 131584
    s_add_u32 s22, s22, 1024
    buffer_load_dwordx4 v3, s[8:11], s22 offen sc1 lds
AT_NH_60:
    ds_read_b64_tr_b16 a[64:65], v19 offset:1792
    ds_read_b64_tr_b16 a[66:67], v19 offset:1856
    ds_read_b64_tr_b16 a[68:69], v19 offset:1920
    ds_read_b64_tr_b16 a[70:71], v19 offset:1984
    v_pk_fma_f32 v[172:173], v[172:173], s[28:29], v[26:27]
    v_pk_fma_f32 v[174:175], v[174:175], s[28:29], v[26:27]
    v_pk_fma_f32 v[176:177], v[176:177], s[28:29], v[26:27]
    s_waitcnt lgkmcnt(8)
    v_mfma_f32_32x32x16_bf16 a[96:111], a[72:75], v[68:71], a[96:111]
    v_pk_fma_f32 v[178:179], v[178:179], s[28:29], v[26:27]
    v_pk_fma_f32 v[180:181], v[180:181], s[28:29], v[26:27]
    v_pk_fma_f32 v[182:183], v[182:183], s[28:29], v[26:27]
    v_pk_fma_f32 v[184:185], v[184:185], s[28:29], v[26:27]
    v_pk_fma_f32 v[186:187], v[186:187], s[28:29], v[26:27]
    v_exp_f32 v172, v172
    v_exp_f32 v173, v173
    v_exp_f32 v174, v174
    v_exp_f32 v175, v175
    v_exp_f32 v176, v176
    v_exp_f32 v177, v177
    v_exp_f32 v178, v178
    v_exp_f32 v179, v179
    v_exp_f32 v180, v180
    v_mfma_f32_32x32x16_bf16 a[96:111], a[76:79], v[72:75], a[96:111]
    v_exp_f32 v181, v181
    v_exp_f32 v182, v182
    v_exp_f32 v183, v183
    v_exp_f32 v184, v184
    v_exp_f32 v185, v185
    v_exp_f32 v186, v186
    v_exp_f32 v187, v187
    v_cvt_pk_bf16_f32 v60, v172, v173
    v_cvt_pk_bf16_f32 v61, v174, v175
    v_cvt_pk_bf16_f32 v62, v176, v177
    v_cvt_pk_bf16_f32 v63, v178, v179
    v_cvt_pk_bf16_f32 v64, v180, v181
    v_cvt_pk_bf16_f32 v65, v182, v183
    v_cvt_pk_bf16_f32 v66, v184, v185
    v_cvt_pk_bf16_f32 v67, v186, v187
    ds_read_b64_tr_b16 a[72:73], v19 offset:2048
    ds_read_b64_tr_b16 a[74:75], v19 offset:2112
    ds_read_b64_tr_b16 a[76:77], v19 offset:2176
    ds_read_b64_tr_b16 a[78:79], v19 offset:2240
    v_pk_fma_f32 v[188:189], v[188:189], s[28:29], v[26:27]
    v_pk_fma_f32 v[190:191], v[190:191], s[28:29], v[26:27]
    v_pk_fma_f32 v[192:193], v[192:193], s[28:29], v[26:27]
    s_waitcnt lgkmcnt(8)
    v_mfma_f32_32x32x16_bf16 a[96:111], a[56:59], v[60:63], a[96:111]
    v_pk_fma_f32 v[194:195], v[194:195], s[28:29], v[26:27]
    v_pk_fma_f32 v[196:197], v[196:197], s[28:29], v[26:27]
    v_pk_fma_f32 v[198:199], v[198:199], s[28:29], v[26:27]
    v_pk_fma_f32 v[200:201], v[200:201], s[28:29], v[26:27]
    v_pk_fma_f32 v[202:203], v[202:203], s[28:29], v[26:27]
    v_exp_f32 v188, v188
    v_exp_f32 v189, v189
    v_exp_f32 v190, v190
    v_exp_f32 v191, v191
    v_exp_f32 v192, v192
    v_exp_f32 v193, v193
    v_exp_f32 v194, v194
    v_exp_f32 v195, v195
    v_exp_f32 v196, v196
    v_mfma_f32_32x32x16_bf16 a[96:111], a[60:63], v[64:67], a[96:111]
    v_exp_f32 v197, v197
    v_exp_f32 v198, v198
    v_exp_f32 v199, v199
    v_exp_f32 v200, v200
    v_exp_f32 v201, v201
    v_exp_f32 v202, v202
    v_exp_f32 v203, v203
    v_cvt_pk_bf16_f32 v68, v188, v189
    v_cvt_pk_bf16_f32 v69, v190, v191
    v_cvt_pk_bf16_f32 v70, v192, v193
    v_cvt_pk_bf16_f32 v71, v194, v195
    v_cvt_pk_bf16_f32 v72, v196, v197
    v_cvt_pk_bf16_f32 v73, v198, v199
    v_cvt_pk_bf16_f32 v74, v200, v201
    v_cvt_pk_bf16_f32 v75, v202, v203
    v_pk_fma_f32 v[204:205], v[204:205], s[28:29], v[26:27]
    v_pk_fma_f32 v[206:207], v[206:207], s[28:29], v[26:27]
    v_pk_fma_f32 v[208:209], v[208:209], s[28:29], v[26:27]
    s_waitcnt lgkmcnt(4)
    v_mfma_f32_32x32x16_bf16 a[96:111], a[64:67], v[68:71], a[96:111]
    v_pk_fma_f32 v[210:211], v[210:211], s[28:29], v[26:27]
    v_pk_fma_f32 v[212:213], v[212:213], s[28:29], v[26:27]
    v_pk_fma_f32 v[214:215], v[214:215], s[28:29], v[26:27]
    v_pk_fma_f32 v[216:217], v[216:217], s[28:29], v[26:27]
    v_pk_fma_f32 v[218:219], v[218:219], s[28:29], v[26:27]
    v_exp_f32 v204, v204
    v_exp_f32 v205, v205
    v_exp_f32 v206, v206
    v_exp_f32 v207, v207
    v_exp_f32 v208, v208
    v_exp_f32 v209, v209
    v_exp_f32 v210, v210
    v_exp_f32 v211, v211
    v_exp_f32 v212, v212
    v_mfma_f32_32x32x16_bf16 a[96:111], a[68:71], v[72:75], a[96:111]
    v_exp_f32 v213, v213
    v_exp_f32 v214, v214
    v_exp_f32 v215, v215
    v_exp_f32 v216, v216
    v_exp_f32 v217, v217
    v_exp_f32 v218, v218
    v_exp_f32 v219, v219
    v_cvt_pk_bf16_f32 v60, v204, v205
    v_cvt_pk_bf16_f32 v61, v206, v207
    v_cvt_pk_bf16_f32 v62, v208, v209
    v_cvt_pk_bf16_f32 v63, v210, v211
    v_cvt_pk_bf16_f32 v64, v212, v213
    v_cvt_pk_bf16_f32 v65, v214, v215
    v_cvt_pk_bf16_f32 v66, v216, v217
    v_cvt_pk_bf16_f32 v67, v218, v219
    s_waitcnt lgkmcnt(0)
    v_mfma_f32_32x32x16_bf16 a[96:111], a[72:75], v[60:63], a[96:111]
    v_mfma_f32_32x32x16_bf16 a[96:111], a[76:79], v[64:67], a[96:111]
    s_add_u32 m0, s27, 0
    s_nop 0
    buffer_load_dwordx4 v3, s[8:11], s26 offen offset:0 lds
    buffer_load_dwordx4 v3, s[8:11], s26 offen offset:1024 lds
    buffer_load_dwordx4 v3, s[8:11], s26 offen offset:2048 lds
    buffer_load_dwordx4 v3, s[8:11], s26 offen offset:3072 lds
    s_add_u32 m0, s27, 4096
    s_add_u32 s26, s26, 4096
    buffer_load_dwordx4 v3, s[8:11], s26 offen offset:0 lds
    buffer_load_dwordx4 v3, s[8:11], s26 offen offset:1024 lds
    buffer_load_dwordx4 v3, s[8:11], s26 offen offset:2048 lds
    buffer_load_dwordx4 v3, s[8:11], s26 offen offset:3072 lds
    s_add_u32 m0, s27, 8192
    s_add_u32 s26, s26, 4096
    buffer_load_dwordx4 v3, s[8:11], s26 offen offset:0 lds
    buffer_load_dwordx4 v3, s[8:11], s26 offen offset:1024 lds
    buffer_load_dwordx4 v3, s[8:11], s26 offen offset:2048 lds
    buffer_load_dwordx4 v3, s[8:11], s26 offen offset:3072 lds
    s_waitcnt vmcnt(12) lgkmcnt(0)
    s_barrier
    ds_read_b64 a[32:33], v16 offset:0
    ds_read_b64 a[34:35], v16 offset:8192
    ds_read_b64 a[36:37], v16 offset:16384
    ds_read_b64 a[40:41], v16 offset:256
    ds_read_b64 a[42:43], v16 offset:8448
    ds_read_b64 a[44:45], v16 offset:16640
    ds_read_b64 a[48:49], v16 offset:512
    ds_read_b64 a[50:51], v16 offset:8704
    ds_read_b64 a[52:53], v16 offset:16896
    s_waitcnt lgkmcnt(6)
    v_mfma_f32_32x32x16_bf16 v[76:91], a[32:35], v[224:227], v[28:43]
    v_mfma_f32_32x32x16_bf16 v[76:91], a[36:39], v[228:231], v[76:91]
    ds_read_b64 a[32:33], v16 offset:768
    ds_read_b64 a[34:35], v16 offset:8960
    ds_read_b64 a[36:37], v16 offset:17152
    s_waitcnt lgkmcnt(6)
    v_mfma_f32_32x32x16_bf16 v[92:107], a[40:43], v[224:227], 0
    v_mfma_f32_32x32x16_bf16 v[92:107], a[44:47], v[228:231], v[92:107]
    ds_read_b64 a[40:41], v16 offset:1024
    ds_read_b64 a[42:43], v16 offset:9216
    ds_read_b64 a[44:45], v16 offset:17408
    s_waitcnt lgkmcnt(6)
    v_mfma_f32_32x32x16_bf16 v[108:123], a[48:51], v[224:227], 0
    v_mfma_f32_32x32x16_bf16 v[108:123], a[52:55], v[228:231], v[108:123]
    v_max3_f32 v20, v76, v77, v78
    v_max3_f32 v21, v79, v80, v81
    v_max3_f32 v20, v20, v82, v83
    v_max3_f32 v21, v21, v84, v85
    v_max3_f32 v20, v20, v86, v87
    v_max3_f32 v21, v21, v88, v89
    ds_read_b64 a[48:49], v16 offset:1280
    s_add_u32 m0, s27, 12288
    s_add_u32 s26, s26, 4096
    buffer_load_dwordx4 v3, s[8:11], s26 offen offset:0 lds
    ds_read_b64 a[50:51], v16 offset:9472
    ds_read_b64 a[52:53], v16 offset:17664
    s_waitcnt lgkmcnt(6)
    v_mfma_f32_32x32x16_bf16 v[124:139], a[32:35], v[224:227], 0
    v_max3_f32 v20, v20, v90, v91
    v_mfma_f32_32x32x16_bf16 v[124:139], a[36:39], v[228:231], v[124:139]
    v_max3_f32 v20, v20, v92, v93
    s_add_u32 s31, s30, 2560
    buffer_load_dwordx4 a[156:159], v15, s[8:11], s31 offen offset:0 sc1
    v_max3_f32 v21, v21, v94, v95
    v_max3_f32 v20, v20, v96, v97
    v_max3_f32 v21, v21, v98, v99
    v_max3_f32 v20, v20, v100, v101
    v_max3_f32 v21, v21, v102, v103
    ds_read_b64 a[32:33], v16 offset:1536
    ds_read_b64 a[34:35], v16 offset:9728
    ds_read_b64 a[36:37], v16 offset:17920
    s_waitcnt lgkmcnt(6)
    v_mfma_f32_32x32x16_bf16 v[140:155], a[40:43], v[224:227], 0
    v_max3_f32 v20, v20, v104, v105
    v_max3_f32 v21, v21, v106, v107
    v_mfma_f32_32x32x16_bf16 v[140:155], a[44:47], v[228:231], v[140:155]
    v_max3_f32 v20, v20, v108, v109
    v_max3_f32 v21, v21, v110, v111
    v_max3_f32 v20, v20, v112, v113
    v_max3_f32 v21, v21, v114, v115
    v_max3_f32 v20, v20, v116, v117
    v_max3_f32 v21, v21, v118, v119
    ds_read_b64 a[40:41], v18 offset:0
    ds_read_b64 a[42:43], v18 offset:8192
    ds_read_b64 a[44:45], v18 offset:16384
    s_waitcnt lgkmcnt(6)
    v_mfma_f32_32x32x16_bf16 v[156:171], a[48:51], v[224:227], 0
    s_add_u32 s31, s30, 2560
    buffer_load_dwordx4 a[160:163], v15, s[8:11], s31 offen offset:32 sc1
    v_max3_f32 v20, v20, v120, v121
    v_max3_f32 v21, v21, v122, v123
    v_mfma_f32_32x32x16_bf16 v[156:171], a[52:55], v[228:231], v[156:171]
    v_max3_f32 v20, v20, v124, v125
    v_max3_f32 v21, v21, v126, v127
    buffer_load_dwordx4 v3, s[8:11], s26 offen offset:1024 lds
    v_max3_f32 v20, v20, v128, v129
    v_max3_f32 v21, v21, v130, v131
    v_max3_f32 v20, v20, v132, v133
    v_max3_f32 v21, v21, v134, v135
    ds_read_b64 a[48:49], v18 offset:256
    ds_read_b64 a[50:51], v18 offset:8448
    ds_read_b64 a[52:53], v18 offset:16640
    s_waitcnt lgkmcnt(6)
    v_mfma_f32_32x32x16_bf16 v[172:187], a[32:35], v[224:227], 0
    v_max3_f32 v20, v20, v136, v137
    v_max3_f32 v21, v21, v138, v139
    v_mfma_f32_32x32x16_bf16 v[172:187], a[36:39], v[228:231], v[172:187]
    v_max3_f32 v20, v20, v140, v141
    v_max3_f32 v21, v21, v142, v143
    v_max3_f32 v20, v20, v144, v145
    v_max3_f32 v21, v21, v146, v147
    v_max3_f32 v20, v20, v148, v149
    v_max3_f32 v21, v21, v150, v151
    s_waitcnt lgkmcnt(3)
    v_mfma_f32_32x32x16_bf16 v[188:203], a[40:43], v[232:235], v[28:43]
    s_add_u32 s31, s30, 2560
    buffer_load_dwordx4 a[164:167], v15, s[8:11], s31 offen offset:64 sc1
    v_max3_f32 v20, v20, v152, v153
    v_max3_f32 v21, v21, v154, v155
    v_mfma_f32_32x32x16_bf16 v[188:203], a[44:47], v[236:239], v[188:203]
    v_max3_f32 v20, v20, v156, v157
    v_max3_f32 v21, v21, v158, v159
    v_max3_f32 v20, v20, v160, v161
    v_max3_f32 v21, v21, v162, v163
    v_max3_f32 v20, v20, v164, v165
    v_max3_f32 v21, v21, v166, v167
    s_waitcnt lgkmcnt(0)
    v_mfma_f32_32x32x16_bf16 v[204:219], a[48:51], v[232:235], 0
    v_max3_f32 v20, v20, v168, v169
    v_max3_f32 v21, v21, v170, v171
    v_mfma_f32_32x32x16_bf16 v[204:219], a[52:55], v[236:239], v[204:219]
    v_max3_f32 v20, v20, v172, v173
    v_max3_f32 v21, v21, v174, v175
    buffer_load_dwordx4 v3, s[8:11], s26 offen offset:2048 lds
    v_max3_f32 v20, v20, v176, v177
    v_max3_f32 v21, v21, v178, v179
    v_max3_f32 v20, v20, v180, v181
    v_max3_f32 v21, v21, v182, v183
    ds_read_b64_tr_b16 a[56:57], v17 offset:0
    ds_read_b64_tr_b16 a[58:59], v17 offset:64
    ds_read_b64_tr_b16 a[60:61], v17 offset:128
    ds_read_b64_tr_b16 a[62:63], v17 offset:192
    v_max3_f32 v20, v20, v184, v185
    s_add_u32 s31, s30, 5120
    buffer_load_dwordx4 a[168:171], v15, s[8:11], s31 offen offset:0 sc1
    v_max3_f32 v21, v21, v186, v187
    v_max3_f32 v22, v188, v189, v190
    v_max3_f32 v23, v191, v192, v193
    v_max3_f32 v22, v22, v194, v195
    v_max3_f32 v23, v23, v196, v197
    v_max3_f32 v22, v22, v198, v199
    v_max3_f32 v23, v23, v200, v201
    v_max3_f32 v22, v22, v202, v203
    v_max3_f32 v22, v22, v204, v205
    v_max3_f32 v23, v23, v206, v207
    v_max3_f32 v22, v22, v208, v209
    v_max3_f32 v23, v23, v210, v211
    v_max3_f32 v22, v22, v212, v213
    v_max3_f32 v23, v23, v214, v215
    v_max3_f32 v22, v22, v216, v217
    v_max3_f32 v23, v23, v218, v219
    v_max_f32 v20, v20, v21
    v_mov_b32 v21, v20
    s_nop 1
    v_permlane32_swap_b32 v20, v21
    v_max_f32 v20, v20, v21
    v_max_f32 v20, v20, v252
    v_sub_f32 v21, v252, v20
    v_mul_f32 v21, s28, v21
    v_exp_f32 v222, v21
    s_add_u32 s31, s30, 5120
    buffer_load_dwordx4 a[172:175], v15, s[8:11], s31 offen offset:32 sc1
    v_mul_f32 v24, 0xbea52b5c, v20
    v_mov_b32 v25, v24
    buffer_load_dwordx4 v3, s[8:11], s26 offen offset:3072 lds
    v_max_f32 v22, v22, v23
    v_mov_b32 v23, v22
    s_nop 1
    v_permlane32_swap_b32 v22, v23
    v_max_f32 v22, v22, v23
    v_max_f32 v22, v22, v253
    v_sub_f32 v23, v253, v22
    v_mul_f32 v23, s28, v23
    v_exp_f32 v223, v23
    v_mul_f32 v26, 0xbea52b5c, v22
    v_mov_b32 v27, v26
    ds_read_b64_tr_b16 a[64:65], v17 offset:256
    ds_read_b64_tr_b16 a[66:67], v17 offset:320
    ds_read_b64_tr_b16 a[68:69], v17 offset:384
    ds_read_b64_tr_b16 a[70:71], v17 offset:448
    v_pk_fma_f32 v[76:77], v[76:77], s[28:29], v[24:25]
    v_pk_fma_f32 v[78:79], v[78:79], s[28:29], v[24:25]
    v_pk_fma_f32 v[80:81], v[80:81], s[28:29], v[24:25]
    v_pk_fma_f32 v[82:83], v[82:83], s[28:29], v[24:25]
    v_pk_fma_f32 v[84:85], v[84:85], s[28:29], v[24:25]
    v_pk_fma_f32 v[86:87], v[86:87], s[28:29], v[24:25]
    v_pk_fma_f32 v[88:89], v[88:89], s[28:29], v[24:25]
    v_pk_fma_f32 v[90:91], v[90:91], s[28:29], v[24:25]
    v_exp_f32 v76, v76
    s_add_u32 s31, s30, 5120
    buffer_load_dwordx4 a[176:179], v15, s[8:11], s31 offen offset:64 sc1
    v_exp_f32 v77, v77
    v_exp_f32 v78, v78
    v_exp_f32 v79, v79
    v_exp_f32 v80, v80
    v_exp_f32 v81, v81
    v_exp_f32 v82, v82
    v_exp_f32 v83, v83
    v_exp_f32 v84, v84
    v_exp_f32 v85, v85
    v_exp_f32 v86, v86
    v_exp_f32 v87, v87
    v_exp_f32 v88, v88
    v_exp_f32 v89, v89
    s_add_u32 m0, s27, 16384
    s_add_u32 s26, s26, 4096
    buffer_load_dwordx4 v3, s[8:11], s26 offen offset:0 lds
    v_exp_f32 v90, v90
    v_exp_f32 v91, v91
    v_cvt_pk_bf16_f32 v60, v76, v77
    v_cvt_pk_bf16_f32 v61, v78, v79
    v_cvt_pk_bf16_f32 v62, v80, v81
    v_cvt_pk_bf16_f32 v63, v82, v83
    v_cvt_pk_bf16_f32 v64, v84, v85
    v_cvt_pk_bf16_f32 v65, v86, v87
    v_cvt_pk_bf16_f32 v66, v88, v89
    v_cvt_pk_bf16_f32 v67, v90, v91
    ds_read_b64_tr_b16 a[72:73], v17 offset:512
    ds_read_b64_tr_b16 a[74:75], v17 offset:576
    s_add_u32 s31, s30, 3840
    buffer_load_dwordx4 a[180:183], v15, s[8:11], s31 offen offset:0 sc1
    s_bfm_b64 exec, s25, 0
    buffer_load_dword v255, v4, s[8:11], s16 offen
    s_mov_b64 exec, 3
    buffer_load_dword v255, v4, s[8:11], s17 offen
    s_mov_b64 exec, -1
    ds_read_b64_tr_b16 a[76:77], v17 offset:640
    ds_read_b64_tr_b16 a[78:79], v17 offset:704
    v_pk_fma_f32 v[92:93], v[92:93], s[28:29], v[24:25]
    v_pk_fma_f32 v[94:95], v[94:95], s[28:29], v[24:25]
    v_pk_fma_f32 v[96:97], v[96:97], s[28:29], v[24:25]
    s_waitcnt lgkmcnt(8)
    v_mfma_f32_32x32x16_bf16 a[112:127], a[56:59], v[60:63], 0
    v_pk_fma_f32 v[98:99], v[98:99], s[28:29], v[24:25]
    v_pk_fma_f32 v[100:101], v[100:101], s[28:29], v[24:25]
    v_pk_fma_f32 v[102:103], v[102:103], s[28:29], v[24:25]
    v_pk_fma_f32 v[104:105], v[104:105], s[28:29], v[24:25]
    v_pk_fma_f32 v[106:107], v[106:107], s[28:29], v[24:25]
    v_exp_f32 v92, v92
    v_exp_f32 v93, v93
    v_exp_f32 v94, v94
    v_exp_f32 v95, v95
    v_exp_f32 v96, v96
    v_exp_f32 v97, v97
    v_exp_f32 v98, v98
    v_exp_f32 v99, v99
    v_exp_f32 v100, v100
    v_mfma_f32_32x32x16_bf16 a[112:127], a[60:63], v[64:67], a[112:127]
    v_exp_f32 v101, v101
    buffer_load_dwordx4 v3, s[8:11], s26 offen offset:1024 lds
    v_exp_f32 v102, v102
    s_add_u32 s31, s30, 3840
    buffer_load_dwordx4 a[184:187], v15, s[8:11], s31 offen offset:32 sc1
    v_exp_f32 v103, v103
    v_exp_f32 v104, v104
    v_exp_f32 v105, v105
    v_exp_f32 v106, v106
    v_exp_f32 v107, v107
    v_cvt_pk_bf16_f32 v68, v92, v93
    v_cvt_pk_bf16_f32 v69, v94, v95
    v_cvt_pk_bf16_f32 v70, v96, v97
    v_cvt_pk_bf16_f32 v71, v98, v99
    v_cvt_pk_bf16_f32 v72, v100, v101
    v_cvt_pk_bf16_f32 v73, v102, v103
    v_cvt_pk_bf16_f32 v74, v104, v105
    v_cvt_pk_bf16_f32 v75, v106, v107
    ds_read_b64_tr_b16 a[56:57], v17 offset:768
    ds_read_b64_tr_b16 a[58:59], v17 offset:832
    ds_read_b64_tr_b16 a[60:61], v17 offset:896
    ds_read_b64_tr_b16 a[62:63], v17 offset:960
    v_pk_fma_f32 v[108:109], v[108:109], s[28:29], v[24:25]
    v_pk_fma_f32 v[110:111], v[110:111], s[28:29], v[24:25]
    v_pk_fma_f32 v[112:113], v[112:113], s[28:29], v[24:25]
    s_waitcnt lgkmcnt(8)
    v_mfma_f32_32x32x16_bf16 a[112:127], a[64:67], v[68:71], a[112:127]
    v_pk_fma_f32 v[114:115], v[114:115], s[28:29], v[24:25]
    v_pk_fma_f32 v[116:117], v[116:117], s[28:29], v[24:25]
    v_pk_fma_f32 v[118:119], v[118:119], s[28:29], v[24:25]
    s_add_u32 s31, s30, 3840
    buffer_load_dwordx4 a[188:191], v15, s[8:11], s31 offen offset:64 sc1
    v_pk_fma_f32 v[120:121], v[120:121], s[28:29], v[24:25]
    v_pk_fma_f32 v[122:123], v[122:123], s[28:29], v[24:25]
    v_exp_f32 v108, v108
    v_exp_f32 v109, v109
    v_exp_f32 v110, v110
    v_exp_f32 v111, v111
    v_exp_f32 v112, v112
    v_exp_f32 v113, v113
    v_exp_f32 v114, v114
    v_exp_f32 v115, v115
    buffer_load_dwordx4 v3, s[8:11], s26 offen offset:2048 lds
    v_exp_f32 v116, v116
    v_mfma_f32_32x32x16_bf16 a[112:127], a[68:71], v[72:75], a[112:127]
    v_exp_f32 v117, v117
    v_exp_f32 v118, v118
    v_exp_f32 v119, v119
    v_exp_f32 v120, v120
    v_exp_f32 v121, v121
    v_exp_f32 v122, v122
    v_exp_f32 v123, v123
    v_cvt_pk_bf16_f32 v60, v108, v109
    v_cvt_pk_bf16_f32 v61, v110, v111
    v_cvt_pk_bf16_f32 v62, v112, v113
    v_cvt_pk_bf16_f32 v63, v114, v115
    v_cvt_pk_bf16_f32 v64, v116, v117
    v_cvt_pk_bf16_f32 v65, v118, v119
    buffer_load_dwordx2 a[144:145], v8, s[32:35], s43 offen offset:0
    v_cvt_pk_bf16_f32 v66, v120, v121
    v_cvt_pk_bf16_f32 v67, v122, v123
    ds_read_b64_tr_b16 a[64:65], v17 offset:1024
    ds_read_b64_tr_b16 a[66:67], v17 offset:1088
    ds_read_b64_tr_b16 a[68:69], v17 offset:1152
    ds_read_b64_tr_b16 a[70:71], v17 offset:1216
    v_pk_fma_f32 v[124:125], v[124:125], s[28:29], v[24:25]
    v_pk_fma_f32 v[126:127], v[126:127], s[28:29], v[24:25]
    v_pk_fma_f32 v[128:129], v[128:129], s[28:29], v[24:25]
    s_waitcnt lgkmcnt(8)
    v_mfma_f32_32x32x16_bf16 a[112:127], a[72:75], v[60:63], a[112:127]
    v_pk_fma_f32 v[130:131], v[130:131], s[28:29], v[24:25]
    v_pk_fma_f32 v[132:133], v[132:133], s[28:29], v[24:25]
    v_pk_fma_f32 v[134:135], v[134:135], s[28:29], v[24:25]
    v_pk_fma_f32 v[136:137], v[136:137], s[28:29], v[24:25]
    v_pk_fma_f32 v[138:139], v[138:139], s[28:29], v[24:25]
    v_exp_f32 v124, v124
    v_exp_f32 v125, v125
    v_exp_f32 v126, v126
    v_exp_f32 v127, v127
    v_exp_f32 v128, v128
    buffer_load_dwordx4 v3, s[8:11], s26 offen offset:3072 lds
    v_exp_f32 v129, v129
    v_exp_f32 v130, v130
    v_exp_f32 v131, v131
    buffer_load_dwordx2 a[146:147], v8, s[32:35], s43 offen offset:16
    v_exp_f32 v132, v132
    v_mfma_f32_32x32x16_bf16 a[112:127], a[76:79], v[64:67], a[112:127]
    v_exp_f32 v133, v133
    v_exp_f32 v134, v134
    v_exp_f32 v135, v135
    v_exp_f32 v136, v136
    v_exp_f32 v137, v137
    v_exp_f32 v138, v138
    v_exp_f32 v139, v139
    v_cvt_pk_bf16_f32 v68, v124, v125
    v_cvt_pk_bf16_f32 v69, v126, v127
    v_cvt_pk_bf16_f32 v70, v128, v129
    v_cvt_pk_bf16_f32 v71, v130, v131
    v_cvt_pk_bf16_f32 v72, v132, v133
    v_cvt_pk_bf16_f32 v73, v134, v135
    v_cvt_pk_bf16_f32 v74, v136, v137
    v_cvt_pk_bf16_f32 v75, v138, v139
    ds_read_b64_tr_b16 a[72:73], v17 offset:1280
    ds_read_b64_tr_b16 a[74:75], v17 offset:1344
    ds_read_b64_tr_b16 a[76:77], v17 offset:1408
    ds_read_b64_tr_b16 a[78:79], v17 offset:1472
    v_pk_fma_f32 v[140:141], v[140:141], s[28:29], v[24:25]
    v_pk_fma_f32 v[142:143], v[142:143], s[28:29], v[24:25]
    v_pk_fma_f32 v[144:145], v[144:145], s[28:29], v[24:25]
    s_waitcnt lgkmcnt(8)
    buffer_load_dwordx2 a[148:149], v8, s[32:35], s43 offen offset:32
    v_mfma_f32_32x32x16_bf16 a[112:127], a[56:59], v[68:71], a[112:127]
    v_pk_fma_f32 v[146:147], v[146:147], s[28:29], v[24:25]
    v_pk_fma_f32 v[148:149], v[148:149], s[28:29], v[24:25]
    v_pk_fma_f32 v[150:151], v[150:151], s[28:29], v[24:25]
    v_pk_fma_f32 v[152:153], v[152:153], s[28:29], v[24:25]
    v_pk_fma_f32 v[154:155], v[154:155], s[28:29], v[24:25]
    v_exp_f32 v140, v140
    s_add_u32 m0, s27, 20480
    s_add_u32 s26, s26, 4096
    buffer_load_dwordx4 v3, s[8:11], s26 offen offset:0 lds
    v_exp_f32 v141, v141
    v_exp_f32 v142, v142
    v_exp_f32 v143, v143
    v_exp_f32 v144, v144
    v_exp_f32 v145, v145
    v_exp_f32 v146, v146
    v_exp_f32 v147, v147
    v_exp_f32 v148, v148
    v_mfma_f32_32x32x16_bf16 a[112:127], a[60:63], v[72:75], a[112:127]
    v_exp_f32 v149, v149
    v_exp_f32 v150, v150
    v_exp_f32 v151, v151
    v_exp_f32 v152, v152
    v_exp_f32 v153, v153
    v_exp_f32 v154, v154
    v_exp_f32 v155, v155
    v_cvt_pk_bf16_f32 v60, v140, v141
    v_cvt_pk_bf16_f32 v61, v142, v143
    buffer_load_dwordx2 a[150:151], v8, s[32:35], s43 offen offset:48
    v_cvt_pk_bf16_f32 v62, v144, v145
    v_cvt_pk_bf16_f32 v63, v146, v147
    v_cvt_pk_bf16_f32 v64, v148, v149
    v_cvt_pk_bf16_f32 v65, v150, v151
    v_cvt_pk_bf16_f32 v66, v152, v153
    v_cvt_pk_bf16_f32 v67, v154, v155
    ds_read_b64_tr_b16 a[56:57], v17 offset:1536
    ds_read_b64_tr_b16 a[58:59], v17 offset:1600
    ds_read_b64_tr_b16 a[60:61], v17 offset:1664
    ds_read_b64_tr_b16 a[62:63], v17 offset:1728
    v_pk_fma_f32 v[156:157], v[156:157], s[28:29], v[24:25]
    v_pk_fma_f32 v[158:159], v[158:159], s[28:29], v[24:25]
    v_pk_fma_f32 v[160:161], v[160:161], s[28:29], v[24:25]
    s_waitcnt lgkmcnt(8)
    v_mfma_f32_32x32x16_bf16 a[112:127], a[64:67], v[60:63], a[112:127]
    v_pk_fma_f32 v[162:163], v[162:163], s[28:29], v[24:25]
    v_pk_fma_f32 v[164:165], v[164:165], s[28:29], v[24:25]
    v_pk_fma_f32 v[166:167], v[166:167], s[28:29], v[24:25]
    buffer_load_dwordx4 v3, s[8:11], s26 offen offset:1024 lds
    v_pk_fma_f32 v[168:169], v[168:169], s[28:29], v[24:25]
    v_pk_fma_f32 v[170:171], v[170:171], s[28:29], v[24:25]
    v_exp_f32 v156, v156
    v_exp_f32 v157, v157
    v_exp_f32 v158, v158
    v_exp_f32 v159, v159
    buffer_load_dwordx2 a[152:153], v8, s[32:35], s43 offen offset:64
    v_exp_f32 v160, v160
    v_exp_f32 v161, v161
    v_exp_f32 v162, v162
    v_exp_f32 v163, v163
    v_exp_f32 v164, v164
    v_mfma_f32_32x32x16_bf16 a[112:127], a[68:71], v[64:67], a[112:127]
    v_exp_f32 v165, v165
    v_exp_f32 v166, v166
    v_exp_f32 v167, v167
    v_exp_f32 v168, v168
    v_exp_f32 v169, v169
    v_exp_f32 v170, v170
    v_exp_f32 v171, v171
    v_cvt_pk_bf16_f32 v68, v156, v157
    v_cvt_pk_bf16_f32 v69, v158, v159
    v_cvt_pk_bf16_f32 v70, v160, v161
    v_cvt_pk_bf16_f32 v71, v162, v163
    v_cvt_pk_bf16_f32 v72, v164, v165
    v_cvt_pk_bf16_f32 v73, v166, v167
    v_cvt_pk_bf16_f32 v74, v168, v169
    v_cvt_pk_bf16_f32 v75, v170, v171
    ds_read_b64_tr_b16 a[64:65], v19 offset:0
    ds_read_b64_tr_b16 a[66:67], v19 offset:64
    ds_read_b64_tr_b16 a[68:69], v19 offset:128
    ds_read_b64_tr_b16 a[70:71], v19 offset:192
    buffer_load_dwordx2 a[154:155], v8, s[32:35], s43 offen offset:80
    v_pk_fma_f32 v[172:173], v[172:173], s[28:29], v[24:25]
    v_pk_fma_f32 v[174:175], v[174:175], s[28:29], v[24:25]
    v_pk_fma_f32 v[176:177], v[176:177], s[28:29], v[24:25]
    s_waitcnt lgkmcnt(8)
    buffer_load_dwordx4 v3, s[8:11], s26 offen offset:2048 lds
    v_mfma_f32_32x32x16_bf16 a[112:127], a[72:75], v[68:71], a[112:127]
    v_pk_fma_f32 v[178:179], v[178:179], s[28:29], v[24:25]
    v_pk_fma_f32 v[180:181], v[180:181], s[28:29], v[24:25]
    v_pk_fma_f32 v[182:183], v[182:183], s[28:29], v[24:25]
    v_pk_fma_f32 v[184:185], v[184:185], s[28:29], v[24:25]
    v_pk_fma_f32 v[186:187], v[186:187], s[28:29], v[24:25]
    v_exp_f32 v172, v172
    v_exp_f32 v173, v173
    v_exp_f32 v174, v174
    v_exp_f32 v175, v175
    v_exp_f32 v176, v176
    v_exp_f32 v177, v177
    v_exp_f32 v178, v178
    v_exp_f32 v179, v179
    v_exp_f32 v180, v180
    v_mfma_f32_32x32x16_bf16 a[112:127], a[76:79], v[72:75], a[112:127]
    v_exp_f32 v181, v181
    v_exp_f32 v182, v182
    v_exp_f32 v183, v183
    v_exp_f32 v184, v184
    v_exp_f32 v185, v185
    v_exp_f32 v186, v186
    v_exp_f32 v187, v187
    v_cvt_pk_bf16_f32 v60, v172, v173
    v_cvt_pk_bf16_f32 v61, v174, v175
    v_cvt_pk_bf16_f32 v62, v176, v177
    v_cvt_pk_bf16_f32 v63, v178, v179
    v_cvt_pk_bf16_f32 v64, v180, v181
    v_cvt_pk_bf16_f32 v65, v182, v183
    v_cvt_pk_bf16_f32 v66, v184, v185
    v_cvt_pk_bf16_f32 v67, v186, v187
    ds_read_b64_tr_b16 a[72:73], v19 offset:256
    ds_read_b64_tr_b16 a[74:75], v19 offset:320
    ds_read_b64_tr_b16 a[76:77], v19 offset:384
    ds_read_b64_tr_b16 a[78:79], v19 offset:448
    v_pk_fma_f32 v[188:189], v[188:189], s[28:29], v[26:27]
    buffer_load_dwordx4 v3, s[8:11], s26 offen offset:3072 lds
    v_pk_fma_f32 v[190:191], v[190:191], s[28:29], v[26:27]
    v_pk_fma_f32 v[192:193], v[192:193], s[28:29], v[26:27]
    s_waitcnt lgkmcnt(8)
    v_mfma_f32_32x32x16_bf16 a[112:127], a[56:59], v[60:63], a[112:127]
    v_pk_fma_f32 v[194:195], v[194:195], s[28:29], v[26:27]
    v_pk_fma_f32 v[196:197], v[196:197], s[28:29], v[26:27]
    v_pk_fma_f32 v[198:199], v[198:199], s[28:29], v[26:27]
    v_pk_fma_f32 v[200:201], v[200:201], s[28:29], v[26:27]
    v_pk_fma_f32 v[202:203], v[202:203], s[28:29], v[26:27]
    v_exp_f32 v188, v188
    v_exp_f32 v189, v189
    v_exp_f32 v190, v190
    v_exp_f32 v191, v191
    v_exp_f32 v192, v192
    v_exp_f32 v193, v193
    v_exp_f32 v194, v194
    v_exp_f32 v195, v195
    v_exp_f32 v196, v196
    v_mfma_f32_32x32x16_bf16 a[112:127], a[60:63], v[64:67], a[112:127]
    v_exp_f32 v197, v197
    v_exp_f32 v198, v198
    v_exp_f32 v199, v199
    v_exp_f32 v200, v200
    v_exp_f32 v201, v201
    v_exp_f32 v202, v202
    v_exp_f32 v203, v203
    v_cvt_pk_bf16_f32 v68, v188, v189
    v_cvt_pk_bf16_f32 v69, v190, v191
    v_cvt_pk_bf16_f32 v70, v192, v193
    v_cvt_pk_bf16_f32 v71, v194, v195
    v_cvt_pk_bf16_f32 v72, v196, v197
    v_cvt_pk_bf16_f32 v73, v198, v199
    v_cvt_pk_bf16_f32 v74, v200, v201
    v_cvt_pk_bf16_f32 v75, v202, v203
    v_pk_fma_f32 v[204:205], v[204:205], s[28:29], v[26:27]
    v_pk_fma_f32 v[206:207], v[206:207], s[28:29], v[26:27]
    s_add_u32 m0, s27, 24576
    s_add_u32 s26, s26, 4096
    buffer_load_dwordx4 v3, s[8:11], s26 offen offset:0 lds
    v_pk_fma_f32 v[208:209], v[208:209], s[28:29], v[26:27]
    s_waitcnt lgkmcnt(4)
    v_mfma_f32_32x32x16_bf16 a[128:143], a[64:67], v[68:71], 0
    v_pk_fma_f32 v[210:211], v[210:211], s[28:29], v[26:27]
    v_pk_fma_f32 v[212:213], v[212:213], s[28:29], v[26:27]
    v_pk_fma_f32 v[214:215], v[214:215], s[28:29], v[26:27]
    v_pk_fma_f32 v[216:217], v[216:217], s[28:29], v[26:27]
    v_pk_fma_f32 v[218:219], v[218:219], s[28:29], v[26:27]
    v_exp_f32 v204, v204
    v_exp_f32 v205, v205
    v_exp_f32 v206, v206
    v_exp_f32 v207, v207
    v_exp_f32 v208, v208
    v_exp_f32 v209, v209
    v_exp_f32 v210, v210
    v_exp_f32 v211, v211
    v_exp_f32 v212, v212
    v_mfma_f32_32x32x16_bf16 a[128:143], a[68:71], v[72:75], a[128:143]
    v_exp_f32 v213, v213
    v_exp_f32 v214, v214
    v_exp_f32 v215, v215
    v_exp_f32 v216, v216
    v_exp_f32 v217, v217
    v_exp_f32 v218, v218
    v_exp_f32 v219, v219
    v_cvt_pk_bf16_f32 v60, v204, v205
    v_cvt_pk_bf16_f32 v61, v206, v207
    v_cvt_pk_bf16_f32 v62, v208, v209
    v_cvt_pk_bf16_f32 v63, v210, v211
    v_cvt_pk_bf16_f32 v64, v212, v213
    v_cvt_pk_bf16_f32 v65, v214, v215
    v_cvt_pk_bf16_f32 v66, v216, v217
    v_cvt_pk_bf16_f32 v67, v218, v219
    s_waitcnt lgkmcnt(0)
    v_mfma_f32_32x32x16_bf16 a[128:143], a[72:75], v[60:63], a[128:143]
    v_mfma_f32_32x32x16_bf16 a[128:143], a[76:79], v[64:67], a[128:143]
    v_accvgpr_read_b32 v20, a88
    v_accvgpr_read_b32 v21, a120
    v_fma_f32 v20, v20, v222, v21
    v_mov_b32 v21, v20
    s_nop 1
    v_permlane32_swap_b32 v20, v21
    v_rcp_f32 v21, v21
    s_nop 0
    v_mul_f32 v222, v222, v21
    v_accvgpr_read_b32 v22, a112
    v_accvgpr_read_b32 v23, a113
    v_accvgpr_read_b32 v9, a80
    v_accvgpr_read_b32 v10, a81
    v_mul_f32 v22, v22, v21
    v_mul_f32 v23, v23, v21
    v_fma_f32 v22, v9, v222, v22
    v_fma_f32 v23, v10, v222, v23
    v_cvt_pk_bf16_f32 v240, v22, v23
    v_accvgpr_read_b32 v22, a114
    v_accvgpr_read_b32 v23, a115
    v_accvgpr_read_b32 v9, a82
    v_accvgpr_read_b32 v10, a83
    v_mul_f32 v22, v22, v21
    v_mul_f32 v23, v23, v21
    v_fma_f32 v22, v9, v222, v22
    v_fma_f32 v23, v10, v222, v23
    v_cvt_pk_bf16_f32 v241, v22, v23
    v_accvgpr_read_b32 v22, a116
    v_accvgpr_read_b32 v23, a117
    v_accvgpr_read_b32 v9, a84
    v_accvgpr_read_b32 v10, a85
    v_mul_f32 v22, v22, v21
    v_mul_f32 v23, v23, v21
    v_fma_f32 v22, v9, v222, v22
    v_fma_f32 v23, v10, v222, v23
    v_cvt_pk_bf16_f32 v242, v22, v23
    v_accvgpr_read_b32 v22, a118
    v_accvgpr_read_b32 v23, a119
    v_accvgpr_read_b32 v9, a86
    v_accvgpr_read_b32 v10, a87
    v_mul_f32 v22, v22, v21
    v_mul_f32 v23, v23, v21
    v_fma_f32 v22, v9, v222, v22
    v_fma_f32 v23, v10, v222, v23
    v_cvt_pk_bf16_f32 v243, v22, v23
    v_accvgpr_read_b32 v22, a120
    v_accvgpr_read_b32 v23, a121
    v_accvgpr_read_b32 v9, a88
    v_accvgpr_read_b32 v10, a89
    v_mul_f32 v22, v22, v21
    v_mul_f32 v23, v23, v21
    v_fma_f32 v22, v9, v222, v22
    v_fma_f32 v23, v10, v222, v23
    v_cvt_pk_bf16_f32 v244, v22, v23
    v_accvgpr_read_b32 v22, a122
    v_accvgpr_read_b32 v23, a123
    v_accvgpr_read_b32 v9, a90
    v_accvgpr_read_b32 v10, a91
    v_mul_f32 v22, v22, v21
    v_mul_f32 v23, v23, v21
    v_fma_f32 v22, v9, v222, v22
    v_fma_f32 v23, v10, v222, v23
    v_cvt_pk_bf16_f32 v245, v22, v23
    v_accvgpr_read_b32 v20, a104
    v_accvgpr_read_b32 v21, a136
    v_fma_f32 v20, v20, v223, v21
    v_mov_b32 v21, v20
    s_nop 1
    v_permlane32_swap_b32 v20, v21
    v_rcp_f32 v21, v21
    s_nop 0
    v_mul_f32 v223, v223, v21
    v_accvgpr_read_b32 v22, a128
    v_accvgpr_read_b32 v23, a129
    v_accvgpr_read_b32 v9, a96
    v_accvgpr_read_b32 v10, a97
    v_mul_f32 v22, v22, v21
    v_mul_f32 v23, v23, v21
    v_fma_f32 v22, v9, v223, v22
    v_fma_f32 v23, v10, v223, v23
    v_cvt_pk_bf16_f32 v246, v22, v23
    v_accvgpr_read_b32 v22, a130
    v_accvgpr_read_b32 v23, a131
    v_accvgpr_read_b32 v9, a98
    v_accvgpr_read_b32 v10, a99
    v_mul_f32 v22, v22, v21
    v_mul_f32 v23, v23, v21
    v_fma_f32 v22, v9, v223, v22
    v_fma_f32 v23, v10, v223, v23
    v_cvt_pk_bf16_f32 v247, v22, v23
    v_accvgpr_read_b32 v22, a132
    v_accvgpr_read_b32 v23, a133
    v_accvgpr_read_b32 v9, a100
    v_accvgpr_read_b32 v10, a101
    v_mul_f32 v22, v22, v21
    v_mul_f32 v23, v23, v21
    v_fma_f32 v22, v9, v223, v22
    v_fma_f32 v23, v10, v223, v23
    v_cvt_pk_bf16_f32 v248, v22, v23
    v_accvgpr_read_b32 v22, a134
    v_accvgpr_read_b32 v23, a135
    v_accvgpr_read_b32 v9, a102
    v_accvgpr_read_b32 v10, a103
    v_mul_f32 v22, v22, v21
    v_mul_f32 v23, v23, v21
    v_fma_f32 v22, v9, v223, v22
    v_fma_f32 v23, v10, v223, v23
    v_cvt_pk_bf16_f32 v249, v22, v23
    v_accvgpr_read_b32 v22, a136
    v_accvgpr_read_b32 v23, a137
    v_accvgpr_read_b32 v9, a104
    v_accvgpr_read_b32 v10, a105
    v_mul_f32 v22, v22, v21
    v_mul_f32 v23, v23, v21
    v_fma_f32 v22, v9, v223, v22
    v_fma_f32 v23, v10, v223, v23
    v_cvt_pk_bf16_f32 v250, v22, v23
    v_accvgpr_read_b32 v22, a138
    v_accvgpr_read_b32 v23, a139
    v_accvgpr_read_b32 v9, a106
    v_accvgpr_read_b32 v10, a107
    v_mul_f32 v22, v22, v21
    v_mul_f32 v23, v23, v21
    v_fma_f32 v22, v9, v223, v22
    v_fma_f32 v23, v10, v223, v23
    v_cvt_pk_bf16_f32 v251, v22, v23
    s_branch AT_END_52
AT_W2_55:
    ds_read_b64 a[32:33], v16 offset:1536
    ds_read_b64 a[34:35], v16 offset:9728
    ds_read_b64 a[36:37], v16 offset:17920
    ds_read_b64 a[40:41], v16 offset:1792
    ds_read_b64 a[42:43], v16 offset:9984
    ds_read_b64 a[44:45], v16 offset:18176
    ds_read_b64 a[48:49], v18 offset:768
    ds_read_b64 a[50:51], v18 offset:8960
    ds_read_b64 a[52:53], v18 offset:17152
    s_waitcnt lgkmcnt(6)
    v_mfma_f32_32x32x16_bf16 v[76:91], a[32:35], v[224:227], 0
    v_cmp_gt_i32 vcc, 0, v13
    v_cmp_gt_i32 s[20:21], 1, v13
    v_cmp_gt_i32 s[22:23], 2, v13
    v_cndmask_b32_e64 v28, v220, 0, vcc
    v_cndmask_b32_e64 v44, 0, v220, vcc
    v_mfma_f32_32x32x16_bf16 v[76:91], a[36:39], v[228:231], v[76:91]
    v_cmp_gt_i32 vcc, 3, v13
    v_cndmask_b32_e64 v29, v220, 0, s[20:21]
    v_cndmask_b32_e64 v45, 0, v220, s[20:21]
    v_cmp_gt_i32 s[20:21], 8, v13
    v_cndmask_b32_e64 v30, v220, 0, s[22:23]
    v_cndmask_b32_e64 v46, 0, v220, s[22:23]
    ds_read_b64 a[32:33], v18 offset:1024
    ds_read_b64 a[34:35], v18 offset:9216
    ds_read_b64 a[36:37], v18 offset:17408
    s_waitcnt lgkmcnt(6)
    v_mfma_f32_32x32x16_bf16 v[92:107], a[40:43], v[224:227], 0
    v_cmp_gt_i32 s[22:23], 9, v13
    v_cndmask_b32_e64 v31, v220, 0, vcc
    v_cndmask_b32_e64 v47, 0, v220, vcc
    v_cmp_gt_i32 vcc, 10, v13
    v_cndmask_b32_e64 v32, v220, 0, s[20:21]
    v_mfma_f32_32x32x16_bf16 v[92:107], a[44:47], v[228:231], v[92:107]
    v_cndmask_b32_e64 v48, 0, v220, s[20:21]
    v_cmp_gt_i32 s[20:21], 11, v13
    v_cndmask_b32_e64 v33, v220, 0, s[22:23]
    v_cndmask_b32_e64 v49, 0, v220, s[22:23]
    v_cmp_gt_i32 s[22:23], 16, v13
    v_cndmask_b32_e64 v34, v220, 0, vcc
    ds_read_b64 a[40:41], v18 offset:1280
    ds_read_b64 a[42:43], v18 offset:9472
    ds_read_b64 a[44:45], v18 offset:17664
    s_waitcnt lgkmcnt(6)
    v_mfma_f32_32x32x16_bf16 v[124:139], a[48:51], v[232:235], 0
    v_cndmask_b32_e64 v50, 0, v220, vcc
    v_cmp_gt_i32 vcc, 17, v13
    v_cndmask_b32_e64 v35, v220, 0, s[20:21]
    v_cndmask_b32_e64 v51, 0, v220, s[20:21]
    v_cmp_gt_i32 s[20:21], 18, v13
    v_mfma_f32_32x32x16_bf16 v[124:139], a[52:55], v[236:239], v[124:139]
    v_cndmask_b32_e64 v36, v220, 0, s[22:23]
    v_cndmask_b32_e64 v52, 0, v220, s[22:23]
    v_cmp_gt_i32 s[22:23], 19, v13
    v_cndmask_b32_e64 v37, v220, 0, vcc
    v_cndmask_b32_e64 v53, 0, v220, vcc
    v_cmp_gt_i32 vcc, 24, v13
    ds_read_b64 a[48:49], v18 offset:1536
    ds_read_b64 a[50:51], v18 offset:9728
    ds_read_b64 a[52:53], v18 offset:17920
    s_waitcnt lgkmcnt(6)
    v_mfma_f32_32x32x16_bf16 v[140:155], a[32:35], v[232:235], 0
    v_cndmask_b32_e64 v38, v220, 0, s[20:21]
    v_cndmask_b32_e64 v54, 0, v220, s[20:21]
    v_cmp_gt_i32 s[20:21], 25, v13
    v_cndmask_b32_e64 v39, v220, 0, s[22:23]
    v_cndmask_b32_e64 v55, 0, v220, s[22:23]
    v_mfma_f32_32x32x16_bf16 v[140:155], a[36:39], v[236:239], v[140:155]
    v_cmp_gt_i32 s[22:23], 26, v13
    v_cndmask_b32_e64 v40, v220, 0, vcc
    v_cndmask_b32_e64 v56, 0, v220, vcc
    v_cmp_gt_i32 vcc, 27, v13
    v_cndmask_b32_e64 v41, v220, 0, s[20:21]
    v_cndmask_b32_e64 v57, 0, v220, s[20:21]
    ds_read_b64 a[32:33], v18 offset:1792
    ds_read_b64 a[34:35], v18 offset:9984
    ds_read_b64 a[36:37], v18 offset:18176
    s_waitcnt lgkmcnt(6)
    v_mfma_f32_32x32x16_bf16 v[156:171], a[40:43], v[232:235], 0
    v_cndmask_b32_e64 v42, v220, 0, s[22:23]
    v_cndmask_b32_e64 v58, 0, v220, s[22:23]
    v_cndmask_b32_e64 v43, v220, 0, vcc
    v_cndmask_b32_e64 v59, 0, v220, vcc
    v_max3_f32 v20, v76, v77, v78
    v_mfma_f32_32x32x16_bf16 v[156:171], a[44:47], v[236:239], v[156:171]
    v_max3_f32 v21, v79, v80, v81
    v_max3_f32 v20, v20, v82, v83
    v_max3_f32 v21, v21, v84, v85
    v_max3_f32 v20, v20, v86, v87
    v_max3_f32 v21, v21, v88, v89
    v_max3_f32 v20, v20, v90, v91
    ds_read_b64 a[40:41], v16 offset:2048
    ds_read_b64 a[42:43], v16 offset:10240
    ds_read_b64 a[44:45], v16 offset:18432
    s_waitcnt lgkmcnt(6)
    v_mfma_f32_32x32x16_bf16 v[172:187], a[48:51], v[232:235], 0
    v_max3_f32 v20, v20, v92, v93
    v_max3_f32 v21, v21, v94, v95
    v_max3_f32 v20, v20, v96, v97
    v_max3_f32 v21, v21, v98, v99
    v_max3_f32 v20, v20, v100, v101
    v_mfma_f32_32x32x16_bf16 v[172:187], a[52:55], v[236:239], v[172:187]
    v_max3_f32 v21, v21, v102, v103
    v_max3_f32 v20, v20, v104, v105
    v_max3_f32 v21, v21, v106, v107
    v_max3_f32 v22, v124, v125, v126
    v_max3_f32 v23, v127, v128, v129
    v_max3_f32 v22, v22, v130, v131
    ds_read_b64 a[48:49], v18 offset:2048
    ds_read_b64 a[50:51], v18 offset:10240
    ds_read_b64 a[52:53], v18 offset:18432
    s_waitcnt lgkmcnt(6)
    v_mfma_f32_32x32x16_bf16 v[188:203], a[32:35], v[232:235], 0
    v_max3_f32 v23, v23, v132, v133
    v_max3_f32 v22, v22, v134, v135
    v_max3_f32 v23, v23, v136, v137
    v_max3_f32 v22, v22, v138, v139
    v_max3_f32 v22, v22, v140, v141
    v_mfma_f32_32x32x16_bf16 v[188:203], a[36:39], v[236:239], v[188:203]
    v_max3_f32 v23, v23, v142, v143
    v_max3_f32 v22, v22, v144, v145
    v_max3_f32 v23, v23, v146, v147
    v_max3_f32 v22, v22, v148, v149
    v_max3_f32 v23, v23, v150, v151
    v_max3_f32 v22, v22, v152, v153
    s_waitcnt lgkmcnt(3)
    v_mfma_f32_32x32x16_bf16 v[108:123], a[40:43], v[224:227], v[44:59]
    v_max3_f32 v23, v23, v154, v155
    v_max3_f32 v22, v22, v156, v157
    v_max3_f32 v23, v23, v158, v159
    v_max3_f32 v22, v22, v160, v161
    v_max3_f32 v23, v23, v162, v163
    v_mfma_f32_32x32x16_bf16 v[108:123], a[44:47], v[228:231], v[108:123]
    v_max3_f32 v22, v22, v164, v165
    v_max3_f32 v23, v23, v166, v167
    v_max3_f32 v22, v22, v168, v169
    v_max3_f32 v23, v23, v170, v171
    v_max3_f32 v22, v22, v172, v173
    v_max3_f32 v23, v23, v174, v175
    s_waitcnt lgkmcnt(0)
    v_mfma_f32_32x32x16_bf16 v[204:219], a[48:51], v[232:235], v[44:59]
    v_max3_f32 v22, v22, v176, v177
    v_max3_f32 v23, v23, v178, v179
    v_max3_f32 v22, v22, v180, v181
    v_max3_f32 v23, v23, v182, v183
    v_max3_f32 v22, v22, v184, v185
    v_mfma_f32_32x32x16_bf16 v[204:219], a[52:55], v[236:239], v[204:219]
    v_max3_f32 v23, v23, v186, v187
    v_max3_f32 v22, v22, v188, v189
    v_max3_f32 v23, v23, v190, v191
    v_max3_f32 v22, v22, v192, v193
    v_max3_f32 v23, v23, v194, v195
    v_max3_f32 v22, v22, v196, v197
    ds_read_b64_tr_b16 a[56:57], v17 offset:1536
    ds_read_b64_tr_b16 a[58:59], v17 offset:1600
    ds_read_b64_tr_b16 a[60:61], v17 offset:1664
    ds_read_b64_tr_b16 a[62:63], v17 offset:1728
    v_max3_f32 v23, v23, v198, v199
    v_max3_f32 v22, v22, v200, v201
    v_max3_f32 v23, v23, v202, v203
    v_max3_f32 v20, v20, v108, v109
    v_max3_f32 v21, v21, v110, v111
    v_max3_f32 v20, v20, v112, v113
    v_max3_f32 v21, v21, v114, v115
    v_max3_f32 v20, v20, v116, v117
    v_max3_f32 v21, v21, v118, v119
    v_max3_f32 v20, v20, v120, v121
    v_max3_f32 v21, v21, v122, v123
    v_max3_f32 v22, v22, v204, v205
    v_max3_f32 v23, v23, v206, v207
    v_max3_f32 v22, v22, v208, v209
    v_max3_f32 v23, v23, v210, v211
    v_max3_f32 v22, v22, v212, v213
    v_max3_f32 v23, v23, v214, v215
    v_max3_f32 v22, v22, v216, v217
    v_max3_f32 v23, v23, v218, v219
    v_max_f32 v20, v20, v21
    v_mov_b32 v21, v20
    s_nop 1
    v_permlane32_swap_b32 v20, v21
    v_max_f32 v20, v20, v21
    v_mov_b32 v252, v20
    v_mul_f32 v24, 0xbea52b5c, v20
    v_mov_b32 v25, v24
    v_max_f32 v22, v22, v23
    v_mov_b32 v23, v22
    s_nop 1
    v_permlane32_swap_b32 v22, v23
    v_max_f32 v22, v22, v23
    v_mov_b32 v253, v22
    v_mul_f32 v26, 0xbea52b5c, v22
    v_mov_b32 v27, v26
    s_waitcnt vmcnt(0)
    s_barrier
    ds_read_b64_tr_b16 a[64:65], v17 offset:1792
    ds_read_b64_tr_b16 a[66:67], v17 offset:1856
    ds_read_b64_tr_b16 a[68:69], v17 offset:1920
    ds_read_b64_tr_b16 a[70:71], v17 offset:1984
    v_pk_fma_f32 v[76:77], v[76:77], s[28:29], v[24:25]
    v_pk_fma_f32 v[78:79], v[78:79], s[28:29], v[24:25]
    v_pk_fma_f32 v[80:81], v[80:81], s[28:29], v[24:25]
    v_pk_fma_f32 v[82:83], v[82:83], s[28:29], v[24:25]
    v_pk_fma_f32 v[84:85], v[84:85], s[28:29], v[24:25]
    v_pk_fma_f32 v[86:87], v[86:87], s[28:29], v[24:25]
    v_pk_fma_f32 v[88:89], v[88:89], s[28:29], v[24:25]
    v_pk_fma_f32 v[90:91], v[90:91], s[28:29], v[24:25]
    v_exp_f32 v76, v76
    v_exp_f32 v77, v77
    v_exp_f32 v78, v78
    v_exp_f32 v79, v79
    v_exp_f32 v80, v80
    v_exp_f32 v81, v81
    v_exp_f32 v82, v82
    v_exp_f32 v83, v83
    v_exp_f32 v84, v84
    v_exp_f32 v85, v85
    v_exp_f32 v86, v86
    v_exp_f32 v87, v87
    v_exp_f32 v88, v88
    v_exp_f32 v89, v89
    v_exp_f32 v90, v90
    v_exp_f32 v91, v91
    v_cvt_pk_bf16_f32 v60, v76, v77
    v_cvt_pk_bf16_f32 v61, v78, v79
    v_cvt_pk_bf16_f32 v62, v80, v81
    v_cvt_pk_bf16_f32 v63, v82, v83
    v_cvt_pk_bf16_f32 v64, v84, v85
    v_cvt_pk_bf16_f32 v65, v86, v87
    v_cvt_pk_bf16_f32 v66, v88, v89
    v_cvt_pk_bf16_f32 v67, v90, v91
    s_lshl_b32 s19, s12, 3
    s_add_u32 s20, s19, s3
    s_sub_u32 s21, 7, s3
    s_add_u32 s21, s21, s19
    s_mul_i32 s20, s20, 40960
    s_mul_i32 s21, s21, 40960
    s_lshl_b32 s22, s13, 10
    s_add_u32 s22, s22, 1048576
    s_add_u32 s36, s20, s22
    s_add_u32 s37, s21, s22
    s_lshr_b32 s23, s13, 2
    s_add_u32 s23, s23, 32
    s_lshl_b32 s23, s23, 10
    s_bfe_u32 s22, s13, 0x10001
    s_lshl_b32 s22, s22, 9
    s_add_u32 s23, s23, s22
    s_and_b32 s22, s13, 1
    s_lshl_b32 s22, s22, 3
    s_add_u32 s23, s23, s22
    s_add_u32 s23, s23, 1048576
    s_add_u32 s38, s20, s23
    s_add_u32 s39, s21, s23
    s_lshr_b32 s26, s13, 2
    s_mul_i32 s26, s26, 102400
    s_mul_i32 s27, s3, 25600
    s_add_u32 s26, s26, s27
    s_add_u32 s26, s26, 41943040
    s_add_u32 s19, s12, 7
    s_and_b32 s19, s19, 7
    s_mul_i32 s19, s19, 786432
    s_add_u32 s19, s19, 8388608
    s_mul_i32 s20, s13, 24576
    s_mul_i32 s21, s3, 6144
    s_add_u32 s20, s20, s21
    s_add_u32 s20, s20, s19
    s_lshl_b32 s21, s13, 12
    s_lshl_b32 s22, s3, 10
    s_add_u32 s21, s21, s22
    s_add_u32 s21, s21, s19
    s_add_u32 s21, s21, 655360
    s_cmp_eq_u32 s12, 0
    s_cselect_b32 s16, s20, s21
    s_cselect_b32 s25, 48, 8
    s_lshl_b32 s22, s12, 15
    s_lshl_b32 s23, s13, 10
    s_add_u32 s22, s22, s23
    s_lshl_b32 s23, s3, 8
    s_add_u32 s22, s22, s23
    s_add_u32 s17, s22, 65536
    v_lshlrev_b32 v4, 7, v2
    s_mov_b32 s32, s40
    s_mov_b32 s33, s41
    s_mov_b32 s34, 2621440
    s_mov_b32 s35, 0x20000
    s_lshl_b32 s19, s12, 8
    s_and_b32 s20, s13, 3
    s_lshl_b32 s20, s20, 6
    s_add_u32 s19, s19, s20
    s_and_b32 s20, s3, 1
    s_lshl_b32 s20, s20, 5
    s_add_u32 s19, s19, s20
    v_and_b32 v8, 31, v2
    v_add_u32 v8, s19, v8
    v_mul_u32_u24 v8, 1280, v8
    v_lshrrev_b32 v14, 5, v2
    v_lshl_add_u32 v8, v14, 3, v8
    s_lshr_b32 s19, s13, 2
    s_mul_i32 s19, s19, 5
    s_lshr_b32 s20, s3, 1
    s_mul_i32 s20, s20, 3
    s_add_u32 s19, s19, s20
    s_lshl_b32 s43, s19, 5
    s_lshl_b32 s30, s12, 13
    s_add_u32 s30, s30, s43
    s_add_u32 s30, s30, 458752
    v_lshlrev_b32 v15, 4, v14
    ds_read_b64_tr_b16 a[72:73], v17 offset:2048
    ds_read_b64_tr_b16 a[74:75], v17 offset:2112
    ds_read_b64_tr_b16 a[76:77], v17 offset:2176
    ds_read_b64_tr_b16 a[78:79], v17 offset:2240
    v_pk_fma_f32 v[92:93], v[92:93], s[28:29], v[24:25]
    v_pk_fma_f32 v[94:95], v[94:95], s[28:29], v[24:25]
    v_pk_fma_f32 v[96:97], v[96:97], s[28:29], v[24:25]
    s_waitcnt lgkmcnt(8)
    v_mfma_f32_32x32x16_bf16 a[80:95], a[56:59], v[60:63], 0
    v_pk_fma_f32 v[98:99], v[98:99], s[28:29], v[24:25]
    v_pk_fma_f32 v[100:101], v[100:101], s[28:29], v[24:25]
    v_pk_fma_f32 v[102:103], v[102:103], s[28:29], v[24:25]
    v_pk_fma_f32 v[104:105], v[104:105], s[28:29], v[24:25]
    v_pk_fma_f32 v[106:107], v[106:107], s[28:29], v[24:25]
    v_exp_f32 v92, v92
    v_exp_f32 v93, v93
    v_exp_f32 v94, v94
    v_exp_f32 v95, v95
    v_exp_f32 v96, v96
    v_exp_f32 v97, v97
    v_exp_f32 v98, v98
    v_exp_f32 v99, v99
    v_exp_f32 v100, v100
    v_mfma_f32_32x32x16_bf16 a[80:95], a[60:63], v[64:67], a[80:95]
    v_exp_f32 v101, v101
    v_exp_f32 v102, v102
    v_exp_f32 v103, v103
    v_exp_f32 v104, v104
    v_exp_f32 v105, v105
    v_exp_f32 v106, v106
    v_exp_f32 v107, v107
    v_cvt_pk_bf16_f32 v68, v92, v93
    v_cvt_pk_bf16_f32 v69, v94, v95
    v_cvt_pk_bf16_f32 v70, v96, v97
    v_cvt_pk_bf16_f32 v71, v98, v99
    v_cvt_pk_bf16_f32 v72, v100, v101
    v_cvt_pk_bf16_f32 v73, v102, v103
    v_cvt_pk_bf16_f32 v74, v104, v105
    v_cvt_pk_bf16_f32 v75, v106, v107
    ds_read_b64_tr_b16 a[56:57], v19 offset:768
    ds_read_b64_tr_b16 a[58:59], v19 offset:832
    ds_read_b64_tr_b16 a[60:61], v19 offset:896
    ds_read_b64_tr_b16 a[62:63], v19 offset:960
    v_pk_fma_f32 v[108:109], v[108:109], s[28:29], v[24:25]
    v_pk_fma_f32 v[110:111], v[110:111], s[28:29], v[24:25]
    v_pk_fma_f32 v[112:113], v[112:113], s[28:29], v[24:25]
    s_waitcnt lgkmcnt(8)
    v_mfma_f32_32x32x16_bf16 a[80:95], a[64:67], v[68:71], a[80:95]
    v_pk_fma_f32 v[114:115], v[114:115], s[28:29], v[24:25]
    v_pk_fma_f32 v[116:117], v[116:117], s[28:29], v[24:25]
    v_pk_fma_f32 v[118:119], v[118:119], s[28:29], v[24:25]
    v_pk_fma_f32 v[120:121], v[120:121], s[28:29], v[24:25]
    v_pk_fma_f32 v[122:123], v[122:123], s[28:29], v[24:25]
    v_exp_f32 v108, v108
    v_exp_f32 v109, v109
    v_exp_f32 v110, v110
    v_exp_f32 v111, v111
    v_exp_f32 v112, v112
    v_exp_f32 v113, v113
    v_exp_f32 v114, v114
    v_exp_f32 v115, v115
    v_exp_f32 v116, v116
    v_mfma_f32_32x32x16_bf16 a[80:95], a[68:71], v[72:75], a[80:95]
    v_exp_f32 v117, v117
    v_exp_f32 v118, v118
    v_exp_f32 v119, v119
    v_exp_f32 v120, v120
    v_exp_f32 v121, v121
    v_exp_f32 v122, v122
    v_exp_f32 v123, v123
    v_cvt_pk_bf16_f32 v60, v108, v109
    v_cvt_pk_bf16_f32 v61, v110, v111
    v_cvt_pk_bf16_f32 v62, v112, v113
    v_cvt_pk_bf16_f32 v63, v114, v115
    v_cvt_pk_bf16_f32 v64, v116, v117
    v_cvt_pk_bf16_f32 v65, v118, v119
    v_cvt_pk_bf16_f32 v66, v120, v121
    v_cvt_pk_bf16_f32 v67, v122, v123
    ds_read_b64_tr_b16 a[64:65], v19 offset:1024
    ds_read_b64_tr_b16 a[66:67], v19 offset:1088
    ds_read_b64_tr_b16 a[68:69], v19 offset:1152
    ds_read_b64_tr_b16 a[70:71], v19 offset:1216
    v_pk_fma_f32 v[124:125], v[124:125], s[28:29], v[26:27]
    v_pk_fma_f32 v[126:127], v[126:127], s[28:29], v[26:27]
    v_pk_fma_f32 v[128:129], v[128:129], s[28:29], v[26:27]
    s_waitcnt lgkmcnt(8)
    v_mfma_f32_32x32x16_bf16 a[80:95], a[72:75], v[60:63], a[80:95]
    v_pk_fma_f32 v[130:131], v[130:131], s[28:29], v[26:27]
    v_pk_fma_f32 v[132:133], v[132:133], s[28:29], v[26:27]
    v_pk_fma_f32 v[134:135], v[134:135], s[28:29], v[26:27]
    v_pk_fma_f32 v[136:137], v[136:137], s[28:29], v[26:27]
    v_pk_fma_f32 v[138:139], v[138:139], s[28:29], v[26:27]
    v_exp_f32 v124, v124
    v_exp_f32 v125, v125
    v_exp_f32 v126, v126
    v_exp_f32 v127, v127
    v_exp_f32 v128, v128
    v_exp_f32 v129, v129
    v_exp_f32 v130, v130
    v_exp_f32 v131, v131
    v_exp_f32 v132, v132
    v_mfma_f32_32x32x16_bf16 a[80:95], a[76:79], v[64:67], a[80:95]
    v_exp_f32 v133, v133
    v_exp_f32 v134, v134
    v_exp_f32 v135, v135
    v_exp_f32 v136, v136
    v_exp_f32 v137, v137
    v_exp_f32 v138, v138
    v_exp_f32 v139, v139
    v_cvt_pk_bf16_f32 v68, v124, v125
    v_cvt_pk_bf16_f32 v69, v126, v127
    v_cvt_pk_bf16_f32 v70, v128, v129
    v_cvt_pk_bf16_f32 v71, v130, v131
    v_cvt_pk_bf16_f32 v72, v132, v133
    v_cvt_pk_bf16_f32 v73, v134, v135
    v_cvt_pk_bf16_f32 v74, v136, v137
    v_cvt_pk_bf16_f32 v75, v138, v139
    ds_read_b64_tr_b16 a[72:73], v19 offset:1280
    ds_read_b64_tr_b16 a[74:75], v19 offset:1344
    ds_read_b64_tr_b16 a[76:77], v19 offset:1408
    ds_read_b64_tr_b16 a[78:79], v19 offset:1472
    v_pk_fma_f32 v[140:141], v[140:141], s[28:29], v[26:27]
    v_pk_fma_f32 v[142:143], v[142:143], s[28:29], v[26:27]
    v_pk_fma_f32 v[144:145], v[144:145], s[28:29], v[26:27]
    s_waitcnt lgkmcnt(8)
    v_mfma_f32_32x32x16_bf16 a[96:111], a[56:59], v[68:71], 0
    v_pk_fma_f32 v[146:147], v[146:147], s[28:29], v[26:27]
    v_pk_fma_f32 v[148:149], v[148:149], s[28:29], v[26:27]
    v_pk_fma_f32 v[150:151], v[150:151], s[28:29], v[26:27]
    v_pk_fma_f32 v[152:153], v[152:153], s[28:29], v[26:27]
    v_pk_fma_f32 v[154:155], v[154:155], s[28:29], v[26:27]
    v_exp_f32 v140, v140
    v_exp_f32 v141, v141
    v_exp_f32 v142, v142
    v_exp_f32 v143, v143
    v_exp_f32 v144, v144
    v_exp_f32 v145, v145
    v_exp_f32 v146, v146
    v_exp_f32 v147, v147
    v_exp_f32 v148, v148
    v_mfma_f32_32x32x16_bf16 a[96:111], a[60:63], v[72:75], a[96:111]
    v_exp_f32 v149, v149
    v_exp_f32 v150, v150
    v_exp_f32 v151, v151
    v_exp_f32 v152, v152
    v_exp_f32 v153, v153
    v_exp_f32 v154, v154
    v_exp_f32 v155, v155
    v_cvt_pk_bf16_f32 v60, v140, v141
    v_cvt_pk_bf16_f32 v61, v142, v143
    v_cvt_pk_bf16_f32 v62, v144, v145
    v_cvt_pk_bf16_f32 v63, v146, v147
    v_cvt_pk_bf16_f32 v64, v148, v149
    v_cvt_pk_bf16_f32 v65, v150, v151
    v_cvt_pk_bf16_f32 v66, v152, v153
    v_cvt_pk_bf16_f32 v67, v154, v155
    ds_read_b64_tr_b16 a[56:57], v19 offset:1536
    ds_read_b64_tr_b16 a[58:59], v19 offset:1600
    ds_read_b64_tr_b16 a[60:61], v19 offset:1664
    ds_read_b64_tr_b16 a[62:63], v19 offset:1728
    v_pk_fma_f32 v[156:157], v[156:157], s[28:29], v[26:27]
    v_pk_fma_f32 v[158:159], v[158:159], s[28:29], v[26:27]
    v_pk_fma_f32 v[160:161], v[160:161], s[28:29], v[26:27]
    s_waitcnt lgkmcnt(8)
    v_mfma_f32_32x32x16_bf16 a[96:111], a[64:67], v[60:63], a[96:111]
    v_pk_fma_f32 v[162:163], v[162:163], s[28:29], v[26:27]
    v_pk_fma_f32 v[164:165], v[164:165], s[28:29], v[26:27]
    v_pk_fma_f32 v[166:167], v[166:167], s[28:29], v[26:27]
    v_pk_fma_f32 v[168:169], v[168:169], s[28:29], v[26:27]
    v_pk_fma_f32 v[170:171], v[170:171], s[28:29], v[26:27]
    v_exp_f32 v156, v156
    v_exp_f32 v157, v157
    v_exp_f32 v158, v158
    v_exp_f32 v159, v159
    v_exp_f32 v160, v160
    v_exp_f32 v161, v161
    v_exp_f32 v162, v162
    v_exp_f32 v163, v163
    v_exp_f32 v164, v164
    v_mfma_f32_32x32x16_bf16 a[96:111], a[68:71], v[64:67], a[96:111]
    v_exp_f32 v165, v165
    v_exp_f32 v166, v166
    v_exp_f32 v167, v167
    v_exp_f32 v168, v168
    v_exp_f32 v169, v169
    v_exp_f32 v170, v170
    v_exp_f32 v171, v171
    v_cvt_pk_bf16_f32 v68, v156, v157
    v_cvt_pk_bf16_f32 v69, v158, v159
    v_cvt_pk_bf16_f32 v70, v160, v161
    v_cvt_pk_bf16_f32 v71, v162, v163
    v_cvt_pk_bf16_f32 v72, v164, v165
    v_cvt_pk_bf16_f32 v73, v166, v167
    v_cvt_pk_bf16_f32 v74, v168, v169
    v_cvt_pk_bf16_f32 v75, v170, v171
    s_barrier
    s_cmp_eq_u32 s12, 0
    s_cbranch_scc1 AT_NH_61
    s_sub_u32 s22, s24, 776192
    s_mov_b32 m0, 138752
    s_nop 0
    buffer_load_dwordx4 v3, s[8:11], s22 offen sc1 lds
    s_mov_b32 m0, 139776
    s_add_u32 s22, s22, 1024
    buffer_load_dwordx4 v3, s[8:11], s22 offen sc1 lds
    s_mov_b32 m0, 142880
    s_add_u32 s22, s22, 1024
    buffer_load_dwordx4 v3, s[8:11], s22 offen sc1 lds
    s_mov_b32 m0, 143904
    s_add_u32 s22, s22, 1024
    buffer_load_dwordx4 v3, s[8:11], s22 offen sc1 lds
    s_mov_b32 m0, 147008
    s_add_u32 s22, s22, 1024
    buffer_load_dwordx4 v3, s[8:11], s22 offen sc1 lds
AT_NH_61:
    ds_read_b64_tr_b16 a[64:65], v19 offset:1792
    ds_read_b64_tr_b16 a[66:67], v19 offset:1856
    ds_read_b64_tr_b16 a[68:69], v19 offset:1920
    ds_read_b64_tr_b16 a[70:71], v19 offset:1984
    v_pk_fma_f32 v[172:173], v[172:173], s[28:29], v[26:27]
    v_pk_fma_f32 v[174:175], v[174:175], s[28:29], v[26:27]
    v_pk_fma_f32 v[176:177], v[176:177], s[28:29], v[26:27]
    s_waitcnt lgkmcnt(8)
    v_mfma_f32_32x32x16_bf16 a[96:111], a[72:75], v[68:71], a[96:111]
    v_pk_fma_f32 v[178:179], v[178:179], s[28:29], v[26:27]
    v_pk_fma_f32 v[180:181], v[180:181], s[28:29], v[26:27]
    v_pk_fma_f32 v[182:183], v[182:183], s[28:29], v[26:27]
    v_pk_fma_f32 v[184:185], v[184:185], s[28:29], v[26:27]
    v_pk_fma_f32 v[186:187], v[186:187], s[28:29], v[26:27]
    v_exp_f32 v172, v172
    v_exp_f32 v173, v173
    v_exp_f32 v174, v174
    v_exp_f32 v175, v175
    v_exp_f32 v176, v176
    v_exp_f32 v177, v177
    v_exp_f32 v178, v178
    v_exp_f32 v179, v179
    v_exp_f32 v180, v180
    v_mfma_f32_32x32x16_bf16 a[96:111], a[76:79], v[72:75], a[96:111]
    v_exp_f32 v181, v181
    v_exp_f32 v182, v182
    v_exp_f32 v183, v183
    v_exp_f32 v184, v184
    v_exp_f32 v185, v185
    v_exp_f32 v186, v186
    v_exp_f32 v187, v187
    v_cvt_pk_bf16_f32 v60, v172, v173
    v_cvt_pk_bf16_f32 v61, v174, v175
    v_cvt_pk_bf16_f32 v62, v176, v177
    v_cvt_pk_bf16_f32 v63, v178, v179
    v_cvt_pk_bf16_f32 v64, v180, v181
    v_cvt_pk_bf16_f32 v65, v182, v183
    v_cvt_pk_bf16_f32 v66, v184, v185
    v_cvt_pk_bf16_f32 v67, v186, v187
    ds_read_b64_tr_b16 a[72:73], v19 offset:2048
    ds_read_b64_tr_b16 a[74:75], v19 offset:2112
    ds_read_b64_tr_b16 a[76:77], v19 offset:2176
    ds_read_b64_tr_b16 a[78:79], v19 offset:2240
    v_pk_fma_f32 v[188:189], v[188:189], s[28:29], v[26:27]
    v_pk_fma_f32 v[190:191], v[190:191], s[28:29], v[26:27]
    v_pk_fma_f32 v[192:193], v[192:193], s[28:29], v[26:27]
    s_waitcnt lgkmcnt(8)
    v_mfma_f32_32x32x16_bf16 a[96:111], a[56:59], v[60:63], a[96:111]
    v_pk_fma_f32 v[194:195], v[194:195], s[28:29], v[26:27]
    v_pk_fma_f32 v[196:197], v[196:197], s[28:29], v[26:27]
    v_pk_fma_f32 v[198:199], v[198:199], s[28:29], v[26:27]
    v_pk_fma_f32 v[200:201], v[200:201], s[28:29], v[26:27]
    v_pk_fma_f32 v[202:203], v[202:203], s[28:29], v[26:27]
    v_exp_f32 v188, v188
    v_exp_f32 v189, v189
    v_exp_f32 v190, v190
    v_exp_f32 v191, v191
    v_exp_f32 v192, v192
    v_exp_f32 v193, v193
    v_exp_f32 v194, v194
    v_exp_f32 v195, v195
    v_exp_f32 v196, v196
    v_mfma_f32_32x32x16_bf16 a[96:111], a[60:63], v[64:67], a[96:111]
    v_exp_f32 v197, v197
    v_exp_f32 v198, v198
    v_exp_f32 v199, v199
    v_exp_f32 v200, v200
    v_exp_f32 v201, v201
    v_exp_f32 v202, v202
    v_exp_f32 v203, v203
    v_cvt_pk_bf16_f32 v68, v188, v189
    v_cvt_pk_bf16_f32 v69, v190, v191
    v_cvt_pk_bf16_f32 v70, v192, v193
    v_cvt_pk_bf16_f32 v71, v194, v195
    v_cvt_pk_bf16_f32 v72, v196, v197
    v_cvt_pk_bf16_f32 v73, v198, v199
    v_cvt_pk_bf16_f32 v74, v200, v201
    v_cvt_pk_bf16_f32 v75, v202, v203
    v_pk_fma_f32 v[204:205], v[204:205], s[28:29], v[26:27]
    v_pk_fma_f32 v[206:207], v[206:207], s[28:29], v[26:27]
    v_pk_fma_f32 v[208:209], v[208:209], s[28:29], v[26:27]
    s_waitcnt lgkmcnt(4)
    v_mfma_f32_32x32x16_bf16 a[96:111], a[64:67], v[68:71], a[96:111]
    v_pk_fma_f32 v[210:211], v[210:211], s[28:29], v[26:27]
    v_pk_fma_f32 v[212:213], v[212:213], s[28:29], v[26:27]
    v_pk_fma_f32 v[214:215], v[214:215], s[28:29], v[26:27]
    v_pk_fma_f32 v[216:217], v[216:217], s[28:29], v[26:27]
    v_pk_fma_f32 v[218:219], v[218:219], s[28:29], v[26:27]
    v_exp_f32 v204, v204
    v_exp_f32 v205, v205
    v_exp_f32 v206, v206
    v_exp_f32 v207, v207
    v_exp_f32 v208, v208
    v_exp_f32 v209, v209
    v_exp_f32 v210, v210
    v_exp_f32 v211, v211
    v_exp_f32 v212, v212
    v_mfma_f32_32x32x16_bf16 a[96:111], a[68:71], v[72:75], a[96:111]
    v_exp_f32 v213, v213
    v_exp_f32 v214, v214
    v_exp_f32 v215, v215
    v_exp_f32 v216, v216
    v_exp_f32 v217, v217
    v_exp_f32 v218, v218
    v_exp_f32 v219, v219
    v_cvt_pk_bf16_f32 v60, v204, v205
    v_cvt_pk_bf16_f32 v61, v206, v207
    v_cvt_pk_bf16_f32 v62, v208, v209
    v_cvt_pk_bf16_f32 v63, v210, v211
    v_cvt_pk_bf16_f32 v64, v212, v213
    v_cvt_pk_bf16_f32 v65, v214, v215
    v_cvt_pk_bf16_f32 v66, v216, v217
    v_cvt_pk_bf16_f32 v67, v218, v219
    s_waitcnt lgkmcnt(0)
    v_mfma_f32_32x32x16_bf16 a[96:111], a[72:75], v[60:63], a[96:111]
    v_mfma_f32_32x32x16_bf16 a[96:111], a[76:79], v[64:67], a[96:111]
    s_add_u32 m0, s27, 0
    s_nop 0
    buffer_load_dwordx4 v3, s[8:11], s26 offen offset:0 lds
    buffer_load_dwordx4 v3, s[8:11], s26 offen offset:1024 lds
    buffer_load_dwordx4 v3, s[8:11], s26 offen offset:2048 lds
    buffer_load_dwordx4 v3, s[8:11], s26 offen offset:3072 lds
    s_add_u32 m0, s27, 4096
    s_add_u32 s26, s26, 4096
    buffer_load_dwordx4 v3, s[8:11], s26 offen offset:0 lds
    buffer_load_dwordx4 v3, s[8:11], s26 offen offset:1024 lds
    buffer_load_dwordx4 v3, s[8:11], s26 offen offset:2048 lds
    buffer_load_dwordx4 v3, s[8:11], s26 offen offset:3072 lds
    s_add_u32 m0, s27, 8192
    s_add_u32 s26, s26, 4096
    buffer_load_dwordx4 v3, s[8:11], s26 offen offset:0 lds
    buffer_load_dwordx4 v3, s[8:11], s26 offen offset:1024 lds
    buffer_load_dwordx4 v3, s[8:11], s26 offen offset:2048 lds
    buffer_load_dwordx4 v3, s[8:11], s26 offen offset:3072 lds
    s_waitcnt vmcnt(12) lgkmcnt(0)
    s_barrier
    ds_read_b64 a[32:33], v16 offset:0
    ds_read_b64 a[34:35], v16 offset:8192
    ds_read_b64 a[36:37], v16 offset:16384
    ds_read_b64 a[40:41], v16 offset:256
    ds_read_b64 a[42:43], v16 offset:8448
    ds_read_b64 a[44:45], v16 offset:16640
    ds_read_b64 a[48:49], v16 offset:512
    ds_read_b64 a[50:51], v16 offset:8704
    ds_read_b64 a[52:53], v16 offset:16896
    s_waitcnt lgkmcnt(6)
    v_mfma_f32_32x32x16_bf16 v[76:91], a[32:35], v[224:227], v[28:43]
    v_mfma_f32_32x32x16_bf16 v[76:91], a[36:39], v[228:231], v[76:91]
    ds_read_b64 a[32:33], v16 offset:768
    ds_read_b64 a[34:35], v16 offset:8960
    ds_read_b64 a[36:37], v16 offset:17152
    s_waitcnt lgkmcnt(6)
    v_mfma_f32_32x32x16_bf16 v[92:107], a[40:43], v[224:227], 0
    v_mfma_f32_32x32x16_bf16 v[92:107], a[44:47], v[228:231], v[92:107]
    ds_read_b64 a[40:41], v16 offset:1024
    ds_read_b64 a[42:43], v16 offset:9216
    ds_read_b64 a[44:45], v16 offset:17408
    s_waitcnt lgkmcnt(6)
    v_mfma_f32_32x32x16_bf16 v[108:123], a[48:51], v[224:227], 0
    v_mfma_f32_32x32x16_bf16 v[108:123], a[52:55], v[228:231], v[108:123]
    v_max3_f32 v20, v76, v77, v78
    v_max3_f32 v21, v79, v80, v81
    v_max3_f32 v20, v20, v82, v83
    v_max3_f32 v21, v21, v84, v85
    v_max3_f32 v20, v20, v86, v87
    v_max3_f32 v21, v21, v88, v89
    ds_read_b64 a[48:49], v16 offset:1280
    s_add_u32 m0, s27, 12288
    s_add_u32 s26, s26, 4096
    buffer_load_dwordx4 v3, s[8:11], s26 offen offset:0 lds
    ds_read_b64 a[50:51], v16 offset:9472
    ds_read_b64 a[52:53], v16 offset:17664
    s_waitcnt lgkmcnt(6)
    v_mfma_f32_32x32x16_bf16 v[124:139], a[32:35], v[224:227], 0
    v_max3_f32 v20, v20, v90, v91
    v_mfma_f32_32x32x16_bf16 v[124:139], a[36:39], v[228:231], v[124:139]
    v_max3_f32 v20, v20, v92, v93
    s_add_u32 s31, s30, 2560
    buffer_load_dwordx4 a[156:159], v15, s[8:11], s31 offen offset:0 sc1
    v_max3_f32 v21, v21, v94, v95
    v_max3_f32 v20, v20, v96, v97
    v_max3_f32 v21, v21, v98, v99
    v_max3_f32 v20, v20, v100, v101
    v_max3_f32 v21, v21, v102, v103
    ds_read_b64 a[32:33], v18 offset:0
    ds_read_b64 a[34:35], v18 offset:8192
    ds_read_b64 a[36:37], v18 offset:16384
    s_waitcnt lgkmcnt(6)
    v_mfma_f32_32x32x16_bf16 v[140:155], a[40:43], v[224:227], 0
    v_max3_f32 v20, v20, v104, v105
    v_max3_f32 v21, v21, v106, v107
    v_mfma_f32_32x32x16_bf16 v[140:155], a[44:47], v[228:231], v[140:155]
    v_max3_f32 v20, v20, v108, v109
    v_max3_f32 v21, v21, v110, v111
    v_max3_f32 v20, v20, v112, v113
    v_max3_f32 v21, v21, v114, v115
    v_max3_f32 v20, v20, v116, v117
    v_max3_f32 v21, v21, v118, v119
    ds_read_b64 a[40:41], v18 offset:256
    ds_read_b64 a[42:43], v18 offset:8448
    ds_read_b64 a[44:45], v18 offset:16640
    s_waitcnt lgkmcnt(6)
    v_mfma_f32_32x32x16_bf16 v[156:171], a[48:51], v[224:227], 0
    s_add_u32 s31, s30, 2560
    buffer_load_dwordx4 a[160:163], v15, s[8:11], s31 offen offset:32 sc1
    v_max3_f32 v20, v20, v120, v121
    v_max3_f32 v21, v21, v122, v123
    v_mfma_f32_32x32x16_bf16 v[156:171], a[52:55], v[228:231], v[156:171]
    v_max3_f32 v20, v20, v124, v125
    v_max3_f32 v21, v21, v126, v127
    buffer_load_dwordx4 v3, s[8:11], s26 offen offset:1024 lds
    v_max3_f32 v20, v20, v128, v129
    v_max3_f32 v21, v21, v130, v131
    v_max3_f32 v20, v20, v132, v133
    v_max3_f32 v21, v21, v134, v135
    ds_read_b64 a[48:49], v18 offset:512
    ds_read_b64 a[50:51], v18 offset:8704
    ds_read_b64 a[52:53], v18 offset:16896
    s_waitcnt lgkmcnt(6)
    v_mfma_f32_32x32x16_bf16 v[172:187], a[32:35], v[232:235], v[28:43]
    v_max3_f32 v20, v20, v136, v137
    v_max3_f32 v21, v21, v138, v139
    v_mfma_f32_32x32x16_bf16 v[172:187], a[36:39], v[236:239], v[172:187]
    v_max3_f32 v20, v20, v140, v141
    v_max3_f32 v21, v21, v142, v143
    v_max3_f32 v20, v20, v144, v145
    v_max3_f32 v21, v21, v146, v147
    v_max3_f32 v20, v20, v148, v149
    v_max3_f32 v21, v21, v150, v151
    s_waitcnt lgkmcnt(3)
    v_mfma_f32_32x32x16_bf16 v[188:203], a[40:43], v[232:235], 0
    s_add_u32 s31, s30, 2560
    buffer_load_dwordx4 a[164:167], v15, s[8:11], s31 offen offset:64 sc1
    v_max3_f32 v20, v20, v152, v153
    v_max3_f32 v21, v21, v154, v155
    v_mfma_f32_32x32x16_bf16 v[188:203], a[44:47], v[236:239], v[188:203]
    v_max3_f32 v20, v20, v156, v157
    v_max3_f32 v21, v21, v158, v159
    v_max3_f32 v20, v20, v160, v161
    v_max3_f32 v21, v21, v162, v163
    v_max3_f32 v20, v20, v164, v165
    v_max3_f32 v21, v21, v166, v167
    s_waitcnt lgkmcnt(0)
    v_mfma_f32_32x32x16_bf16 v[204:219], a[48:51], v[232:235], 0
    v_max3_f32 v20, v20, v168, v169
    v_max3_f32 v21, v21, v170, v171
    v_mfma_f32_32x32x16_bf16 v[204:219], a[52:55], v[236:239], v[204:219]
    v_max3_f32 v22, v172, v173, v174
    v_max3_f32 v23, v175, v176, v177
    buffer_load_dwordx4 v3, s[8:11], s26 offen offset:2048 lds
    v_max3_f32 v22, v22, v178, v179
    v_max3_f32 v23, v23, v180, v181
    v_max3_f32 v22, v22, v182, v183
    v_max3_f32 v23, v23, v184, v185
    ds_read_b64_tr_b16 a[56:57], v17 offset:0
    ds_read_b64_tr_b16 a[58:59], v17 offset:64
    ds_read_b64_tr_b16 a[60:61], v17 offset:128
    ds_read_b64_tr_b16 a[62:63], v17 offset:192
    v_max3_f32 v22, v22, v186, v187
    s_add_u32 s31, s30, 5120
    buffer_load_dwordx4 a[168:171], v15, s[8:11], s31 offen offset:0 sc1
    v_max3_f32 v22, v22, v188, v189
    v_max3_f32 v23, v23, v190, v191
    v_max3_f32 v22, v22, v192, v193
    v_max3_f32 v23, v23, v194, v195
    v_max3_f32 v22, v22, v196, v197
    v_max3_f32 v23, v23, v198, v199
    v_max3_f32 v22, v22, v200, v201
    v_max3_f32 v23, v23, v202, v203
    v_max3_f32 v22, v22, v204, v205
    v_max3_f32 v23, v23, v206, v207
    v_max3_f32 v22, v22, v208, v209
    v_max3_f32 v23, v23, v210, v211
    v_max3_f32 v22, v22, v212, v213
    v_max3_f32 v23, v23, v214, v215
    v_max3_f32 v22, v22, v216, v217
    v_max3_f32 v23, v23, v218, v219
    v_max_f32 v20, v20, v21
    v_mov_b32 v21, v20
    s_nop 1
    v_permlane32_swap_b32 v20, v21
    v_max_f32 v20, v20, v21
    v_max_f32 v20, v20, v252
    v_sub_f32 v21, v252, v20
    v_mul_f32 v21, s28, v21
    v_exp_f32 v222, v21
    s_add_u32 s31, s30, 5120
    buffer_load_dwordx4 a[172:175], v15, s[8:11], s31 offen offset:32 sc1
    v_mul_f32 v24, 0xbea52b5c, v20
    v_mov_b32 v25, v24
    buffer_load_dwordx4 v3, s[8:11], s26 offen offset:3072 lds
    v_max_f32 v22, v22, v23
    v_mov_b32 v23, v22
    s_nop 1
    v_permlane32_swap_b32 v22, v23
    v_max_f32 v22, v22, v23
    v_max_f32 v22, v22, v253
    v_sub_f32 v23, v253, v22
    v_mul_f32 v23, s28, v23
    v_exp_f32 v223, v23
    v_mul_f32 v26, 0xbea52b5c, v22
    v_mov_b32 v27, v26
    ds_read_b64_tr_b16 a[64:65], v17 offset:256
    ds_read_b64_tr_b16 a[66:67], v17 offset:320
    ds_read_b64_tr_b16 a[68:69], v17 offset:384
    ds_read_b64_tr_b16 a[70:71], v17 offset:448
    v_pk_fma_f32 v[76:77], v[76:77], s[28:29], v[24:25]
    v_pk_fma_f32 v[78:79], v[78:79], s[28:29], v[24:25]
    v_pk_fma_f32 v[80:81], v[80:81], s[28:29], v[24:25]
    v_pk_fma_f32 v[82:83], v[82:83], s[28:29], v[24:25]
    v_pk_fma_f32 v[84:85], v[84:85], s[28:29], v[24:25]
    v_pk_fma_f32 v[86:87], v[86:87], s[28:29], v[24:25]
    v_pk_fma_f32 v[88:89], v[88:89], s[28:29], v[24:25]
    v_pk_fma_f32 v[90:91], v[90:91], s[28:29], v[24:25]
    v_exp_f32 v76, v76
    s_add_u32 s31, s30, 5120
    buffer_load_dwordx4 a[176:179], v15, s[8:11], s31 offen offset:64 sc1
    v_exp_f32 v77, v77
    v_exp_f32 v78, v78
    v_exp_f32 v79, v79
    v_exp_f32 v80, v80
    v_exp_f32 v81, v81
    v_exp_f32 v82, v82
    v_exp_f32 v83, v83
    v_exp_f32 v84, v84
    v_exp_f32 v85, v85
    v_exp_f32 v86, v86
    v_exp_f32 v87, v87
    v_exp_f32 v88, v88
    v_exp_f32 v89, v89
    s_add_u32 m0, s27, 16384
    s_add_u32 s26, s26, 4096
    buffer_load_dwordx4 v3, s[8:11], s26 offen offset:0 lds
    v_exp_f32 v90, v90
    v_exp_f32 v91, v91
    v_cvt_pk_bf16_f32 v60, v76, v77
    v_cvt_pk_bf16_f32 v61, v78, v79
    v_cvt_pk_bf16_f32 v62, v80, v81
    v_cvt_pk_bf16_f32 v63, v82, v83
    v_cvt_pk_bf16_f32 v64, v84, v85
    v_cvt_pk_bf16_f32 v65, v86, v87
    v_cvt_pk_bf16_f32 v66, v88, v89
    v_cvt_pk_bf16_f32 v67, v90, v91
    ds_read_b64_tr_b16 a[72:73], v17 offset:512
    ds_read_b64_tr_b16 a[74:75], v17 offset:576
    s_add_u32 s31, s30, 3840
    buffer_load_dwordx4 a[180:183], v15, s[8:11], s31 offen offset:0 sc1
    s_bfm_b64 exec, s25, 0
    buffer_load_dword v255, v4, s[8:11], s16 offen
    s_mov_b64 exec, 3
    buffer_load_dword v255, v4, s[8:11], s17 offen
    s_mov_b64 exec, -1
    ds_read_b64_tr_b16 a[76:77], v17 offset:640
    ds_read_b64_tr_b16 a[78:79], v17 offset:704
    v_pk_fma_f32 v[92:93], v[92:93], s[28:29], v[24:25]
    v_pk_fma_f32 v[94:95], v[94:95], s[28:29], v[24:25]
    v_pk_fma_f32 v[96:97], v[96:97], s[28:29], v[24:25]
    s_waitcnt lgkmcnt(8)
    v_mfma_f32_32x32x16_bf16 a[112:127], a[56:59], v[60:63], 0
    v_pk_fma_f32 v[98:99], v[98:99], s[28:29], v[24:25]
    v_pk_fma_f32 v[100:101], v[100:101], s[28:29], v[24:25]
    v_pk_fma_f32 v[102:103], v[102:103], s[28:29], v[24:25]
    v_pk_fma_f32 v[104:105], v[104:105], s[28:29], v[24:25]
    v_pk_fma_f32 v[106:107], v[106:107], s[28:29], v[24:25]
    v_exp_f32 v92, v92
    v_exp_f32 v93, v93
    v_exp_f32 v94, v94
    v_exp_f32 v95, v95
    v_exp_f32 v96, v96
    v_exp_f32 v97, v97
    v_exp_f32 v98, v98
    v_exp_f32 v99, v99
    v_exp_f32 v100, v100
    v_mfma_f32_32x32x16_bf16 a[112:127], a[60:63], v[64:67], a[112:127]
    v_exp_f32 v101, v101
    buffer_load_dwordx4 v3, s[8:11], s26 offen offset:1024 lds
    v_exp_f32 v102, v102
    s_add_u32 s31, s30, 3840
    buffer_load_dwordx4 a[184:187], v15, s[8:11], s31 offen offset:32 sc1
    v_exp_f32 v103, v103
    v_exp_f32 v104, v104
    v_exp_f32 v105, v105
    v_exp_f32 v106, v106
    v_exp_f32 v107, v107
    v_cvt_pk_bf16_f32 v68, v92, v93
    v_cvt_pk_bf16_f32 v69, v94, v95
    v_cvt_pk_bf16_f32 v70, v96, v97
    v_cvt_pk_bf16_f32 v71, v98, v99
    v_cvt_pk_bf16_f32 v72, v100, v101
    v_cvt_pk_bf16_f32 v73, v102, v103
    v_cvt_pk_bf16_f32 v74, v104, v105
    v_cvt_pk_bf16_f32 v75, v106, v107
    ds_read_b64_tr_b16 a[56:57], v17 offset:768
    ds_read_b64_tr_b16 a[58:59], v17 offset:832
    ds_read_b64_tr_b16 a[60:61], v17 offset:896
    ds_read_b64_tr_b16 a[62:63], v17 offset:960
    v_pk_fma_f32 v[108:109], v[108:109], s[28:29], v[24:25]
    v_pk_fma_f32 v[110:111], v[110:111], s[28:29], v[24:25]
    v_pk_fma_f32 v[112:113], v[112:113], s[28:29], v[24:25]
    s_waitcnt lgkmcnt(8)
    v_mfma_f32_32x32x16_bf16 a[112:127], a[64:67], v[68:71], a[112:127]
    v_pk_fma_f32 v[114:115], v[114:115], s[28:29], v[24:25]
    v_pk_fma_f32 v[116:117], v[116:117], s[28:29], v[24:25]
    v_pk_fma_f32 v[118:119], v[118:119], s[28:29], v[24:25]
    s_add_u32 s31, s30, 3840
    buffer_load_dwordx4 a[188:191], v15, s[8:11], s31 offen offset:64 sc1
    v_pk_fma_f32 v[120:121], v[120:121], s[28:29], v[24:25]
    v_pk_fma_f32 v[122:123], v[122:123], s[28:29], v[24:25]
    v_exp_f32 v108, v108
    v_exp_f32 v109, v109
    v_exp_f32 v110, v110
    v_exp_f32 v111, v111
    v_exp_f32 v112, v112
    v_exp_f32 v113, v113
    v_exp_f32 v114, v114
    v_exp_f32 v115, v115
    buffer_load_dwordx4 v3, s[8:11], s26 offen offset:2048 lds
    v_exp_f32 v116, v116
    v_mfma_f32_32x32x16_bf16 a[112:127], a[68:71], v[72:75], a[112:127]
    v_exp_f32 v117, v117
    v_exp_f32 v118, v118
    v_exp_f32 v119, v119
    v_exp_f32 v120, v120
    v_exp_f32 v121, v121
    v_exp_f32 v122, v122
    v_exp_f32 v123, v123
    v_cvt_pk_bf16_f32 v60, v108, v109
    v_cvt_pk_bf16_f32 v61, v110, v111
    v_cvt_pk_bf16_f32 v62, v112, v113
    v_cvt_pk_bf16_f32 v63, v114, v115
    v_cvt_pk_bf16_f32 v64, v116, v117
    v_cvt_pk_bf16_f32 v65, v118, v119
    buffer_load_dwordx2 a[144:145], v8, s[32:35], s43 offen offset:0
    v_cvt_pk_bf16_f32 v66, v120, v121
    v_cvt_pk_bf16_f32 v67, v122, v123
    ds_read_b64_tr_b16 a[64:65], v17 offset:1024
    ds_read_b64_tr_b16 a[66:67], v17 offset:1088
    ds_read_b64_tr_b16 a[68:69], v17 offset:1152
    ds_read_b64_tr_b16 a[70:71], v17 offset:1216
    v_pk_fma_f32 v[124:125], v[124:125], s[28:29], v[24:25]
    v_pk_fma_f32 v[126:127], v[126:127], s[28:29], v[24:25]
    v_pk_fma_f32 v[128:129], v[128:129], s[28:29], v[24:25]
    s_waitcnt lgkmcnt(8)
    v_mfma_f32_32x32x16_bf16 a[112:127], a[72:75], v[60:63], a[112:127]
    v_pk_fma_f32 v[130:131], v[130:131], s[28:29], v[24:25]
    v_pk_fma_f32 v[132:133], v[132:133], s[28:29], v[24:25]
    v_pk_fma_f32 v[134:135], v[134:135], s[28:29], v[24:25]
    v_pk_fma_f32 v[136:137], v[136:137], s[28:29], v[24:25]
    v_pk_fma_f32 v[138:139], v[138:139], s[28:29], v[24:25]
    v_exp_f32 v124, v124
    v_exp_f32 v125, v125
    v_exp_f32 v126, v126
    v_exp_f32 v127, v127
    v_exp_f32 v128, v128
    buffer_load_dwordx4 v3, s[8:11], s26 offen offset:3072 lds
    v_exp_f32 v129, v129
    v_exp_f32 v130, v130
    v_exp_f32 v131, v131
    buffer_load_dwordx2 a[146:147], v8, s[32:35], s43 offen offset:16
    v_exp_f32 v132, v132
    v_mfma_f32_32x32x16_bf16 a[112:127], a[76:79], v[64:67], a[112:127]
    v_exp_f32 v133, v133
    v_exp_f32 v134, v134
    v_exp_f32 v135, v135
    v_exp_f32 v136, v136
    v_exp_f32 v137, v137
    v_exp_f32 v138, v138
    v_exp_f32 v139, v139
    v_cvt_pk_bf16_f32 v68, v124, v125
    v_cvt_pk_bf16_f32 v69, v126, v127
    v_cvt_pk_bf16_f32 v70, v128, v129
    v_cvt_pk_bf16_f32 v71, v130, v131
    v_cvt_pk_bf16_f32 v72, v132, v133
    v_cvt_pk_bf16_f32 v73, v134, v135
    v_cvt_pk_bf16_f32 v74, v136, v137
    v_cvt_pk_bf16_f32 v75, v138, v139
    ds_read_b64_tr_b16 a[72:73], v17 offset:1280
    ds_read_b64_tr_b16 a[74:75], v17 offset:1344
    ds_read_b64_tr_b16 a[76:77], v17 offset:1408
    ds_read_b64_tr_b16 a[78:79], v17 offset:1472
    v_pk_fma_f32 v[140:141], v[140:141], s[28:29], v[24:25]
    v_pk_fma_f32 v[142:143], v[142:143], s[28:29], v[24:25]
    v_pk_fma_f32 v[144:145], v[144:145], s[28:29], v[24:25]
    s_waitcnt lgkmcnt(8)
    buffer_load_dwordx2 a[148:149], v8, s[32:35], s43 offen offset:32
    v_mfma_f32_32x32x16_bf16 a[112:127], a[56:59], v[68:71], a[112:127]
    v_pk_fma_f32 v[146:147], v[146:147], s[28:29], v[24:25]
    v_pk_fma_f32 v[148:149], v[148:149], s[28:29], v[24:25]
    v_pk_fma_f32 v[150:151], v[150:151], s[28:29], v[24:25]
    v_pk_fma_f32 v[152:153], v[152:153], s[28:29], v[24:25]
    v_pk_fma_f32 v[154:155], v[154:155], s[28:29], v[24:25]
    v_exp_f32 v140, v140
    s_add_u32 m0, s27, 20480
    s_add_u32 s26, s26, 4096
    buffer_load_dwordx4 v3, s[8:11], s26 offen offset:0 lds
    v_exp_f32 v141, v141
    v_exp_f32 v142, v142
    v_exp_f32 v143, v143
    v_exp_f32 v144, v144
    v_exp_f32 v145, v145
    v_exp_f32 v146, v146
    v_exp_f32 v147, v147
    v_exp_f32 v148, v148
    v_mfma_f32_32x32x16_bf16 a[112:127], a[60:63], v[72:75], a[112:127]
    v_exp_f32 v149, v149
    v_exp_f32 v150, v150
    v_exp_f32 v151, v151
    v_exp_f32 v152, v152
    v_exp_f32 v153, v153
    v_exp_f32 v154, v154
    v_exp_f32 v155, v155
    v_cvt_pk_bf16_f32 v60, v140, v141
    v_cvt_pk_bf16_f32 v61, v142, v143
    buffer_load_dwordx2 a[150:151], v8, s[32:35], s43 offen offset:48
    v_cvt_pk_bf16_f32 v62, v144, v145
    v_cvt_pk_bf16_f32 v63, v146, v147
    v_cvt_pk_bf16_f32 v64, v148, v149
    v_cvt_pk_bf16_f32 v65, v150, v151
    v_cvt_pk_bf16_f32 v66, v152, v153
    v_cvt_pk_bf16_f32 v67, v154, v155
    ds_read_b64_tr_b16 a[56:57], v19 offset:0
    ds_read_b64_tr_b16 a[58:59], v19 offset:64
    ds_read_b64_tr_b16 a[60:61], v19 offset:128
    ds_read_b64_tr_b16 a[62:63], v19 offset:192
    v_pk_fma_f32 v[156:157], v[156:157], s[28:29], v[24:25]
    v_pk_fma_f32 v[158:159], v[158:159], s[28:29], v[24:25]
    v_pk_fma_f32 v[160:161], v[160:161], s[28:29], v[24:25]
    s_waitcnt lgkmcnt(8)
    v_mfma_f32_32x32x16_bf16 a[112:127], a[64:67], v[60:63], a[112:127]
    v_pk_fma_f32 v[162:163], v[162:163], s[28:29], v[24:25]
    v_pk_fma_f32 v[164:165], v[164:165], s[28:29], v[24:25]
    v_pk_fma_f32 v[166:167], v[166:167], s[28:29], v[24:25]
    buffer_load_dwordx4 v3, s[8:11], s26 offen offset:1024 lds
    v_pk_fma_f32 v[168:169], v[168:169], s[28:29], v[24:25]
    v_pk_fma_f32 v[170:171], v[170:171], s[28:29], v[24:25]
    v_exp_f32 v156, v156
    v_exp_f32 v157, v157
    v_exp_f32 v158, v158
    v_exp_f32 v159, v159
    buffer_load_dwordx2 a[152:153], v8, s[32:35], s43 offen offset:64
    v_exp_f32 v160, v160
    v_exp_f32 v161, v161
    v_exp_f32 v162, v162
    v_exp_f32 v163, v163
    v_exp_f32 v164, v164
    v_mfma_f32_32x32x16_bf16 a[112:127], a[68:71], v[64:67], a[112:127]
    v_exp_f32 v165, v165
    v_exp_f32 v166, v166
    v_exp_f32 v167, v167
    v_exp_f32 v168, v168
    v_exp_f32 v169, v169
    v_exp_f32 v170, v170
    v_exp_f32 v171, v171
    v_cvt_pk_bf16_f32 v68, v156, v157
    v_cvt_pk_bf16_f32 v69, v158, v159
    v_cvt_pk_bf16_f32 v70, v160, v161
    v_cvt_pk_bf16_f32 v71, v162, v163
    v_cvt_pk_bf16_f32 v72, v164, v165
    v_cvt_pk_bf16_f32 v73, v166, v167
    v_cvt_pk_bf16_f32 v74, v168, v169
    v_cvt_pk_bf16_f32 v75, v170, v171
    ds_read_b64_tr_b16 a[64:65], v19 offset:256
    ds_read_b64_tr_b16 a[66:67], v19 offset:320
    ds_read_b64_tr_b16 a[68:69], v19 offset:384
    ds_read_b64_tr_b16 a[70:71], v19 offset:448
    buffer_load_dwordx2 a[154:155], v8, s[32:35], s43 offen offset:80
    v_pk_fma_f32 v[172:173], v[172:173], s[28:29], v[26:27]
    v_pk_fma_f32 v[174:175], v[174:175], s[28:29], v[26:27]
    v_pk_fma_f32 v[176:177], v[176:177], s[28:29], v[26:27]
    s_waitcnt lgkmcnt(8)
    buffer_load_dwordx4 v3, s[8:11], s26 offen offset:2048 lds
    v_mfma_f32_32x32x16_bf16 a[112:127], a[72:75], v[68:71], a[112:127]
    v_pk_fma_f32 v[178:179], v[178:179], s[28:29], v[26:27]
    v_pk_fma_f32 v[180:181], v[180:181], s[28:29], v[26:27]
    v_pk_fma_f32 v[182:183], v[182:183], s[28:29], v[26:27]
    v_pk_fma_f32 v[184:185], v[184:185], s[28:29], v[26:27]
    v_pk_fma_f32 v[186:187], v[186:187], s[28:29], v[26:27]
    v_exp_f32 v172, v172
    v_exp_f32 v173, v173
    v_exp_f32 v174, v174
    v_exp_f32 v175, v175
    v_exp_f32 v176, v176
    v_exp_f32 v177, v177
    v_exp_f32 v178, v178
    v_exp_f32 v179, v179
    v_exp_f32 v180, v180
    v_mfma_f32_32x32x16_bf16 a[112:127], a[76:79], v[72:75], a[112:127]
    v_exp_f32 v181, v181
    v_exp_f32 v182, v182
    v_exp_f32 v183, v183
    v_exp_f32 v184, v184
    v_exp_f32 v185, v185
    v_exp_f32 v186, v186
    v_exp_f32 v187, v187
    v_cvt_pk_bf16_f32 v60, v172, v173
    v_cvt_pk_bf16_f32 v61, v174, v175
    v_cvt_pk_bf16_f32 v62, v176, v177
    v_cvt_pk_bf16_f32 v63, v178, v179
    v_cvt_pk_bf16_f32 v64, v180, v181
    v_cvt_pk_bf16_f32 v65, v182, v183
    v_cvt_pk_bf16_f32 v66, v184, v185
    v_cvt_pk_bf16_f32 v67, v186, v187
    ds_read_b64_tr_b16 a[72:73], v19 offset:512
    ds_read_b64_tr_b16 a[74:75], v19 offset:576
    ds_read_b64_tr_b16 a[76:77], v19 offset:640
    ds_read_b64_tr_b16 a[78:79], v19 offset:704
    v_pk_fma_f32 v[188:189], v[188:189], s[28:29], v[26:27]
    buffer_load_dwordx4 v3, s[8:11], s26 offen offset:3072 lds
    v_pk_fma_f32 v[190:191], v[190:191], s[28:29], v[26:27]
    v_pk_fma_f32 v[192:193], v[192:193], s[28:29], v[26:27]
    s_waitcnt lgkmcnt(8)
    v_mfma_f32_32x32x16_bf16 a[128:143], a[56:59], v[60:63], 0
    v_pk_fma_f32 v[194:195], v[194:195], s[28:29], v[26:27]
    v_pk_fma_f32 v[196:197], v[196:197], s[28:29], v[26:27]
    v_pk_fma_f32 v[198:199], v[198:199], s[28:29], v[26:27]
    v_pk_fma_f32 v[200:201], v[200:201], s[28:29], v[26:27]
    v_pk_fma_f32 v[202:203], v[202:203], s[28:29], v[26:27]
    v_exp_f32 v188, v188
    v_exp_f32 v189, v189
    v_exp_f32 v190, v190
    v_exp_f32 v191, v191
    v_exp_f32 v192, v192
    v_exp_f32 v193, v193
    v_exp_f32 v194, v194
    v_exp_f32 v195, v195
    v_exp_f32 v196, v196
    v_mfma_f32_32x32x16_bf16 a[128:143], a[60:63], v[64:67], a[128:143]
    v_exp_f32 v197, v197
    v_exp_f32 v198, v198
    v_exp_f32 v199, v199
    v_exp_f32 v200, v200
    v_exp_f32 v201, v201
    v_exp_f32 v202, v202
    v_exp_f32 v203, v203
    v_cvt_pk_bf16_f32 v68, v188, v189
    v_cvt_pk_bf16_f32 v69, v190, v191
    v_cvt_pk_bf16_f32 v70, v192, v193
    v_cvt_pk_bf16_f32 v71, v194, v195
    v_cvt_pk_bf16_f32 v72, v196, v197
    v_cvt_pk_bf16_f32 v73, v198, v199
    v_cvt_pk_bf16_f32 v74, v200, v201
    v_cvt_pk_bf16_f32 v75, v202, v203
    v_pk_fma_f32 v[204:205], v[204:205], s[28:29], v[26:27]
    v_pk_fma_f32 v[206:207], v[206:207], s[28:29], v[26:27]
    s_add_u32 m0, s27, 24576
    s_add_u32 s26, s26, 4096
    buffer_load_dwordx4 v3, s[8:11], s26 offen offset:0 lds
    v_pk_fma_f32 v[208:209], v[208:209], s[28:29], v[26:27]
    s_waitcnt lgkmcnt(4)
    v_mfma_f32_32x32x16_bf16 a[128:143], a[64:67], v[68:71], a[128:143]
    v_pk_fma_f32 v[210:211], v[210:211], s[28:29], v[26:27]
    v_pk_fma_f32 v[212:213], v[212:213], s[28:29], v[26:27]
    v_pk_fma_f32 v[214:215], v[214:215], s[28:29], v[26:27]
    v_pk_fma_f32 v[216:217], v[216:217], s[28:29], v[26:27]
    v_pk_fma_f32 v[218:219], v[218:219], s[28:29], v[26:27]
    v_exp_f32 v204, v204
    v_exp_f32 v205, v205
    v_exp_f32 v206, v206
    v_exp_f32 v207, v207
    v_exp_f32 v208, v208
    v_exp_f32 v209, v209
    v_exp_f32 v210, v210
    v_exp_f32 v211, v211
    v_exp_f32 v212, v212
    v_mfma_f32_32x32x16_bf16 a[128:143], a[68:71], v[72:75], a[128:143]
    v_exp_f32 v213, v213
    v_exp_f32 v214, v214
    v_exp_f32 v215, v215
    v_exp_f32 v216, v216
    v_exp_f32 v217, v217
    v_exp_f32 v218, v218
    v_exp_f32 v219, v219
    v_cvt_pk_bf16_f32 v60, v204, v205
    v_cvt_pk_bf16_f32 v61, v206, v207
    v_cvt_pk_bf16_f32 v62, v208, v209
    v_cvt_pk_bf16_f32 v63, v210, v211
    v_cvt_pk_bf16_f32 v64, v212, v213
    v_cvt_pk_bf16_f32 v65, v214, v215
    v_cvt_pk_bf16_f32 v66, v216, v217
    v_cvt_pk_bf16_f32 v67, v218, v219
    s_waitcnt lgkmcnt(0)
    v_mfma_f32_32x32x16_bf16 a[128:143], a[72:75], v[60:63], a[128:143]
    v_mfma_f32_32x32x16_bf16 a[128:143], a[76:79], v[64:67], a[128:143]
    v_accvgpr_read_b32 v20, a88
    v_accvgpr_read_b32 v21, a120
    v_fma_f32 v20, v20, v222, v21
    v_mov_b32 v21, v20
    s_nop 1
    v_permlane32_swap_b32 v20, v21
    v_rcp_f32 v21, v21
    s_nop 0
    v_mul_f32 v222, v222, v21
    v_accvgpr_read_b32 v22, a112
    v_accvgpr_read_b32 v23, a113
    v_accvgpr_read_b32 v9, a80
    v_accvgpr_read_b32 v10, a81
    v_mul_f32 v22, v22, v21
    v_mul_f32 v23, v23, v21
    v_fma_f32 v22, v9, v222, v22
    v_fma_f32 v23, v10, v222, v23
    v_cvt_pk_bf16_f32 v240, v22, v23
    v_accvgpr_read_b32 v22, a114
    v_accvgpr_read_b32 v23, a115
    v_accvgpr_read_b32 v9, a82
    v_accvgpr_read_b32 v10, a83
    v_mul_f32 v22, v22, v21
    v_mul_f32 v23, v23, v21
    v_fma_f32 v22, v9, v222, v22
    v_fma_f32 v23, v10, v222, v23
    v_cvt_pk_bf16_f32 v241, v22, v23
    v_accvgpr_read_b32 v22, a116
    v_accvgpr_read_b32 v23, a117
    v_accvgpr_read_b32 v9, a84
    v_accvgpr_read_b32 v10, a85
    v_mul_f32 v22, v22, v21
    v_mul_f32 v23, v23, v21
    v_fma_f32 v22, v9, v222, v22
    v_fma_f32 v23, v10, v222, v23
    v_cvt_pk_bf16_f32 v242, v22, v23
    v_accvgpr_read_b32 v22, a118
    v_accvgpr_read_b32 v23, a119
    v_accvgpr_read_b32 v9, a86
    v_accvgpr_read_b32 v10, a87
    v_mul_f32 v22, v22, v21
    v_mul_f32 v23, v23, v21
    v_fma_f32 v22, v9, v222, v22
    v_fma_f32 v23, v10, v222, v23
    v_cvt_pk_bf16_f32 v243, v22, v23
    v_accvgpr_read_b32 v22, a120
    v_accvgpr_read_b32 v23, a121
    v_accvgpr_read_b32 v9, a88
    v_accvgpr_read_b32 v10, a89
    v_mul_f32 v22, v22, v21
    v_mul_f32 v23, v23, v21
    v_fma_f32 v22, v9, v222, v22
    v_fma_f32 v23, v10, v222, v23
    v_cvt_pk_bf16_f32 v244, v22, v23
    v_accvgpr_read_b32 v22, a122
    v_accvgpr_read_b32 v23, a123
    v_accvgpr_read_b32 v9, a90
    v_accvgpr_read_b32 v10, a91
    v_mul_f32 v22, v22, v21
    v_mul_f32 v23, v23, v21
    v_fma_f32 v22, v9, v222, v22
    v_fma_f32 v23, v10, v222, v23
    v_cvt_pk_bf16_f32 v245, v22, v23
    v_accvgpr_read_b32 v20, a104
    v_accvgpr_read_b32 v21, a136
    v_fma_f32 v20, v20, v223, v21
    v_mov_b32 v21, v20
    s_nop 1
    v_permlane32_swap_b32 v20, v21
    v_rcp_f32 v21, v21
    s_nop 0
    v_mul_f32 v223, v223, v21
    v_accvgpr_read_b32 v22, a128
    v_accvgpr_read_b32 v23, a129
    v_accvgpr_read_b32 v9, a96
    v_accvgpr_read_b32 v10, a97
    v_mul_f32 v22, v22, v21
    v_mul_f32 v23, v23, v21
    v_fma_f32 v22, v9, v223, v22
    v_fma_f32 v23, v10, v223, v23
    v_cvt_pk_bf16_f32 v246, v22, v23
    v_accvgpr_read_b32 v22, a130
    v_accvgpr_read_b32 v23, a131
    v_accvgpr_read_b32 v9, a98
    v_accvgpr_read_b32 v10, a99
    v_mul_f32 v22, v22, v21
    v_mul_f32 v23, v23, v21
    v_fma_f32 v22, v9, v223, v22
    v_fma_f32 v23, v10, v223, v23
    v_cvt_pk_bf16_f32 v247, v22, v23
    v_accvgpr_read_b32 v22, a132
    v_accvgpr_read_b32 v23, a133
    v_accvgpr_read_b32 v9, a100
    v_accvgpr_read_b32 v10, a101
    v_mul_f32 v22, v22, v21
    v_mul_f32 v23, v23, v21
    v_fma_f32 v22, v9, v223, v22
    v_fma_f32 v23, v10, v223, v23
    v_cvt_pk_bf16_f32 v248, v22, v23
    v_accvgpr_read_b32 v22, a134
    v_accvgpr_read_b32 v23, a135
    v_accvgpr_read_b32 v9, a102
    v_accvgpr_read_b32 v10, a103
    v_mul_f32 v22, v22, v21
    v_mul_f32 v23, v23, v21
    v_fma_f32 v22, v9, v223, v22
    v_fma_f32 v23, v10, v223, v23
    v_cvt_pk_bf16_f32 v249, v22, v23
    v_accvgpr_read_b32 v22, a136
    v_accvgpr_read_b32 v23, a137
    v_accvgpr_read_b32 v9, a104
    v_accvgpr_read_b32 v10, a105
    v_mul_f32 v22, v22, v21
    v_mul_f32 v23, v23, v21
    v_fma_f32 v22, v9, v223, v22
    v_fma_f32 v23, v10, v223, v23
    v_cvt_pk_bf16_f32 v250, v22, v23
    v_accvgpr_read_b32 v22, a138
    v_accvgpr_read_b32 v23, a139
    v_accvgpr_read_b32 v9, a106
    v_accvgpr_read_b32 v10, a107
    v_mul_f32 v22, v22, v21
    v_mul_f32 v23, v23, v21
    v_fma_f32 v22, v9, v223, v22
    v_fma_f32 v23, v10, v223, v23
    v_cvt_pk_bf16_f32 v251, v22, v23
    s_branch AT_END_52
AT_W3_56:
    ds_read_b64 a[32:33], v16 offset:1280
    ds_read_b64 a[34:35], v16 offset:9472
    ds_read_b64 a[36:37], v16 offset:17664
    ds_read_b64 a[40:41], v16 offset:1536
    ds_read_b64 a[42:43], v16 offset:9728
    ds_read_b64 a[44:45], v16 offset:17920
    ds_read_b64 a[48:49], v16 offset:1792
    ds_read_b64 a[50:51], v16 offset:9984
    ds_read_b64 a[52:53], v16 offset:18176
    s_waitcnt lgkmcnt(6)
    v_mfma_f32_32x32x16_bf16 v[76:91], a[32:35], v[224:227], 0
    v_cmp_gt_i32 vcc, 0, v13
    v_cmp_gt_i32 s[20:21], 1, v13
    v_cmp_gt_i32 s[22:23], 2, v13
    v_cndmask_b32_e64 v28, v220, 0, vcc
    v_cndmask_b32_e64 v44, 0, v220, vcc
    v_mfma_f32_32x32x16_bf16 v[76:91], a[36:39], v[228:231], v[76:91]
    v_cmp_gt_i32 vcc, 3, v13
    v_cndmask_b32_e64 v29, v220, 0, s[20:21]
    v_cndmask_b32_e64 v45, 0, v220, s[20:21]
    v_cmp_gt_i32 s[20:21], 8, v13
    v_cndmask_b32_e64 v30, v220, 0, s[22:23]
    v_cndmask_b32_e64 v46, 0, v220, s[22:23]
    ds_read_b64 a[32:33], v18 offset:1024
    ds_read_b64 a[34:35], v18 offset:9216
    ds_read_b64 a[36:37], v18 offset:17408
    s_waitcnt lgkmcnt(6)
    v_mfma_f32_32x32x16_bf16 v[92:107], a[40:43], v[224:227], 0
    v_cmp_gt_i32 s[22:23], 9, v13
    v_cndmask_b32_e64 v31, v220, 0, vcc
    v_cndmask_b32_e64 v47, 0, v220, vcc
    v_cmp_gt_i32 vcc, 10, v13
    v_cndmask_b32_e64 v32, v220, 0, s[20:21]
    v_mfma_f32_32x32x16_bf16 v[92:107], a[44:47], v[228:231], v[92:107]
    v_cndmask_b32_e64 v48, 0, v220, s[20:21]
    v_cmp_gt_i32 s[20:21], 11, v13
    v_cndmask_b32_e64 v33, v220, 0, s[22:23]
    v_cndmask_b32_e64 v49, 0, v220, s[22:23]
    v_cmp_gt_i32 s[22:23], 16, v13
    v_cndmask_b32_e64 v34, v220, 0, vcc
    ds_read_b64 a[40:41], v18 offset:1280
    ds_read_b64 a[42:43], v18 offset:9472
    ds_read_b64 a[44:45], v18 offset:17664
    s_waitcnt lgkmcnt(6)
    v_mfma_f32_32x32x16_bf16 v[108:123], a[48:51], v[224:227], 0
    v_cndmask_b32_e64 v50, 0, v220, vcc
    v_cmp_gt_i32 vcc, 17, v13
    v_cndmask_b32_e64 v35, v220, 0, s[20:21]
    v_cndmask_b32_e64 v51, 0, v220, s[20:21]
    v_cmp_gt_i32 s[20:21], 18, v13
    v_mfma_f32_32x32x16_bf16 v[108:123], a[52:55], v[228:231], v[108:123]
    v_cndmask_b32_e64 v36, v220, 0, s[22:23]
    v_cndmask_b32_e64 v52, 0, v220, s[22:23]
    v_cmp_gt_i32 s[22:23], 19, v13
    v_cndmask_b32_e64 v37, v220, 0, vcc
    v_cndmask_b32_e64 v53, 0, v220, vcc
    v_cmp_gt_i32 vcc, 24, v13
    ds_read_b64 a[48:49], v18 offset:1536
    ds_read_b64 a[50:51], v18 offset:9728
    ds_read_b64 a[52:53], v18 offset:17920
    s_waitcnt lgkmcnt(6)
    v_mfma_f32_32x32x16_bf16 v[140:155], a[32:35], v[232:235], 0
    v_cndmask_b32_e64 v38, v220, 0, s[20:21]
    v_cndmask_b32_e64 v54, 0, v220, s[20:21]
    v_cmp_gt_i32 s[20:21], 25, v13
    v_cndmask_b32_e64 v39, v220, 0, s[22:23]
    v_cndmask_b32_e64 v55, 0, v220, s[22:23]
    v_mfma_f32_32x32x16_bf16 v[140:155], a[36:39], v[236:239], v[140:155]
    v_cmp_gt_i32 s[22:23], 26, v13
    v_cndmask_b32_e64 v40, v220, 0, vcc
    v_cndmask_b32_e64 v56, 0, v220, vcc
    v_cmp_gt_i32 vcc, 27, v13
    v_cndmask_b32_e64 v41, v220, 0, s[20:21]
    v_cndmask_b32_e64 v57, 0, v220, s[20:21]
    ds_read_b64 a[32:33], v18 offset:1792
    ds_read_b64 a[34:35], v18 offset:9984
    ds_read_b64 a[36:37], v18 offset:18176
    s_waitcnt lgkmcnt(6)
    v_mfma_f32_32x32x16_bf16 v[156:171], a[40:43], v[232:235], 0
    v_cndmask_b32_e64 v42, v220, 0, s[22:23]
    v_cndmask_b32_e64 v58, 0, v220, s[22:23]
    v_cndmask_b32_e64 v43, v220, 0, vcc
    v_cndmask_b32_e64 v59, 0, v220, vcc
    v_max3_f32 v20, v76, v77, v78
    v_mfma_f32_32x32x16_bf16 v[156:171], a[44:47], v[236:239], v[156:171]
    v_max3_f32 v21, v79, v80, v81
    v_max3_f32 v20, v20, v82, v83
    v_max3_f32 v21, v21, v84, v85
    v_max3_f32 v20, v20, v86, v87
    v_max3_f32 v21, v21, v88, v89
    v_max3_f32 v20, v20, v90, v91
    ds_read_b64 a[40:41], v16 offset:2048
    ds_read_b64 a[42:43], v16 offset:10240
    ds_read_b64 a[44:45], v16 offset:18432
    s_waitcnt lgkmcnt(6)
    v_mfma_f32_32x32x16_bf16 v[172:187], a[48:51], v[232:235], 0
    v_max3_f32 v20, v20, v92, v93
    v_max3_f32 v21, v21, v94, v95
    v_max3_f32 v20, v20, v96, v97
    v_max3_f32 v21, v21, v98, v99
    v_max3_f32 v20, v20, v100, v101
    v_mfma_f32_32x32x16_bf16 v[172:187], a[52:55], v[236:239], v[172:187]
    v_max3_f32 v21, v21, v102, v103
    v_max3_f32 v20, v20, v104, v105
    v_max3_f32 v21, v21, v106, v107
    v_max3_f32 v20, v20, v108, v109
    v_max3_f32 v21, v21, v110, v111
    v_max3_f32 v20, v20, v112, v113
    ds_read_b64 a[48:49], v18 offset:2048
    ds_read_b64 a[50:51], v18 offset:10240
    ds_read_b64 a[52:53], v18 offset:18432
    s_waitcnt lgkmcnt(6)
    v_mfma_f32_32x32x16_bf16 v[188:203], a[32:35], v[232:235], 0
    v_max3_f32 v21, v21, v114, v115
    v_max3_f32 v20, v20, v116, v117
    v_max3_f32 v21, v21, v118, v119
    v_max3_f32 v20, v20, v120, v121
    v_max3_f32 v21, v21, v122, v123
    v_mfma_f32_32x32x16_bf16 v[188:203], a[36:39], v[236:239], v[188:203]
    v_max3_f32 v22, v140, v141, v142
    v_max3_f32 v23, v143, v144, v145
    v_max3_f32 v22, v22, v146, v147
    v_max3_f32 v23, v23, v148, v149
    v_max3_f32 v22, v22, v150, v151
    v_max3_f32 v23, v23, v152, v153
    s_waitcnt lgkmcnt(3)
    v_mfma_f32_32x32x16_bf16 v[124:139], a[40:43], v[224:227], v[44:59]
    v_max3_f32 v22, v22, v154, v155
    v_max3_f32 v22, v22, v156, v157
    v_max3_f32 v23, v23, v158, v159
    v_max3_f32 v22, v22, v160, v161
    v_max3_f32 v23, v23, v162, v163
    v_mfma_f32_32x32x16_bf16 v[124:139], a[44:47], v[228:231], v[124:139]
    v_max3_f32 v22, v22, v164, v165
    v_max3_f32 v23, v23, v166, v167
    v_max3_f32 v22, v22, v168, v169
    v_max3_f32 v23, v23, v170, v171
    v_max3_f32 v22, v22, v172, v173
    v_max3_f32 v23, v23, v174, v175
    s_waitcnt lgkmcnt(0)
    v_mfma_f32_32x32x16_bf16 v[204:219], a[48:51], v[232:235], v[44:59]
    v_max3_f32 v22, v22, v176, v177
    v_max3_f32 v23, v23, v178, v179
    v_max3_f32 v22, v22, v180, v181
    v_max3_f32 v23, v23, v182, v183
    v_max3_f32 v22, v22, v184, v185
    v_mfma_f32_32x32x16_bf16 v[204:219], a[52:55], v[236:239], v[204:219]
    v_max3_f32 v23, v23, v186, v187
    v_max3_f32 v22, v22, v188, v189
    v_max3_f32 v23, v23, v190, v191
    v_max3_f32 v22, v22, v192, v193
    v_max3_f32 v23, v23, v194, v195
    v_max3_f32 v22, v22, v196, v197
    ds_read_b64_tr_b16 a[56:57], v17 offset:1280
    ds_read_b64_tr_b16 a[58:59], v17 offset:1344
    ds_read_b64_tr_b16 a[60:61], v17 offset:1408
    ds_read_b64_tr_b16 a[62:63], v17 offset:1472
    v_max3_f32 v23, v23, v198, v199
    v_max3_f32 v22, v22, v200, v201
    v_max3_f32 v23, v23, v202, v203
    v_max3_f32 v20, v20, v124, v125
    v_max3_f32 v21, v21, v126, v127
    v_max3_f32 v20, v20, v128, v129
    v_max3_f32 v21, v21, v130, v131
    v_max3_f32 v20, v20, v132, v133
    v_max3_f32 v21, v21, v134, v135
    v_max3_f32 v20, v20, v136, v137
    v_max3_f32 v21, v21, v138, v139
    v_max3_f32 v22, v22, v204, v205
    v_max3_f32 v23, v23, v206, v207
    v_max3_f32 v22, v22, v208, v209
    v_max3_f32 v23, v23, v210, v211
    v_max3_f32 v22, v22, v212, v213
    v_max3_f32 v23, v23, v214, v215
    v_max3_f32 v22, v22, v216, v217
    v_max3_f32 v23, v23, v218, v219
    v_max_f32 v20, v20, v21
    v_mov_b32 v21, v20
    s_nop 1
    v_permlane32_swap_b32 v20, v21
    v_max_f32 v20, v20, v21
    v_mov_b32 v252, v20
    v_mul_f32 v24, 0xbea52b5c, v20
    v_mov_b32 v25, v24
    v_max_f32 v22, v22, v23
    v_mov_b32 v23, v22
    s_nop 1
    v_permlane32_swap_b32 v22, v23
    v_max_f32 v22, v22, v23
    v_mov_b32 v253, v22
    v_mul_f32 v26, 0xbea52b5c, v22
    v_mov_b32 v27, v26
    s_waitcnt vmcnt(0)
    s_barrier
    ds_read_b64_tr_b16 a[64:65], v17 offset:1536
    ds_read_b64_tr_b16 a[66:67], v17 offset:1600
    ds_read_b64_tr_b16 a[68:69], v17 offset:1664
    ds_read_b64_tr_b16 a[70:71], v17 offset:1728
    v_pk_fma_f32 v[76:77], v[76:77], s[28:29], v[24:25]
    v_pk_fma_f32 v[78:79], v[78:79], s[28:29], v[24:25]
    v_pk_fma_f32 v[80:81], v[80:81], s[28:29], v[24:25]
    v_pk_fma_f32 v[82:83], v[82:83], s[28:29], v[24:25]
    v_pk_fma_f32 v[84:85], v[84:85], s[28:29], v[24:25]
    v_pk_fma_f32 v[86:87], v[86:87], s[28:29], v[24:25]
    v_pk_fma_f32 v[88:89], v[88:89], s[28:29], v[24:25]
    v_pk_fma_f32 v[90:91], v[90:91], s[28:29], v[24:25]
    v_exp_f32 v76, v76
    v_exp_f32 v77, v77
    v_exp_f32 v78, v78
    v_exp_f32 v79, v79
    v_exp_f32 v80, v80
    v_exp_f32 v81, v81
    v_exp_f32 v82, v82
    v_exp_f32 v83, v83
    v_exp_f32 v84, v84
    v_exp_f32 v85, v85
    v_exp_f32 v86, v86
    v_exp_f32 v87, v87
    v_exp_f32 v88, v88
    v_exp_f32 v89, v89
    v_exp_f32 v90, v90
    v_exp_f32 v91, v91
    v_cvt_pk_bf16_f32 v60, v76, v77
    v_cvt_pk_bf16_f32 v61, v78, v79
    v_cvt_pk_bf16_f32 v62, v80, v81
    v_cvt_pk_bf16_f32 v63, v82, v83
    v_cvt_pk_bf16_f32 v64, v84, v85
    v_cvt_pk_bf16_f32 v65, v86, v87
    v_cvt_pk_bf16_f32 v66, v88, v89
    v_cvt_pk_bf16_f32 v67, v90, v91
    s_lshl_b32 s19, s12, 3
    s_add_u32 s20, s19, s3
    s_sub_u32 s21, 7, s3
    s_add_u32 s21, s21, s19
    s_mul_i32 s20, s20, 40960
    s_mul_i32 s21, s21, 40960
    s_lshl_b32 s22, s13, 10
    s_add_u32 s22, s22, 1048576
    s_add_u32 s36, s20, s22
    s_add_u32 s37, s21, s22
    s_lshr_b32 s23, s13, 2
    s_add_u32 s23, s23, 32
    s_lshl_b32 s23, s23, 10
    s_bfe_u32 s22, s13, 0x10001
    s_lshl_b32 s22, s22, 9
    s_add_u32 s23, s23, s22
    s_and_b32 s22, s13, 1
    s_lshl_b32 s22, s22, 3
    s_add_u32 s23, s23, s22
    s_add_u32 s23, s23, 1048576
    s_add_u32 s38, s20, s23
    s_add_u32 s39, s21, s23
    s_lshr_b32 s26, s13, 2
    s_mul_i32 s26, s26, 102400
    s_mul_i32 s27, s3, 25600
    s_add_u32 s26, s26, s27
    s_add_u32 s26, s26, 41943040
    s_add_u32 s19, s12, 7
    s_and_b32 s19, s19, 7
    s_mul_i32 s19, s19, 786432
    s_add_u32 s19, s19, 8388608
    s_mul_i32 s20, s13, 24576
    s_mul_i32 s21, s3, 6144
    s_add_u32 s20, s20, s21
    s_add_u32 s20, s20, s19
    s_lshl_b32 s21, s13, 12
    s_lshl_b32 s22, s3, 10
    s_add_u32 s21, s21, s22
    s_add_u32 s21, s21, s19
    s_add_u32 s21, s21, 655360
    s_cmp_eq_u32 s12, 0
    s_cselect_b32 s16, s20, s21
    s_cselect_b32 s25, 48, 8
    s_lshl_b32 s22, s12, 15
    s_lshl_b32 s23, s13, 10
    s_add_u32 s22, s22, s23
    s_lshl_b32 s23, s3, 8
    s_add_u32 s22, s22, s23
    s_add_u32 s17, s22, 65536
    v_lshlrev_b32 v4, 7, v2
    s_mov_b32 s32, s40
    s_mov_b32 s33, s41
    s_mov_b32 s34, 2621440
    s_mov_b32 s35, 0x20000
    s_lshl_b32 s19, s12, 8
    s_and_b32 s20, s13, 3
    s_lshl_b32 s20, s20, 6
    s_add_u32 s19, s19, s20
    s_and_b32 s20, s3, 1
    s_lshl_b32 s20, s20, 5
    s_add_u32 s19, s19, s20
    v_and_b32 v8, 31, v2
    v_add_u32 v8, s19, v8
    v_mul_u32_u24 v8, 1280, v8
    v_lshrrev_b32 v14, 5, v2
    v_lshl_add_u32 v8, v14, 3, v8
    s_lshr_b32 s19, s13, 2
    s_mul_i32 s19, s19, 5
    s_lshr_b32 s20, s3, 1
    s_mul_i32 s20, s20, 3
    s_add_u32 s19, s19, s20
    s_lshl_b32 s43, s19, 5
    s_lshl_b32 s30, s12, 13
    s_add_u32 s30, s30, s43
    s_add_u32 s30, s30, 458752
    v_lshlrev_b32 v15, 4, v14
    ds_read_b64_tr_b16 a[72:73], v17 offset:1792
    ds_read_b64_tr_b16 a[74:75], v17 offset:1856
    ds_read_b64_tr_b16 a[76:77], v17 offset:1920
    ds_read_b64_tr_b16 a[78:79], v17 offset:1984
    v_pk_fma_f32 v[92:93], v[92:93], s[28:29], v[24:25]
    v_pk_fma_f32 v[94:95], v[94:95], s[28:29], v[24:25]
    v_pk_fma_f32 v[96:97], v[96:97], s[28:29], v[24:25]
    s_waitcnt lgkmcnt(8)
    v_mfma_f32_32x32x16_bf16 a[80:95], a[56:59], v[60:63], 0
    v_pk_fma_f32 v[98:99], v[98:99], s[28:29], v[24:25]
    v_pk_fma_f32 v[100:101], v[100:101], s[28:29], v[24:25]
    v_pk_fma_f32 v[102:103], v[102:103], s[28:29], v[24:25]
    v_pk_fma_f32 v[104:105], v[104:105], s[28:29], v[24:25]
    v_pk_fma_f32 v[106:107], v[106:107], s[28:29], v[24:25]
    v_exp_f32 v92, v92
    v_exp_f32 v93, v93
    v_exp_f32 v94, v94
    v_exp_f32 v95, v95
    v_exp_f32 v96, v96
    v_exp_f32 v97, v97
    v_exp_f32 v98, v98
    v_exp_f32 v99, v99
    v_exp_f32 v100, v100
    v_mfma_f32_32x32x16_bf16 a[80:95], a[60:63], v[64:67], a[80:95]
    v_exp_f32 v101, v101
    v_exp_f32 v102, v102
    v_exp_f32 v103, v103
    v_exp_f32 v104, v104
    v_exp_f32 v105, v105
    v_exp_f32 v106, v106
    v_exp_f32 v107, v107
    v_cvt_pk_bf16_f32 v68, v92, v93
    v_cvt_pk_bf16_f32 v69, v94, v95
    v_cvt_pk_bf16_f32 v70, v96, v97
    v_cvt_pk_bf16_f32 v71, v98, v99
    v_cvt_pk_bf16_f32 v72, v100, v101
    v_cvt_pk_bf16_f32 v73, v102, v103
    v_cvt_pk_bf16_f32 v74, v104, v105
    v_cvt_pk_bf16_f32 v75, v106, v107
    ds_read_b64_tr_b16 a[56:57], v17 offset:2048
    ds_read_b64_tr_b16 a[58:59], v17 offset:2112
    ds_read_b64_tr_b16 a[60:61], v17 offset:2176
    ds_read_b64_tr_b16 a[62:63], v17 offset:2240
    v_pk_fma_f32 v[108:109], v[108:109], s[28:29], v[24:25]
    v_pk_fma_f32 v[110:111], v[110:111], s[28:29], v[24:25]
    v_pk_fma_f32 v[112:113], v[112:113], s[28:29], v[24:25]
    s_waitcnt lgkmcnt(8)
    v_mfma_f32_32x32x16_bf16 a[80:95], a[64:67], v[68:71], a[80:95]
    v_pk_fma_f32 v[114:115], v[114:115], s[28:29], v[24:25]
    v_pk_fma_f32 v[116:117], v[116:117], s[28:29], v[24:25]
    v_pk_fma_f32 v[118:119], v[118:119], s[28:29], v[24:25]
    v_pk_fma_f32 v[120:121], v[120:121], s[28:29], v[24:25]
    v_pk_fma_f32 v[122:123], v[122:123], s[28:29], v[24:25]
    v_exp_f32 v108, v108
    v_exp_f32 v109, v109
    v_exp_f32 v110, v110
    v_exp_f32 v111, v111
    v_exp_f32 v112, v112
    v_exp_f32 v113, v113
    v_exp_f32 v114, v114
    v_exp_f32 v115, v115
    v_exp_f32 v116, v116
    v_mfma_f32_32x32x16_bf16 a[80:95], a[68:71], v[72:75], a[80:95]
    v_exp_f32 v117, v117
    v_exp_f32 v118, v118
    v_exp_f32 v119, v119
    v_exp_f32 v120, v120
    v_exp_f32 v121, v121
    v_exp_f32 v122, v122
    v_exp_f32 v123, v123
    v_cvt_pk_bf16_f32 v60, v108, v109
    v_cvt_pk_bf16_f32 v61, v110, v111
    v_cvt_pk_bf16_f32 v62, v112, v113
    v_cvt_pk_bf16_f32 v63, v114, v115
    v_cvt_pk_bf16_f32 v64, v116, v117
    v_cvt_pk_bf16_f32 v65, v118, v119
    v_cvt_pk_bf16_f32 v66, v120, v121
    v_cvt_pk_bf16_f32 v67, v122, v123
    ds_read_b64_tr_b16 a[64:65], v19 offset:1024
    ds_read_b64_tr_b16 a[66:67], v19 offset:1088
    ds_read_b64_tr_b16 a[68:69], v19 offset:1152
    ds_read_b64_tr_b16 a[70:71], v19 offset:1216
    v_pk_fma_f32 v[124:125], v[124:125], s[28:29], v[24:25]
    v_pk_fma_f32 v[126:127], v[126:127], s[28:29], v[24:25]
    v_pk_fma_f32 v[128:129], v[128:129], s[28:29], v[24:25]
    s_waitcnt lgkmcnt(8)
    v_mfma_f32_32x32x16_bf16 a[80:95], a[72:75], v[60:63], a[80:95]
    v_pk_fma_f32 v[130:131], v[130:131], s[28:29], v[24:25]
    v_pk_fma_f32 v[132:133], v[132:133], s[28:29], v[24:25]
    v_pk_fma_f32 v[134:135], v[134:135], s[28:29], v[24:25]
    v_pk_fma_f32 v[136:137], v[136:137], s[28:29], v[24:25]
    v_pk_fma_f32 v[138:139], v[138:139], s[28:29], v[24:25]
    v_exp_f32 v124, v124
    v_exp_f32 v125, v125
    v_exp_f32 v126, v126
    v_exp_f32 v127, v127
    v_exp_f32 v128, v128
    v_exp_f32 v129, v129
    v_exp_f32 v130, v130
    v_exp_f32 v131, v131
    v_exp_f32 v132, v132
    v_mfma_f32_32x32x16_bf16 a[80:95], a[76:79], v[64:67], a[80:95]
    v_exp_f32 v133, v133
    v_exp_f32 v134, v134
    v_exp_f32 v135, v135
    v_exp_f32 v136, v136
    v_exp_f32 v137, v137
    v_exp_f32 v138, v138
    v_exp_f32 v139, v139
    v_cvt_pk_bf16_f32 v68, v124, v125
    v_cvt_pk_bf16_f32 v69, v126, v127
    v_cvt_pk_bf16_f32 v70, v128, v129
    v_cvt_pk_bf16_f32 v71, v130, v131
    v_cvt_pk_bf16_f32 v72, v132, v133
    v_cvt_pk_bf16_f32 v73, v134, v135
    v_cvt_pk_bf16_f32 v74, v136, v137
    v_cvt_pk_bf16_f32 v75, v138, v139
    ds_read_b64_tr_b16 a[72:73], v19 offset:1280
    ds_read_b64_tr_b16 a[74:75], v19 offset:1344
    ds_read_b64_tr_b16 a[76:77], v19 offset:1408
    ds_read_b64_tr_b16 a[78:79], v19 offset:1472
    v_pk_fma_f32 v[140:141], v[140:141], s[28:29], v[26:27]
    v_pk_fma_f32 v[142:143], v[142:143], s[28:29], v[26:27]
    v_pk_fma_f32 v[144:145], v[144:145], s[28:29], v[26:27]
    s_waitcnt lgkmcnt(8)
    v_mfma_f32_32x32x16_bf16 a[80:95], a[56:59], v[68:71], a[80:95]
    v_pk_fma_f32 v[146:147], v[146:147], s[28:29], v[26:27]
    v_pk_fma_f32 v[148:149], v[148:149], s[28:29], v[26:27]
    v_pk_fma_f32 v[150:151], v[150:151], s[28:29], v[26:27]
    v_pk_fma_f32 v[152:153], v[152:153], s[28:29], v[26:27]
    v_pk_fma_f32 v[154:155], v[154:155], s[28:29], v[26:27]
    v_exp_f32 v140, v140
    v_exp_f32 v141, v141
    v_exp_f32 v142, v142
    v_exp_f32 v143, v143
    v_exp_f32 v144, v144
    v_exp_f32 v145, v145
    v_exp_f32 v146, v146
    v_exp_f32 v147, v147
    v_exp_f32 v148, v148
    v_mfma_f32_32x32x16_bf16 a[80:95], a[60:63], v[72:75], a[80:95]
    v_exp_f32 v149, v149
    v_exp_f32 v150, v150
    v_exp_f32 v151, v151
    v_exp_f32 v152, v152
    v_exp_f32 v153, v153
    v_exp_f32 v154, v154
    v_exp_f32 v155, v155
    v_cvt_pk_bf16_f32 v60, v140, v141
    v_cvt_pk_bf16_f32 v61, v142, v143
    v_cvt_pk_bf16_f32 v62, v144, v145
    v_cvt_pk_bf16_f32 v63, v146, v147
    v_cvt_pk_bf16_f32 v64, v148, v149
    v_cvt_pk_bf16_f32 v65, v150, v151
    v_cvt_pk_bf16_f32 v66, v152, v153
    v_cvt_pk_bf16_f32 v67, v154, v155
    ds_read_b64_tr_b16 a[56:57], v19 offset:1536
    ds_read_b64_tr_b16 a[58:59], v19 offset:1600
    ds_read_b64_tr_b16 a[60:61], v19 offset:1664
    ds_read_b64_tr_b16 a[62:63], v19 offset:1728
    v_pk_fma_f32 v[156:157], v[156:157], s[28:29], v[26:27]
    v_pk_fma_f32 v[158:159], v[158:159], s[28:29], v[26:27]
    v_pk_fma_f32 v[160:161], v[160:161], s[28:29], v[26:27]
    s_waitcnt lgkmcnt(8)
    v_mfma_f32_32x32x16_bf16 a[96:111], a[64:67], v[60:63], 0
    v_pk_fma_f32 v[162:163], v[162:163], s[28:29], v[26:27]
    v_pk_fma_f32 v[164:165], v[164:165], s[28:29], v[26:27]
    v_pk_fma_f32 v[166:167], v[166:167], s[28:29], v[26:27]
    v_pk_fma_f32 v[168:169], v[168:169], s[28:29], v[26:27]
    v_pk_fma_f32 v[170:171], v[170:171], s[28:29], v[26:27]
    v_exp_f32 v156, v156
    v_exp_f32 v157, v157
    v_exp_f32 v158, v158
    v_exp_f32 v159, v159
    v_exp_f32 v160, v160
    v_exp_f32 v161, v161
    v_exp_f32 v162, v162
    v_exp_f32 v163, v163
    v_exp_f32 v164, v164
    v_mfma_f32_32x32x16_bf16 a[96:111], a[68:71], v[64:67], a[96:111]
    v_exp_f32 v165, v165
    v_exp_f32 v166, v166
    v_exp_f32 v167, v167
    v_exp_f32 v168, v168
    v_exp_f32 v169, v169
    v_exp_f32 v170, v170
    v_exp_f32 v171, v171
    v_cvt_pk_bf16_f32 v68, v156, v157
    v_cvt_pk_bf16_f32 v69, v158, v159
    v_cvt_pk_bf16_f32 v70, v160, v161
    v_cvt_pk_bf16_f32 v71, v162, v163
    v_cvt_pk_bf16_f32 v72, v164, v165
    v_cvt_pk_bf16_f32 v73, v166, v167
    v_cvt_pk_bf16_f32 v74, v168, v169
    v_cvt_pk_bf16_f32 v75, v170, v171
    s_barrier
    s_cmp_eq_u32 s12, 0
    s_cbranch_scc1 AT_NH_62
    s_sub_u32 s22, s24, 771072
    s_mov_b32 m0, 148032
    s_nop 0
    buffer_load_dwordx4 v3, s[8:11], s22 offen sc1 lds
    s_mov_b32 m0, 151136
    s_add_u32 s22, s22, 1024
    buffer_load_dwordx4 v3, s[8:11], s22 offen sc1 lds
    s_mov_b32 m0, 152160
    s_add_u32 s22, s22, 1024
    buffer_load_dwordx4 v3, s[8:11], s22 offen sc1 lds
    s_mov_b32 m0, 155264
    s_add_u32 s22, s22, 1024
    buffer_load_dwordx4 v3, s[8:11], s22 offen sc1 lds
    s_mov_b32 m0, 156288
    s_add_u32 s22, s22, 1024
    buffer_load_dwordx4 v3, s[8:11], s22 offen sc1 lds
AT_NH_62:
    ds_read_b64_tr_b16 a[64:65], v19 offset:1792
    ds_read_b64_tr_b16 a[66:67], v19 offset:1856
    ds_read_b64_tr_b16 a[68:69], v19 offset:1920
    ds_read_b64_tr_b16 a[70:71], v19 offset:1984
    v_pk_fma_f32 v[172:173], v[172:173], s[28:29], v[26:27]
    v_pk_fma_f32 v[174:175], v[174:175], s[28:29], v[26:27]
    v_pk_fma_f32 v[176:177], v[176:177], s[28:29], v[26:27]
    s_waitcnt lgkmcnt(8)
    v_mfma_f32_32x32x16_bf16 a[96:111], a[72:75], v[68:71], a[96:111]
    v_pk_fma_f32 v[178:179], v[178:179], s[28:29], v[26:27]
    v_pk_fma_f32 v[180:181], v[180:181], s[28:29], v[26:27]
    v_pk_fma_f32 v[182:183], v[182:183], s[28:29], v[26:27]
    v_pk_fma_f32 v[184:185], v[184:185], s[28:29], v[26:27]
    v_pk_fma_f32 v[186:187], v[186:187], s[28:29], v[26:27]
    v_exp_f32 v172, v172
    v_exp_f32 v173, v173
    v_exp_f32 v174, v174
    v_exp_f32 v175, v175
    v_exp_f32 v176, v176
    v_exp_f32 v177, v177
    v_exp_f32 v178, v178
    v_exp_f32 v179, v179
    v_exp_f32 v180, v180
    v_mfma_f32_32x32x16_bf16 a[96:111], a[76:79], v[72:75], a[96:111]
    v_exp_f32 v181, v181
    v_exp_f32 v182, v182
    v_exp_f32 v183, v183
    v_exp_f32 v184, v184
    v_exp_f32 v185, v185
    v_exp_f32 v186, v186
    v_exp_f32 v187, v187
    v_cvt_pk_bf16_f32 v60, v172, v173
    v_cvt_pk_bf16_f32 v61, v174, v175
    v_cvt_pk_bf16_f32 v62, v176, v177
    v_cvt_pk_bf16_f32 v63, v178, v179
    v_cvt_pk_bf16_f32 v64, v180, v181
    v_cvt_pk_bf16_f32 v65, v182, v183
    v_cvt_pk_bf16_f32 v66, v184, v185
    v_cvt_pk_bf16_f32 v67, v186, v187
    ds_read_b64_tr_b16 a[72:73], v19 offset:2048
    ds_read_b64_tr_b16 a[74:75], v19 offset:2112
    ds_read_b64_tr_b16 a[76:77], v19 offset:2176
    ds_read_b64_tr_b16 a[78:79], v19 offset:2240
    v_pk_fma_f32 v[188:189], v[188:189], s[28:29], v[26:27]
    v_pk_fma_f32 v[190:191], v[190:191], s[28:29], v[26:27]
    v_pk_fma_f32 v[192:193], v[192:193], s[28:29], v[26:27]
    s_waitcnt lgkmcnt(8)
    v_mfma_f32_32x32x16_bf16 a[96:111], a[56:59], v[60:63], a[96:111]
    v_pk_fma_f32 v[194:195], v[194:195], s[28:29], v[26:27]
    v_pk_fma_f32 v[196:197], v[196:197], s[28:29], v[26:27]
    v_pk_fma_f32 v[198:199], v[198:199], s[28:29], v[26:27]
    v_pk_fma_f32 v[200:201], v[200:201], s[28:29], v[26:27]
    v_pk_fma_f32 v[202:203], v[202:203], s[28:29], v[26:27]
    v_exp_f32 v188, v188
    v_exp_f32 v189, v189
    v_exp_f32 v190, v190
    v_exp_f32 v191, v191
    v_exp_f32 v192, v192
    v_exp_f32 v193, v193
    v_exp_f32 v194, v194
    v_exp_f32 v195, v195
    v_exp_f32 v196, v196
    v_mfma_f32_32x32x16_bf16 a[96:111], a[60:63], v[64:67], a[96:111]
    v_exp_f32 v197, v197
    v_exp_f32 v198, v198
    v_exp_f32 v199, v199
    v_exp_f32 v200, v200
    v_exp_f32 v201, v201
    v_exp_f32 v202, v202
    v_exp_f32 v203, v203
    v_cvt_pk_bf16_f32 v68, v188, v189
    v_cvt_pk_bf16_f32 v69, v190, v191
    v_cvt_pk_bf16_f32 v70, v192, v193
    v_cvt_pk_bf16_f32 v71, v194, v195
    v_cvt_pk_bf16_f32 v72, v196, v197
    v_cvt_pk_bf16_f32 v73, v198, v199
    v_cvt_pk_bf16_f32 v74, v200, v201
    v_cvt_pk_bf16_f32 v75, v202, v203
    v_pk_fma_f32 v[204:205], v[204:205], s[28:29], v[26:27]
    v_pk_fma_f32 v[206:207], v[206:207], s[28:29], v[26:27]
    v_pk_fma_f32 v[208:209], v[208:209], s[28:29], v[26:27]
    s_waitcnt lgkmcnt(4)
    v_mfma_f32_32x32x16_bf16 a[96:111], a[64:67], v[68:71], a[96:111]
    v_pk_fma_f32 v[210:211], v[210:211], s[28:29], v[26:27]
    v_pk_fma_f32 v[212:213], v[212:213], s[28:29], v[26:27]
    v_pk_fma_f32 v[214:215], v[214:215], s[28:29], v[26:27]
    v_pk_fma_f32 v[216:217], v[216:217], s[28:29], v[26:27]
    v_pk_fma_f32 v[218:219], v[218:219], s[28:29], v[26:27]
    v_exp_f32 v204, v204
    v_exp_f32 v205, v205
    v_exp_f32 v206, v206
    v_exp_f32 v207, v207
    v_exp_f32 v208, v208
    v_exp_f32 v209, v209
    v_exp_f32 v210, v210
    v_exp_f32 v211, v211
    v_exp_f32 v212, v212
    v_mfma_f32_32x32x16_bf16 a[96:111], a[68:71], v[72:75], a[96:111]
    v_exp_f32 v213, v213
    v_exp_f32 v214, v214
    v_exp_f32 v215, v215
    v_exp_f32 v216, v216
    v_exp_f32 v217, v217
    v_exp_f32 v218, v218
    v_exp_f32 v219, v219
    v_cvt_pk_bf16_f32 v60, v204, v205
    v_cvt_pk_bf16_f32 v61, v206, v207
    v_cvt_pk_bf16_f32 v62, v208, v209
    v_cvt_pk_bf16_f32 v63, v210, v211
    v_cvt_pk_bf16_f32 v64, v212, v213
    v_cvt_pk_bf16_f32 v65, v214, v215
    v_cvt_pk_bf16_f32 v66, v216, v217
    v_cvt_pk_bf16_f32 v67, v218, v219
    s_waitcnt lgkmcnt(0)
    v_mfma_f32_32x32x16_bf16 a[96:111], a[72:75], v[60:63], a[96:111]
    v_mfma_f32_32x32x16_bf16 a[96:111], a[76:79], v[64:67], a[96:111]
    s_add_u32 m0, s27, 0
    s_nop 0
    buffer_load_dwordx4 v3, s[8:11], s26 offen offset:0 lds
    buffer_load_dwordx4 v3, s[8:11], s26 offen offset:1024 lds
    buffer_load_dwordx4 v3, s[8:11], s26 offen offset:2048 lds
    buffer_load_dwordx4 v3, s[8:11], s26 offen offset:3072 lds
    s_add_u32 m0, s27, 4096
    s_add_u32 s26, s26, 4096
    buffer_load_dwordx4 v3, s[8:11], s26 offen offset:0 lds
    buffer_load_dwordx4 v3, s[8:11], s26 offen offset:1024 lds
    buffer_load_dwordx4 v3, s[8:11], s26 offen offset:2048 lds
    buffer_load_dwordx4 v3, s[8:11], s26 offen offset:3072 lds
    s_add_u32 m0, s27, 8192
    s_add_u32 s26, s26, 4096
    buffer_load_dwordx4 v3, s[8:11], s26 offen offset:0 lds
    buffer_load_dwordx4 v3, s[8:11], s26 offen offset:1024 lds
    buffer_load_dwordx4 v3, s[8:11], s26 offen offset:2048 lds
    buffer_load_dwordx4 v3, s[8:11], s26 offen offset:3072 lds
    s_waitcnt vmcnt(12) lgkmcnt(0)
    s_barrier
    ds_read_b64 a[32:33], v16 offset:0
    ds_read_b64 a[34:35], v16 offset:8192
    ds_read_b64 a[36:37], v16 offset:16384
    ds_read_b64 a[40:41], v16 offset:256
    ds_read_b64 a[42:43], v16 offset:8448
    ds_read_b64 a[44:45], v16 offset:16640
    ds_read_b64 a[48:49], v16 offset:512
    ds_read_b64 a[50:51], v16 offset:8704
    ds_read_b64 a[52:53], v16 offset:16896
    s_waitcnt lgkmcnt(6)
    v_mfma_f32_32x32x16_bf16 v[76:91], a[32:35], v[224:227], v[28:43]
    v_mfma_f32_32x32x16_bf16 v[76:91], a[36:39], v[228:231], v[76:91]
    ds_read_b64 a[32:33], v16 offset:768
    ds_read_b64 a[34:35], v16 offset:8960
    ds_read_b64 a[36:37], v16 offset:17152
    s_waitcnt lgkmcnt(6)
    v_mfma_f32_32x32x16_bf16 v[92:107], a[40:43], v[224:227], 0
    v_mfma_f32_32x32x16_bf16 v[92:107], a[44:47], v[228:231], v[92:107]
    ds_read_b64 a[40:41], v16 offset:1024
    ds_read_b64 a[42:43], v16 offset:9216
    ds_read_b64 a[44:45], v16 offset:17408
    s_waitcnt lgkmcnt(6)
    v_mfma_f32_32x32x16_bf16 v[108:123], a[48:51], v[224:227], 0
    v_mfma_f32_32x32x16_bf16 v[108:123], a[52:55], v[228:231], v[108:123]
    v_max3_f32 v20, v76, v77, v78
    v_max3_f32 v21, v79, v80, v81
    v_max3_f32 v20, v20, v82, v83
    v_max3_f32 v21, v21, v84, v85
    v_max3_f32 v20, v20, v86, v87
    v_max3_f32 v21, v21, v88, v89
    ds_read_b64 a[48:49], v18 offset:0
    s_add_u32 m0, s27, 12288
    s_add_u32 s26, s26, 4096
    buffer_load_dwordx4 v3, s[8:11], s26 offen offset:0 lds
    ds_read_b64 a[50:51], v18 offset:8192
    ds_read_b64 a[52:53], v18 offset:16384
    s_waitcnt lgkmcnt(6)
    v_mfma_f32_32x32x16_bf16 v[124:139], a[32:35], v[224:227], 0
    v_max3_f32 v20, v20, v90, v91
    v_mfma_f32_32x32x16_bf16 v[124:139], a[36:39], v[228:231], v[124:139]
    v_max3_f32 v20, v20, v92, v93
    s_add_u32 s31, s30, 2560
    buffer_load_dwordx4 a[156:159], v15, s[8:11], s31 offen offset:0 sc1
    v_max3_f32 v21, v21, v94, v95
    v_max3_f32 v20, v20, v96, v97
    v_max3_f32 v21, v21, v98, v99
    v_max3_f32 v20, v20, v100, v101
    v_max3_f32 v21, v21, v102, v103
    ds_read_b64 a[32:33], v18 offset:256
    ds_read_b64 a[34:35], v18 offset:8448
    ds_read_b64 a[36:37], v18 offset:16640
    s_waitcnt lgkmcnt(6)
    v_mfma_f32_32x32x16_bf16 v[140:155], a[40:43], v[224:227], 0
    v_max3_f32 v20, v20, v104, v105
    v_max3_f32 v21, v21, v106, v107
    v_mfma_f32_32x32x16_bf16 v[140:155], a[44:47], v[228:231], v[140:155]
    v_max3_f32 v20, v20, v108, v109
    v_max3_f32 v21, v21, v110, v111
    v_max3_f32 v20, v20, v112, v113
    v_max3_f32 v21, v21, v114, v115
    v_max3_f32 v20, v20, v116, v117
    v_max3_f32 v21, v21, v118, v119
    ds_read_b64 a[40:41], v18 offset:512
    ds_read_b64 a[42:43], v18 offset:8704
    ds_read_b64 a[44:45], v18 offset:16896
    s_waitcnt lgkmcnt(6)
    v_mfma_f32_32x32x16_bf16 v[156:171], a[48:51], v[232:235], v[28:43]
    s_add_u32 s31, s30, 2560
    buffer_load_dwordx4 a[160:163], v15, s[8:11], s31 offen offset:32 sc1
    v_max3_f32 v20, v20, v120, v121
    v_max3_f32 v21, v21, v122, v123
    v_mfma_f32_32x32x16_bf16 v[156:171], a[52:55], v[236:239], v[156:171]
    v_max3_f32 v20, v20, v124, v125
    v_max3_f32 v21, v21, v126, v127
    buffer_load_dwordx4 v3, s[8:11], s26 offen offset:1024 lds
    v_max3_f32 v20, v20, v128, v129
    v_max3_f32 v21, v21, v130, v131
    v_max3_f32 v20, v20, v132, v133
    v_max3_f32 v21, v21, v134, v135
    ds_read_b64 a[48:49], v18 offset:768
    ds_read_b64 a[50:51], v18 offset:8960
    ds_read_b64 a[52:53], v18 offset:17152
    s_waitcnt lgkmcnt(6)
    v_mfma_f32_32x32x16_bf16 v[172:187], a[32:35], v[232:235], 0
    v_max3_f32 v20, v20, v136, v137
    v_max3_f32 v21, v21, v138, v139
    v_mfma_f32_32x32x16_bf16 v[172:187], a[36:39], v[236:239], v[172:187]
    v_max3_f32 v20, v20, v140, v141
    v_max3_f32 v21, v21, v142, v143
    v_max3_f32 v20, v20, v144, v145
    v_max3_f32 v21, v21, v146, v147
    v_max3_f32 v20, v20, v148, v149
    v_max3_f32 v21, v21, v150, v151
    s_waitcnt lgkmcnt(3)
    v_mfma_f32_32x32x16_bf16 v[188:203], a[40:43], v[232:235], 0
    s_add_u32 s31, s30, 2560
    buffer_load_dwordx4 a[164:167], v15, s[8:11], s31 offen offset:64 sc1
    v_max3_f32 v20, v20, v152, v153
    v_max3_f32 v21, v21, v154, v155
    v_mfma_f32_32x32x16_bf16 v[188:203], a[44:47], v[236:239], v[188:203]
    v_max3_f32 v22, v156, v157, v158
    v_max3_f32 v23, v159, v160, v161
    v_max3_f32 v22, v22, v162, v163
    v_max3_f32 v23, v23, v164, v165
    v_max3_f32 v22, v22, v166, v167
    v_max3_f32 v23, v23, v168, v169
    s_waitcnt lgkmcnt(0)
    v_mfma_f32_32x32x16_bf16 v[204:219], a[48:51], v[232:235], 0
    v_max3_f32 v22, v22, v170, v171
    v_mfma_f32_32x32x16_bf16 v[204:219], a[52:55], v[236:239], v[204:219]
    v_max3_f32 v22, v22, v172, v173
    v_max3_f32 v23, v23, v174, v175
    v_max3_f32 v22, v22, v176, v177
    buffer_load_dwordx4 v3, s[8:11], s26 offen offset:2048 lds
    v_max3_f32 v23, v23, v178, v179
    v_max3_f32 v22, v22, v180, v181
    v_max3_f32 v23, v23, v182, v183
    ds_read_b64_tr_b16 a[56:57], v17 offset:0
    ds_read_b64_tr_b16 a[58:59], v17 offset:64
    ds_read_b64_tr_b16 a[60:61], v17 offset:128
    ds_read_b64_tr_b16 a[62:63], v17 offset:192
    v_max3_f32 v22, v22, v184, v185
    v_max3_f32 v23, v23, v186, v187
    s_add_u32 s31, s30, 5120
    buffer_load_dwordx4 a[168:171], v15, s[8:11], s31 offen offset:0 sc1
    v_max3_f32 v22, v22, v188, v189
    v_max3_f32 v23, v23, v190, v191
    v_max3_f32 v22, v22, v192, v193
    v_max3_f32 v23, v23, v194, v195
    v_max3_f32 v22, v22, v196, v197
    v_max3_f32 v23, v23, v198, v199
    v_max3_f32 v22, v22, v200, v201
    v_max3_f32 v23, v23, v202, v203
    v_max3_f32 v22, v22, v204, v205
    v_max3_f32 v23, v23, v206, v207
    v_max3_f32 v22, v22, v208, v209
    v_max3_f32 v23, v23, v210, v211
    v_max3_f32 v22, v22, v212, v213
    v_max3_f32 v23, v23, v214, v215
    v_max3_f32 v22, v22, v216, v217
    v_max3_f32 v23, v23, v218, v219
    v_max_f32 v20, v20, v21
    v_mov_b32 v21, v20
    s_nop 1
    v_permlane32_swap_b32 v20, v21
    v_max_f32 v20, v20, v21
    v_max_f32 v20, v20, v252
    v_sub_f32 v21, v252, v20
    v_mul_f32 v21, s28, v21
    v_exp_f32 v222, v21
    s_add_u32 s31, s30, 5120
    buffer_load_dwordx4 a[172:175], v15, s[8:11], s31 offen offset:32 sc1
    v_mul_f32 v24, 0xbea52b5c, v20
    v_mov_b32 v25, v24
    buffer_load_dwordx4 v3, s[8:11], s26 offen offset:3072 lds
    v_max_f32 v22, v22, v23
    v_mov_b32 v23, v22
    s_nop 1
    v_permlane32_swap_b32 v22, v23
    v_max_f32 v22, v22, v23
    v_max_f32 v22, v22, v253
    v_sub_f32 v23, v253, v22
    v_mul_f32 v23, s28, v23
    v_exp_f32 v223, v23
    v_mul_f32 v26, 0xbea52b5c, v22
    v_mov_b32 v27, v26
    ds_read_b64_tr_b16 a[64:65], v17 offset:256
    ds_read_b64_tr_b16 a[66:67], v17 offset:320
    ds_read_b64_tr_b16 a[68:69], v17 offset:384
    ds_read_b64_tr_b16 a[70:71], v17 offset:448
    v_pk_fma_f32 v[76:77], v[76:77], s[28:29], v[24:25]
    v_pk_fma_f32 v[78:79], v[78:79], s[28:29], v[24:25]
    v_pk_fma_f32 v[80:81], v[80:81], s[28:29], v[24:25]
    v_pk_fma_f32 v[82:83], v[82:83], s[28:29], v[24:25]
    v_pk_fma_f32 v[84:85], v[84:85], s[28:29], v[24:25]
    v_pk_fma_f32 v[86:87], v[86:87], s[28:29], v[24:25]
    v_pk_fma_f32 v[88:89], v[88:89], s[28:29], v[24:25]
    v_pk_fma_f32 v[90:91], v[90:91], s[28:29], v[24:25]
    v_exp_f32 v76, v76
    s_add_u32 s31, s30, 5120
    buffer_load_dwordx4 a[176:179], v15, s[8:11], s31 offen offset:64 sc1
    v_exp_f32 v77, v77
    v_exp_f32 v78, v78
    v_exp_f32 v79, v79
    v_exp_f32 v80, v80
    v_exp_f32 v81, v81
    v_exp_f32 v82, v82
    v_exp_f32 v83, v83
    v_exp_f32 v84, v84
    v_exp_f32 v85, v85
    v_exp_f32 v86, v86
    v_exp_f32 v87, v87
    v_exp_f32 v88, v88
    v_exp_f32 v89, v89
    s_add_u32 m0, s27, 16384
    s_add_u32 s26, s26, 4096
    buffer_load_dwordx4 v3, s[8:11], s26 offen offset:0 lds
    v_exp_f32 v90, v90
    v_exp_f32 v91, v91
    v_cvt_pk_bf16_f32 v60, v76, v77
    v_cvt_pk_bf16_f32 v61, v78, v79
    v_cvt_pk_bf16_f32 v62, v80, v81
    v_cvt_pk_bf16_f32 v63, v82, v83
    v_cvt_pk_bf16_f32 v64, v84, v85
    v_cvt_pk_bf16_f32 v65, v86, v87
    v_cvt_pk_bf16_f32 v66, v88, v89
    v_cvt_pk_bf16_f32 v67, v90, v91
    ds_read_b64_tr_b16 a[72:73], v17 offset:512
    ds_read_b64_tr_b16 a[74:75], v17 offset:576
    s_add_u32 s31, s30, 3840
    buffer_load_dwordx4 a[180:183], v15, s[8:11], s31 offen offset:0 sc1
    s_bfm_b64 exec, s25, 0
    buffer_load_dword v255, v4, s[8:11], s16 offen
    s_mov_b64 exec, 3
    buffer_load_dword v255, v4, s[8:11], s17 offen
    s_mov_b64 exec, -1
    ds_read_b64_tr_b16 a[76:77], v17 offset:640
    ds_read_b64_tr_b16 a[78:79], v17 offset:704
    v_pk_fma_f32 v[92:93], v[92:93], s[28:29], v[24:25]
    v_pk_fma_f32 v[94:95], v[94:95], s[28:29], v[24:25]
    v_pk_fma_f32 v[96:97], v[96:97], s[28:29], v[24:25]
    s_waitcnt lgkmcnt(8)
    v_mfma_f32_32x32x16_bf16 a[112:127], a[56:59], v[60:63], 0
    v_pk_fma_f32 v[98:99], v[98:99], s[28:29], v[24:25]
    v_pk_fma_f32 v[100:101], v[100:101], s[28:29], v[24:25]
    v_pk_fma_f32 v[102:103], v[102:103], s[28:29], v[24:25]
    v_pk_fma_f32 v[104:105], v[104:105], s[28:29], v[24:25]
    v_pk_fma_f32 v[106:107], v[106:107], s[28:29], v[24:25]
    v_exp_f32 v92, v92
    v_exp_f32 v93, v93
    v_exp_f32 v94, v94
    v_exp_f32 v95, v95
    v_exp_f32 v96, v96
    v_exp_f32 v97, v97
    v_exp_f32 v98, v98
    v_exp_f32 v99, v99
    v_exp_f32 v100, v100
    v_mfma_f32_32x32x16_bf16 a[112:127], a[60:63], v[64:67], a[112:127]
    v_exp_f32 v101, v101
    buffer_load_dwordx4 v3, s[8:11], s26 offen offset:1024 lds
    v_exp_f32 v102, v102
    s_add_u32 s31, s30, 3840
    buffer_load_dwordx4 a[184:187], v15, s[8:11], s31 offen offset:32 sc1
    v_exp_f32 v103, v103
    v_exp_f32 v104, v104
    v_exp_f32 v105, v105
    v_exp_f32 v106, v106
    v_exp_f32 v107, v107
    v_cvt_pk_bf16_f32 v68, v92, v93
    v_cvt_pk_bf16_f32 v69, v94, v95
    v_cvt_pk_bf16_f32 v70, v96, v97
    v_cvt_pk_bf16_f32 v71, v98, v99
    v_cvt_pk_bf16_f32 v72, v100, v101
    v_cvt_pk_bf16_f32 v73, v102, v103
    v_cvt_pk_bf16_f32 v74, v104, v105
    v_cvt_pk_bf16_f32 v75, v106, v107
    ds_read_b64_tr_b16 a[56:57], v17 offset:768
    ds_read_b64_tr_b16 a[58:59], v17 offset:832
    ds_read_b64_tr_b16 a[60:61], v17 offset:896
    ds_read_b64_tr_b16 a[62:63], v17 offset:960
    v_pk_fma_f32 v[108:109], v[108:109], s[28:29], v[24:25]
    v_pk_fma_f32 v[110:111], v[110:111], s[28:29], v[24:25]
    v_pk_fma_f32 v[112:113], v[112:113], s[28:29], v[24:25]
    s_waitcnt lgkmcnt(8)
    v_mfma_f32_32x32x16_bf16 a[112:127], a[64:67], v[68:71], a[112:127]
    v_pk_fma_f32 v[114:115], v[114:115], s[28:29], v[24:25]
    v_pk_fma_f32 v[116:117], v[116:117], s[28:29], v[24:25]
    v_pk_fma_f32 v[118:119], v[118:119], s[28:29], v[24:25]
    s_add_u32 s31, s30, 3840
    buffer_load_dwordx4 a[188:191], v15, s[8:11], s31 offen offset:64 sc1
    v_pk_fma_f32 v[120:121], v[120:121], s[28:29], v[24:25]
    v_pk_fma_f32 v[122:123], v[122:123], s[28:29], v[24:25]
    v_exp_f32 v108, v108
    v_exp_f32 v109, v109
    v_exp_f32 v110, v110
    v_exp_f32 v111, v111
    v_exp_f32 v112, v112
    v_exp_f32 v113, v113
    v_exp_f32 v114, v114
    v_exp_f32 v115, v115
    buffer_load_dwordx4 v3, s[8:11], s26 offen offset:2048 lds
    v_exp_f32 v116, v116
    v_mfma_f32_32x32x16_bf16 a[112:127], a[68:71], v[72:75], a[112:127]
    v_exp_f32 v117, v117
    v_exp_f32 v118, v118
    v_exp_f32 v119, v119
    v_exp_f32 v120, v120
    v_exp_f32 v121, v121
    v_exp_f32 v122, v122
    v_exp_f32 v123, v123
    v_cvt_pk_bf16_f32 v60, v108, v109
    v_cvt_pk_bf16_f32 v61, v110, v111
    v_cvt_pk_bf16_f32 v62, v112, v113
    v_cvt_pk_bf16_f32 v63, v114, v115
    v_cvt_pk_bf16_f32 v64, v116, v117
    v_cvt_pk_bf16_f32 v65, v118, v119
    buffer_load_dwordx2 a[144:145], v8, s[32:35], s43 offen offset:0
    v_cvt_pk_bf16_f32 v66, v120, v121
    v_cvt_pk_bf16_f32 v67, v122, v123
    ds_read_b64_tr_b16 a[64:65], v17 offset:1024
    ds_read_b64_tr_b16 a[66:67], v17 offset:1088
    ds_read_b64_tr_b16 a[68:69], v17 offset:1152
    ds_read_b64_tr_b16 a[70:71], v17 offset:1216
    v_pk_fma_f32 v[124:125], v[124:125], s[28:29], v[24:25]
    v_pk_fma_f32 v[126:127], v[126:127], s[28:29], v[24:25]
    v_pk_fma_f32 v[128:129], v[128:129], s[28:29], v[24:25]
    s_waitcnt lgkmcnt(8)
    v_mfma_f32_32x32x16_bf16 a[112:127], a[72:75], v[60:63], a[112:127]
    v_pk_fma_f32 v[130:131], v[130:131], s[28:29], v[24:25]
    v_pk_fma_f32 v[132:133], v[132:133], s[28:29], v[24:25]
    v_pk_fma_f32 v[134:135], v[134:135], s[28:29], v[24:25]
    v_pk_fma_f32 v[136:137], v[136:137], s[28:29], v[24:25]
    v_pk_fma_f32 v[138:139], v[138:139], s[28:29], v[24:25]
    v_exp_f32 v124, v124
    v_exp_f32 v125, v125
    v_exp_f32 v126, v126
    v_exp_f32 v127, v127
    v_exp_f32 v128, v128
    buffer_load_dwordx4 v3, s[8:11], s26 offen offset:3072 lds
    v_exp_f32 v129, v129
    v_exp_f32 v130, v130
    v_exp_f32 v131, v131
    buffer_load_dwordx2 a[146:147], v8, s[32:35], s43 offen offset:16
    v_exp_f32 v132, v132
    v_mfma_f32_32x32x16_bf16 a[112:127], a[76:79], v[64:67], a[112:127]
    v_exp_f32 v133, v133
    v_exp_f32 v134, v134
    v_exp_f32 v135, v135
    v_exp_f32 v136, v136
    v_exp_f32 v137, v137
    v_exp_f32 v138, v138
    v_exp_f32 v139, v139
    v_cvt_pk_bf16_f32 v68, v124, v125
    v_cvt_pk_bf16_f32 v69, v126, v127
    v_cvt_pk_bf16_f32 v70, v128, v129
    v_cvt_pk_bf16_f32 v71, v130, v131
    v_cvt_pk_bf16_f32 v72, v132, v133
    v_cvt_pk_bf16_f32 v73, v134, v135
    v_cvt_pk_bf16_f32 v74, v136, v137
    v_cvt_pk_bf16_f32 v75, v138, v139
    ds_read_b64_tr_b16 a[72:73], v19 offset:0
    ds_read_b64_tr_b16 a[74:75], v19 offset:64
    ds_read_b64_tr_b16 a[76:77], v19 offset:128
    ds_read_b64_tr_b16 a[78:79], v19 offset:192
    v_pk_fma_f32 v[140:141], v[140:141], s[28:29], v[24:25]
    v_pk_fma_f32 v[142:143], v[142:143], s[28:29], v[24:25]
    v_pk_fma_f32 v[144:145], v[144:145], s[28:29], v[24:25]
    s_waitcnt lgkmcnt(8)
    buffer_load_dwordx2 a[148:149], v8, s[32:35], s43 offen offset:32
    v_mfma_f32_32x32x16_bf16 a[112:127], a[56:59], v[68:71], a[112:127]
    v_pk_fma_f32 v[146:147], v[146:147], s[28:29], v[24:25]
    v_pk_fma_f32 v[148:149], v[148:149], s[28:29], v[24:25]
    v_pk_fma_f32 v[150:151], v[150:151], s[28:29], v[24:25]
    v_pk_fma_f32 v[152:153], v[152:153], s[28:29], v[24:25]
    v_pk_fma_f32 v[154:155], v[154:155], s[28:29], v[24:25]
    v_exp_f32 v140, v140
    s_add_u32 m0, s27, 20480
    s_add_u32 s26, s26, 4096
    buffer_load_dwordx4 v3, s[8:11], s26 offen offset:0 lds
    v_exp_f32 v141, v141
    v_exp_f32 v142, v142
    v_exp_f32 v143, v143
    v_exp_f32 v144, v144
    v_exp_f32 v145, v145
    v_exp_f32 v146, v146
    v_exp_f32 v147, v147
    v_exp_f32 v148, v148
    v_mfma_f32_32x32x16_bf16 a[112:127], a[60:63], v[72:75], a[112:127]
    v_exp_f32 v149, v149
    v_exp_f32 v150, v150
    v_exp_f32 v151, v151
    v_exp_f32 v152, v152
    v_exp_f32 v153, v153
    v_exp_f32 v154, v154
    v_exp_f32 v155, v155
    v_cvt_pk_bf16_f32 v60, v140, v141
    v_cvt_pk_bf16_f32 v61, v142, v143
    buffer_load_dwordx2 a[150:151], v8, s[32:35], s43 offen offset:48
    v_cvt_pk_bf16_f32 v62, v144, v145
    v_cvt_pk_bf16_f32 v63, v146, v147
    v_cvt_pk_bf16_f32 v64, v148, v149
    v_cvt_pk_bf16_f32 v65, v150, v151
    v_cvt_pk_bf16_f32 v66, v152, v153
    v_cvt_pk_bf16_f32 v67, v154, v155
    ds_read_b64_tr_b16 a[56:57], v19 offset:256
    ds_read_b64_tr_b16 a[58:59], v19 offset:320
    ds_read_b64_tr_b16 a[60:61], v19 offset:384
    ds_read_b64_tr_b16 a[62:63], v19 offset:448
    v_pk_fma_f32 v[156:157], v[156:157], s[28:29], v[26:27]
    v_pk_fma_f32 v[158:159], v[158:159], s[28:29], v[26:27]
    v_pk_fma_f32 v[160:161], v[160:161], s[28:29], v[26:27]
    s_waitcnt lgkmcnt(8)
    v_mfma_f32_32x32x16_bf16 a[112:127], a[64:67], v[60:63], a[112:127]
    v_pk_fma_f32 v[162:163], v[162:163], s[28:29], v[26:27]
    v_pk_fma_f32 v[164:165], v[164:165], s[28:29], v[26:27]
    v_pk_fma_f32 v[166:167], v[166:167], s[28:29], v[26:27]
    buffer_load_dwordx4 v3, s[8:11], s26 offen offset:1024 lds
    v_pk_fma_f32 v[168:169], v[168:169], s[28:29], v[26:27]
    v_pk_fma_f32 v[170:171], v[170:171], s[28:29], v[26:27]
    v_exp_f32 v156, v156
    v_exp_f32 v157, v157
    v_exp_f32 v158, v158
    v_exp_f32 v159, v159
    buffer_load_dwordx2 a[152:153], v8, s[32:35], s43 offen offset:64
    v_exp_f32 v160, v160
    v_exp_f32 v161, v161
    v_exp_f32 v162, v162
    v_exp_f32 v163, v163
    v_exp_f32 v164, v164
    v_mfma_f32_32x32x16_bf16 a[112:127], a[68:71], v[64:67], a[112:127]
    v_exp_f32 v165, v165
    v_exp_f32 v166, v166
    v_exp_f32 v167, v167
    v_exp_f32 v168, v168
    v_exp_f32 v169, v169
    v_exp_f32 v170, v170
    v_exp_f32 v171, v171
    v_cvt_pk_bf16_f32 v68, v156, v157
    v_cvt_pk_bf16_f32 v69, v158, v159
    v_cvt_pk_bf16_f32 v70, v160, v161
    v_cvt_pk_bf16_f32 v71, v162, v163
    v_cvt_pk_bf16_f32 v72, v164, v165
    v_cvt_pk_bf16_f32 v73, v166, v167
    v_cvt_pk_bf16_f32 v74, v168, v169
    v_cvt_pk_bf16_f32 v75, v170, v171
    ds_read_b64_tr_b16 a[64:65], v19 offset:512
    ds_read_b64_tr_b16 a[66:67], v19 offset:576
    ds_read_b64_tr_b16 a[68:69], v19 offset:640
    ds_read_b64_tr_b16 a[70:71], v19 offset:704
    buffer_load_dwordx2 a[154:155], v8, s[32:35], s43 offen offset:80
    v_pk_fma_f32 v[172:173], v[172:173], s[28:29], v[26:27]
    v_pk_fma_f32 v[174:175], v[174:175], s[28:29], v[26:27]
    v_pk_fma_f32 v[176:177], v[176:177], s[28:29], v[26:27]
    s_waitcnt lgkmcnt(8)
    buffer_load_dwordx4 v3, s[8:11], s26 offen offset:2048 lds
    v_mfma_f32_32x32x16_bf16 a[128:143], a[72:75], v[68:71], 0
    v_pk_fma_f32 v[178:179], v[178:179], s[28:29], v[26:27]
    v_pk_fma_f32 v[180:181], v[180:181], s[28:29], v[26:27]
    v_pk_fma_f32 v[182:183], v[182:183], s[28:29], v[26:27]
    v_pk_fma_f32 v[184:185], v[184:185], s[28:29], v[26:27]
    v_pk_fma_f32 v[186:187], v[186:187], s[28:29], v[26:27]
    v_exp_f32 v172, v172
    v_exp_f32 v173, v173
    v_exp_f32 v174, v174
    v_exp_f32 v175, v175
    v_exp_f32 v176, v176
    v_exp_f32 v177, v177
    v_exp_f32 v178, v178
    v_exp_f32 v179, v179
    v_exp_f32 v180, v180
    v_mfma_f32_32x32x16_bf16 a[128:143], a[76:79], v[72:75], a[128:143]
    v_exp_f32 v181, v181
    v_exp_f32 v182, v182
    v_exp_f32 v183, v183
    v_exp_f32 v184, v184
    v_exp_f32 v185, v185
    v_exp_f32 v186, v186
    v_exp_f32 v187, v187
    v_cvt_pk_bf16_f32 v60, v172, v173
    v_cvt_pk_bf16_f32 v61, v174, v175
    v_cvt_pk_bf16_f32 v62, v176, v177
    v_cvt_pk_bf16_f32 v63, v178, v179
    v_cvt_pk_bf16_f32 v64, v180, v181
    v_cvt_pk_bf16_f32 v65, v182, v183
    v_cvt_pk_bf16_f32 v66, v184, v185
    v_cvt_pk_bf16_f32 v67, v186, v187
    ds_read_b64_tr_b16 a[72:73], v19 offset:768
    ds_read_b64_tr_b16 a[74:75], v19 offset:832
    ds_read_b64_tr_b16 a[76:77], v19 offset:896
    ds_read_b64_tr_b16 a[78:79], v19 offset:960
    v_pk_fma_f32 v[188:189], v[188:189], s[28:29], v[26:27]
    buffer_load_dwordx4 v3, s[8:11], s26 offen offset:3072 lds
    v_pk_fma_f32 v[190:191], v[190:191], s[28:29], v[26:27]
    v_pk_fma_f32 v[192:193], v[192:193], s[28:29], v[26:27]
    s_waitcnt lgkmcnt(8)
    v_mfma_f32_32x32x16_bf16 a[128:143], a[56:59], v[60:63], a[128:143]
    v_pk_fma_f32 v[194:195], v[194:195], s[28:29], v[26:27]
    v_pk_fma_f32 v[196:197], v[196:197], s[28:29], v[26:27]
    v_pk_fma_f32 v[198:199], v[198:199], s[28:29], v[26:27]
    v_pk_fma_f32 v[200:201], v[200:201], s[28:29], v[26:27]
    v_pk_fma_f32 v[202:203], v[202:203], s[28:29], v[26:27]
    v_exp_f32 v188, v188
    v_exp_f32 v189, v189
    v_exp_f32 v190, v190
    v_exp_f32 v191, v191
    v_exp_f32 v192, v192
    v_exp_f32 v193, v193
    v_exp_f32 v194, v194
    v_exp_f32 v195, v195
    v_exp_f32 v196, v196
    v_mfma_f32_32x32x16_bf16 a[128:143], a[60:63], v[64:67], a[128:143]
    v_exp_f32 v197, v197
    v_exp_f32 v198, v198
    v_exp_f32 v199, v199
    v_exp_f32 v200, v200
    v_exp_f32 v201, v201
    v_exp_f32 v202, v202
    v_exp_f32 v203, v203
    v_cvt_pk_bf16_f32 v68, v188, v189
    v_cvt_pk_bf16_f32 v69, v190, v191
    v_cvt_pk_bf16_f32 v70, v192, v193
    v_cvt_pk_bf16_f32 v71, v194, v195
    v_cvt_pk_bf16_f32 v72, v196, v197
    v_cvt_pk_bf16_f32 v73, v198, v199
    v_cvt_pk_bf16_f32 v74, v200, v201
    v_cvt_pk_bf16_f32 v75, v202, v203
    v_pk_fma_f32 v[204:205], v[204:205], s[28:29], v[26:27]
    v_pk_fma_f32 v[206:207], v[206:207], s[28:29], v[26:27]
    s_add_u32 m0, s27, 24576
    s_add_u32 s26, s26, 4096
    buffer_load_dwordx4 v3, s[8:11], s26 offen offset:0 lds
    v_pk_fma_f32 v[208:209], v[208:209], s[28:29], v[26:27]
    s_waitcnt lgkmcnt(4)
    v_mfma_f32_32x32x16_bf16 a[128:143], a[64:67], v[68:71], a[128:143]
    v_pk_fma_f32 v[210:211], v[210:211], s[28:29], v[26:27]
    v_pk_fma_f32 v[212:213], v[212:213], s[28:29], v[26:27]
    v_pk_fma_f32 v[214:215], v[214:215], s[28:29], v[26:27]
    v_pk_fma_f32 v[216:217], v[216:217], s[28:29], v[26:27]
    v_pk_fma_f32 v[218:219], v[218:219], s[28:29], v[26:27]
    v_exp_f32 v204, v204
    v_exp_f32 v205, v205
    v_exp_f32 v206, v206
    v_exp_f32 v207, v207
    v_exp_f32 v208, v208
    v_exp_f32 v209, v209
    v_exp_f32 v210, v210
    v_exp_f32 v211, v211
    v_exp_f32 v212, v212
    v_mfma_f32_32x32x16_bf16 a[128:143], a[68:71], v[72:75], a[128:143]
    v_exp_f32 v213, v213
    v_exp_f32 v214, v214
    v_exp_f32 v215, v215
    v_exp_f32 v216, v216
    v_exp_f32 v217, v217
    v_exp_f32 v218, v218
    v_exp_f32 v219, v219
    v_cvt_pk_bf16_f32 v60, v204, v205
    v_cvt_pk_bf16_f32 v61, v206, v207
    v_cvt_pk_bf16_f32 v62, v208, v209
    v_cvt_pk_bf16_f32 v63, v210, v211
    v_cvt_pk_bf16_f32 v64, v212, v213
    v_cvt_pk_bf16_f32 v65, v214, v215
    v_cvt_pk_bf16_f32 v66, v216, v217
    v_cvt_pk_bf16_f32 v67, v218, v219
    s_waitcnt lgkmcnt(0)
    v_mfma_f32_32x32x16_bf16 a[128:143], a[72:75], v[60:63], a[128:143]
    v_mfma_f32_32x32x16_bf16 a[128:143], a[76:79], v[64:67], a[128:143]
    v_accvgpr_read_b32 v20, a88
    v_accvgpr_read_b32 v21, a120
    v_fma_f32 v20, v20, v222, v21
    v_mov_b32 v21, v20
    s_nop 1
    v_permlane32_swap_b32 v20, v21
    v_rcp_f32 v21, v21
    s_nop 0
    v_mul_f32 v222, v222, v21
    v_accvgpr_read_b32 v22, a112
    v_accvgpr_read_b32 v23, a113
    v_accvgpr_read_b32 v9, a80
    v_accvgpr_read_b32 v10, a81
    v_mul_f32 v22, v22, v21
    v_mul_f32 v23, v23, v21
    v_fma_f32 v22, v9, v222, v22
    v_fma_f32 v23, v10, v222, v23
    v_cvt_pk_bf16_f32 v240, v22, v23
    v_accvgpr_read_b32 v22, a114
    v_accvgpr_read_b32 v23, a115
    v_accvgpr_read_b32 v9, a82
    v_accvgpr_read_b32 v10, a83
    v_mul_f32 v22, v22, v21
    v_mul_f32 v23, v23, v21
    v_fma_f32 v22, v9, v222, v22
    v_fma_f32 v23, v10, v222, v23
    v_cvt_pk_bf16_f32 v241, v22, v23
    v_accvgpr_read_b32 v22, a116
    v_accvgpr_read_b32 v23, a117
    v_accvgpr_read_b32 v9, a84
    v_accvgpr_read_b32 v10, a85
    v_mul_f32 v22, v22, v21
    v_mul_f32 v23, v23, v21
    v_fma_f32 v22, v9, v222, v22
    v_fma_f32 v23, v10, v222, v23
    v_cvt_pk_bf16_f32 v242, v22, v23
    v_accvgpr_read_b32 v22, a118
    v_accvgpr_read_b32 v23, a119
    v_accvgpr_read_b32 v9, a86
    v_accvgpr_read_b32 v10, a87
    v_mul_f32 v22, v22, v21
    v_mul_f32 v23, v23, v21
    v_fma_f32 v22, v9, v222, v22
    v_fma_f32 v23, v10, v222, v23
    v_cvt_pk_bf16_f32 v243, v22, v23
    v_accvgpr_read_b32 v22, a120
    v_accvgpr_read_b32 v23, a121
    v_accvgpr_read_b32 v9, a88
    v_accvgpr_read_b32 v10, a89
    v_mul_f32 v22, v22, v21
    v_mul_f32 v23, v23, v21
    v_fma_f32 v22, v9, v222, v22
    v_fma_f32 v23, v10, v222, v23
    v_cvt_pk_bf16_f32 v244, v22, v23
    v_accvgpr_read_b32 v22, a122
    v_accvgpr_read_b32 v23, a123
    v_accvgpr_read_b32 v9, a90
    v_accvgpr_read_b32 v10, a91
    v_mul_f32 v22, v22, v21
    v_mul_f32 v23, v23, v21
    v_fma_f32 v22, v9, v222, v22
    v_fma_f32 v23, v10, v222, v23
    v_cvt_pk_bf16_f32 v245, v22, v23
    v_accvgpr_read_b32 v20, a104
    v_accvgpr_read_b32 v21, a136
    v_fma_f32 v20, v20, v223, v21
    v_mov_b32 v21, v20
    s_nop 1
    v_permlane32_swap_b32 v20, v21
    v_rcp_f32 v21, v21
    s_nop 0
    v_mul_f32 v223, v223, v21
    v_accvgpr_read_b32 v22, a128
    v_accvgpr_read_b32 v23, a129
    v_accvgpr_read_b32 v9, a96
    v_accvgpr_read_b32 v10, a97
    v_mul_f32 v22, v22, v21
    v_mul_f32 v23, v23, v21
    v_fma_f32 v22, v9, v223, v22
    v_fma_f32 v23, v10, v223, v23
    v_cvt_pk_bf16_f32 v246, v22, v23
    v_accvgpr_read_b32 v22, a130
    v_accvgpr_read_b32 v23, a131
    v_accvgpr_read_b32 v9, a98
    v_accvgpr_read_b32 v10, a99
    v_mul_f32 v22, v22, v21
    v_mul_f32 v23, v23, v21
    v_fma_f32 v22, v9, v223, v22
    v_fma_f32 v23, v10, v223, v23
    v_cvt_pk_bf16_f32 v247, v22, v23
    v_accvgpr_read_b32 v22, a132
    v_accvgpr_read_b32 v23, a133
    v_accvgpr_read_b32 v9, a100
    v_accvgpr_read_b32 v10, a101
    v_mul_f32 v22, v22, v21
    v_mul_f32 v23, v23, v21
    v_fma_f32 v22, v9, v223, v22
    v_fma_f32 v23, v10, v223, v23
    v_cvt_pk_bf16_f32 v248, v22, v23
    v_accvgpr_read_b32 v22, a134
    v_accvgpr_read_b32 v23, a135
    v_accvgpr_read_b32 v9, a102
    v_accvgpr_read_b32 v10, a103
    v_mul_f32 v22, v22, v21
    v_mul_f32 v23, v23, v21
    v_fma_f32 v22, v9, v223, v22
    v_fma_f32 v23, v10, v223, v23
    v_cvt_pk_bf16_f32 v249, v22, v23
    v_accvgpr_read_b32 v22, a136
    v_accvgpr_read_b32 v23, a137
    v_accvgpr_read_b32 v9, a104
    v_accvgpr_read_b32 v10, a105
    v_mul_f32 v22, v22, v21
    v_mul_f32 v23, v23, v21
    v_fma_f32 v22, v9, v223, v22
    v_fma_f32 v23, v10, v223, v23
    v_cvt_pk_bf16_f32 v250, v22, v23
    v_accvgpr_read_b32 v22, a138
    v_accvgpr_read_b32 v23, a139
    v_accvgpr_read_b32 v9, a106
    v_accvgpr_read_b32 v10, a107
    v_mul_f32 v22, v22, v21
    v_mul_f32 v23, v23, v21
    v_fma_f32 v22, v9, v223, v22
    v_fma_f32 v23, v10, v223, v23
    v_cvt_pk_bf16_f32 v251, v22, v23
    s_branch AT_END_52
AT_END_52:
    s_cmp_eq_u32 s14, 0
    s_cbranch_scc1 ST_S_63
    buffer_store_dwordx4 v[240:243], v3, s[8:11], s36 offen
    buffer_store_dwordx4 v[246:249], v3, s[8:11], s37 offen
    s_mov_b32 exec_hi, 0
    buffer_store_dwordx2 v[244:245], v3, s[8:11], s38 offen
    buffer_store_dwordx2 v[250:251], v3, s[8:11], s39 offen
    s_mov_b64 exec, -1
    s_branch ST_E_64
ST_S_63:
    buffer_store_dwordx4 v[240:243], v3, s[8:11], s36 offen sc1
    buffer_store_dwordx4 v[246:249], v3, s[8:11], s37 offen sc1
    s_mov_b32 exec_hi, 0
    buffer_store_dwordx2 v[244:245], v3, s[8:11], s38 offen sc1
    buffer_store_dwordx2 v[250:251], v3, s[8:11], s39 offen sc1
    s_mov_b64 exec, -1
ST_E_64:
    s_lshl_b32 s19, s12, 7
    s_add_u32 s19, s19, 527360
    s_lshl_b32 s20, s13, 2
    s_add_u32 s20, s20, s19
    v_mov_b32 v250, s20
    v_and_b32 v251, 31, v2
    v_lshlrev_b32 v251, 2, v251
    v_add_u32 v251, s19, v251
    v_mov_b32 v249, 1
    s_and_b32 s26, s3, 1
    s_lshr_b32 s27, s3, 1
    s_lshr_b32 s15, s13, 2
    s_lshl_b32 s29, s12, 3
    s_and_b32 s19, s13, 3
    s_lshl_b32 s19, s19, 1
    s_add_u32 s29, s29, s19
    s_add_u32 s29, s29, s26
    s_mul_i32 s28, s15, 5
    s_mul_i32 s19, s27, 3
    s_add_u32 s28, s28, s19
    s_mul_i32 s31, s29, 40
    s_add_u32 s31, s31, s28
    s_lshl_b32 s31, s31, 10
    v_lshrrev_b32 v7, 5, v2
    v_lshlrev_b32 v7, 4, v7
    s_lshl_b32 s32, s28, 5
    s_lshl_b32 s19, s12, 13
    s_add_u32 s32, s32, s19
    s_add_u32 s32, s32, 458752
    s_mul_i32 s22, s29, 40
    s_mul_i32 s19, s27, 20
    s_add_u32 s22, s22, s19
    s_lshl_b32 s22, s22, 10
    s_add_u32 s22, s22, 1048576
    s_mul_i32 s19, s27, 51200
    v_add_u32 v4, s19, v3
    v_lshrrev_b32 v5, 5, v2
    v_lshlrev_b32 v5, 8, v5
    v_and_b32 v6, 15, v2
    v_lshl_add_u32 v5, v6, 4, v5
    v_add_u32 v5, s19, v5
    v_add_u32 v5, 4096, v5
    s_add_u32 s25, s22, 0
    s_waitcnt vmcnt(0)
    s_barrier
    s_cmp_lg_u32 s3, 0
    s_cbranch_scc1 GB_65
    s_mov_b64 exec, 1
    s_cmp_eq_u32 s14, 0
    s_cbranch_scc1 ST_S_67
    global_store_dword v250, v249, s[4:5]
    s_branch ST_E_68
ST_S_67:
    global_store_dword v250, v249, s[4:5] sc1
ST_E_68:
    s_mov_b64 exec, -1
    s_mov_b32 s18, 2000000
    global_load_dword v252, v251, s[4:5] sc1
    s_nop 7
    global_load_dword v253, v251, s[4:5] sc1
    s_nop 7
POLL_69:
    global_load_dword v254, v251, s[4:5] sc1
    s_waitcnt vmcnt(2)
    v_cmp_eq_u32 vcc, 0, v252
    s_cbranch_vccz POLLX_70
    global_load_dword v252, v251, s[4:5] sc1
    s_waitcnt vmcnt(2)
    v_cmp_eq_u32 vcc, 0, v253
    s_cbranch_vccz POLLX_70
    global_load_dword v253, v251, s[4:5] sc1
    s_waitcnt vmcnt(2)
    v_cmp_eq_u32 vcc, 0, v254
    s_cbranch_vccz POLLX_70
    s_sub_u32 s18, s18, 1
    s_cmp_lg_u32 s18, 0
    s_cbranch_scc1 POLL_69
POLLX_70:
GB_65:
    s_barrier
    buffer_load_dwordx4 a[0:3], v3, s[8:11], s25 offen offset:0 sc1
    buffer_load_dwordx4 a[4:7], v3, s[8:11], s25 offen offset:1024 sc1
    buffer_load_dwordx4 a[8:11], v3, s[8:11], s25 offen offset:2048 sc1
    buffer_load_dwordx4 a[12:15], v3, s[8:11], s25 offen offset:3072 sc1
    s_add_u32 s25, s22, 4096
    buffer_load_dwordx4 a[16:19], v3, s[8:11], s25 offen offset:0 sc1
    buffer_load_dwordx4 a[20:23], v3, s[8:11], s25 offen offset:1024 sc1
    buffer_load_dwordx4 a[24:27], v3, s[8:11], s25 offen offset:2048 sc1
    buffer_load_dwordx4 a[28:31], v3, s[8:11], s25 offen offset:3072 sc1
    ds_read_b128 v[16:19], v4 offset:0
    ds_read_b128 v[20:23], v4 offset:1024
    ds_read_b128 v[24:27], v5 offset:0
    ds_read_b128 v[28:31], v4 offset:2048
    ds_read_b128 v[32:35], v4 offset:3072
    ds_read_b128 v[36:39], v5 offset:512
    s_waitcnt vmcnt(7)
    s_waitcnt lgkmcnt(5)
    v_mfma_f32_32x32x16_bf16 v[64:79], v[16:19], a[0:3], 0
    ds_read_b128 v[40:43], v4 offset:5120
    s_add_u32 s25, s22, 8192
    buffer_load_dwordx4 a[32:35], v3, s[8:11], s25 offen offset:0 sc1
    v_accvgpr_read_b32 v10, a144
    v_lshlrev_b32 v112, 16, v10
    s_waitcnt lgkmcnt(5)
    v_mfma_f32_32x32x16_bf16 v[80:95], v[20:23], a[0:3], 0
    ds_read_b128 v[44:47], v4 offset:6144
    buffer_load_dwordx4 a[36:39], v3, s[8:11], s25 offen offset:1024 sc1
    v_and_b32 v113, 0xffff0000, v10
    v_accvgpr_read_b32 v11, a156
    s_waitcnt lgkmcnt(5)
    v_mfma_f32_32x32x16_bf16 v[96:111], v[24:27], a[0:3], 0
    ds_read_b128 v[48:51], v5 offset:5120
    buffer_load_dwordx4 a[40:43], v3, s[8:11], s25 offen offset:2048 sc1
    v_lshlrev_b32 v136, 16, v11
    v_and_b32 v137, 0xffff0000, v11
    s_waitcnt vmcnt(9)
    s_waitcnt lgkmcnt(5)
    v_mfma_f32_32x32x16_bf16 v[64:79], v[28:31], a[4:7], v[64:79]
    ds_read_b128 v[16:19], v4 offset:7168
    buffer_load_dwordx4 a[44:47], v3, s[8:11], s25 offen offset:3072 sc1
    v_accvgpr_read_b32 v10, a145
    v_lshlrev_b32 v114, 16, v10
    s_waitcnt lgkmcnt(5)
    v_mfma_f32_32x32x16_bf16 v[80:95], v[32:35], a[4:7], v[80:95]
    ds_read_b128 v[20:23], v4 offset:8192
    s_add_u32 s25, s22, 12288
    buffer_load_dwordx4 a[48:51], v3, s[8:11], s25 offen offset:0 sc1
    v_and_b32 v115, 0xffff0000, v10
    v_accvgpr_read_b32 v11, a157
    s_waitcnt lgkmcnt(5)
    v_mfma_f32_32x32x16_bf16 v[96:111], v[36:39], a[4:7], v[96:111]
    ds_read_b128 v[24:27], v5 offset:5632
    buffer_load_dwordx4 a[52:55], v3, s[8:11], s25 offen offset:1024 sc1
    v_lshlrev_b32 v138, 16, v11
    v_and_b32 v139, 0xffff0000, v11
    s_waitcnt vmcnt(11)
    s_waitcnt lgkmcnt(5)
    v_mfma_f32_32x32x16_bf16 v[64:79], v[40:43], a[8:11], v[64:79]
    ds_read_b128 v[28:31], v4 offset:10240
    buffer_load_dwordx4 a[56:59], v3, s[8:11], s25 offen offset:2048 sc1
    v_accvgpr_read_b32 v10, a146
    v_lshlrev_b32 v116, 16, v10
    s_waitcnt lgkmcnt(5)
    v_mfma_f32_32x32x16_bf16 v[80:95], v[44:47], a[8:11], v[80:95]
    ds_read_b128 v[32:35], v4 offset:11264
    buffer_load_dwordx4 a[60:63], v3, s[8:11], s25 offen offset:3072 sc1
    v_and_b32 v117, 0xffff0000, v10
    v_accvgpr_read_b32 v11, a158
    s_waitcnt lgkmcnt(5)
    v_mfma_f32_32x32x16_bf16 v[96:111], v[48:51], a[8:11], v[96:111]
    ds_read_b128 v[36:39], v5 offset:10240
    s_add_u32 s25, s22, 16384
    buffer_load_dwordx4 a[64:67], v3, s[8:11], s25 offen offset:0 sc1
    v_lshlrev_b32 v140, 16, v11
    v_and_b32 v141, 0xffff0000, v11
    s_waitcnt vmcnt(13)
    s_waitcnt lgkmcnt(5)
    v_mfma_f32_32x32x16_bf16 v[64:79], v[16:19], a[12:15], v[64:79]
    ds_read_b128 v[40:43], v4 offset:12288
    buffer_load_dwordx4 a[68:71], v3, s[8:11], s25 offen offset:1024 sc1
    v_accvgpr_read_b32 v10, a147
    v_lshlrev_b32 v118, 16, v10
    s_waitcnt lgkmcnt(5)
    v_mfma_f32_32x32x16_bf16 v[80:95], v[20:23], a[12:15], v[80:95]
    ds_read_b128 v[44:47], v4 offset:13312
    buffer_load_dwordx4 a[72:75], v3, s[8:11], s25 offen offset:2048 sc1
    v_and_b32 v119, 0xffff0000, v10
    v_accvgpr_read_b32 v11, a159
    s_waitcnt lgkmcnt(5)
    v_mfma_f32_32x32x16_bf16 v[96:111], v[24:27], a[12:15], v[96:111]
    ds_read_b128 v[48:51], v5 offset:10752
    buffer_load_dwordx4 a[76:79], v3, s[8:11], s25 offen offset:3072 sc1
    v_lshlrev_b32 v142, 16, v11
    v_and_b32 v143, 0xffff0000, v11
    s_waitcnt vmcnt(15)
    s_waitcnt lgkmcnt(5)
    v_mfma_f32_32x32x16_bf16 v[64:79], v[28:31], a[16:19], v[64:79]
    ds_read_b128 v[16:19], v4 offset:15360
    v_accvgpr_read_b32 v10, a148
    v_lshlrev_b32 v120, 16, v10
    s_waitcnt lgkmcnt(5)
    v_mfma_f32_32x32x16_bf16 v[80:95], v[32:35], a[16:19], v[80:95]
    ds_read_b128 v[20:23], v4 offset:16384
    v_and_b32 v121, 0xffff0000, v10
    v_accvgpr_read_b32 v11, a160
    s_waitcnt lgkmcnt(5)
    v_mfma_f32_32x32x16_bf16 v[96:111], v[36:39], a[16:19], v[96:111]
    ds_read_b128 v[24:27], v5 offset:15360
    v_lshlrev_b32 v144, 16, v11
    v_and_b32 v145, 0xffff0000, v11
    s_waitcnt vmcnt(14)
    s_waitcnt lgkmcnt(5)
    v_mfma_f32_32x32x16_bf16 v[64:79], v[40:43], a[20:23], v[64:79]
    ds_read_b128 v[28:31], v4 offset:17408
    v_accvgpr_read_b32 v10, a149
    v_lshlrev_b32 v122, 16, v10
    s_waitcnt lgkmcnt(5)
    v_mfma_f32_32x32x16_bf16 v[80:95], v[44:47], a[20:23], v[80:95]
    ds_read_b128 v[32:35], v4 offset:18432
    v_and_b32 v123, 0xffff0000, v10
    v_accvgpr_read_b32 v11, a161
    s_waitcnt lgkmcnt(5)
    v_mfma_f32_32x32x16_bf16 v[96:111], v[48:51], a[20:23], v[96:111]
    ds_read_b128 v[36:39], v5 offset:15872
    v_lshlrev_b32 v146, 16, v11
    v_and_b32 v147, 0xffff0000, v11
    s_waitcnt vmcnt(13)
    s_waitcnt lgkmcnt(5)
    v_mfma_f32_32x32x16_bf16 v[64:79], v[16:19], a[24:27], v[64:79]
    ds_read_b128 v[40:43], v4 offset:20480
    v_accvgpr_read_b32 v10, a150
    v_lshlrev_b32 v124, 16, v10
    s_waitcnt lgkmcnt(5)
    v_mfma_f32_32x32x16_bf16 v[80:95], v[20:23], a[24:27], v[80:95]
    ds_read_b128 v[44:47], v4 offset:21504
    v_and_b32 v125, 0xffff0000, v10
    v_accvgpr_read_b32 v11, a162
    s_waitcnt lgkmcnt(5)
    v_mfma_f32_32x32x16_bf16 v[96:111], v[24:27], a[24:27], v[96:111]
    ds_read_b128 v[48:51], v5 offset:20480
    v_lshlrev_b32 v148, 16, v11
    v_and_b32 v149, 0xffff0000, v11
    s_waitcnt vmcnt(12)
    s_waitcnt lgkmcnt(5)
    v_mfma_f32_32x32x16_bf16 v[64:79], v[28:31], a[28:31], v[64:79]
    ds_read_b128 v[16:19], v4 offset:22528
    v_accvgpr_read_b32 v10, a151
    v_lshlrev_b32 v126, 16, v10
    s_waitcnt lgkmcnt(5)
    v_mfma_f32_32x32x16_bf16 v[80:95], v[32:35], a[28:31], v[80:95]
    ds_read_b128 v[20:23], v4 offset:23552
    v_and_b32 v127, 0xffff0000, v10
    v_accvgpr_read_b32 v11, a163
    s_waitcnt lgkmcnt(5)
    v_mfma_f32_32x32x16_bf16 v[96:111], v[36:39], a[28:31], v[96:111]
    ds_read_b128 v[24:27], v5 offset:20992
    v_lshlrev_b32 v150, 16, v11
    v_and_b32 v151, 0xffff0000, v11
    s_waitcnt vmcnt(11)
    s_waitcnt lgkmcnt(5)
    v_mfma_f32_32x32x16_bf16 v[64:79], v[40:43], a[32:35], v[64:79]
    ds_read_b128 v[28:31], v4 offset:25600
    v_accvgpr_read_b32 v10, a152
    v_lshlrev_b32 v128, 16, v10
    s_waitcnt lgkmcnt(5)
    v_mfma_f32_32x32x16_bf16 v[80:95], v[44:47], a[32:35], v[80:95]
    ds_read_b128 v[32:35], v4 offset:26624
    v_and_b32 v129, 0xffff0000, v10
    v_accvgpr_read_b32 v11, a164
    s_waitcnt lgkmcnt(5)
    v_mfma_f32_32x32x16_bf16 v[96:111], v[48:51], a[32:35], v[96:111]
    ds_read_b128 v[36:39], v5 offset:25600
    v_lshlrev_b32 v152, 16, v11
    v_and_b32 v153, 0xffff0000, v11
    s_waitcnt vmcnt(10)
    s_waitcnt lgkmcnt(5)
    v_mfma_f32_32x32x16_bf16 v[64:79], v[16:19], a[36:39], v[64:79]
    ds_read_b128 v[40:43], v4 offset:27648
    v_accvgpr_read_b32 v10, a153
    v_lshlrev_b32 v130, 16, v10
    s_waitcnt lgkmcnt(5)
    v_mfma_f32_32x32x16_bf16 v[80:95], v[20:23], a[36:39], v[80:95]
    ds_read_b128 v[44:47], v4 offset:28672
    v_and_b32 v131, 0xffff0000, v10
    v_accvgpr_read_b32 v11, a165
    s_waitcnt lgkmcnt(5)
    v_mfma_f32_32x32x16_bf16 v[96:111], v[24:27], a[36:39], v[96:111]
    ds_read_b128 v[48:51], v5 offset:26112
    v_lshlrev_b32 v154, 16, v11
    v_and_b32 v155, 0xffff0000, v11
    s_waitcnt vmcnt(9)
    s_waitcnt lgkmcnt(5)
    v_mfma_f32_32x32x16_bf16 v[64:79], v[28:31], a[40:43], v[64:79]
    ds_read_b128 v[16:19], v4 offset:30720
    v_accvgpr_read_b32 v10, a154
    v_lshlrev_b32 v132, 16, v10
    s_waitcnt lgkmcnt(5)
    v_mfma_f32_32x32x16_bf16 v[80:95], v[32:35], a[40:43], v[80:95]
    ds_read_b128 v[20:23], v4 offset:31744
    v_and_b32 v133, 0xffff0000, v10
    v_accvgpr_read_b32 v11, a166
    s_waitcnt lgkmcnt(5)
    v_mfma_f32_32x32x16_bf16 v[96:111], v[36:39], a[40:43], v[96:111]
    ds_read_b128 v[24:27], v5 offset:30720
    v_lshlrev_b32 v156, 16, v11
    v_and_b32 v157, 0xffff0000, v11
    s_waitcnt vmcnt(8)
    s_waitcnt lgkmcnt(5)
    v_mfma_f32_32x32x16_bf16 v[64:79], v[40:43], a[44:47], v[64:79]
    ds_read_b128 v[28:31], v4 offset:32768
    v_accvgpr_read_b32 v10, a155
    v_lshlrev_b32 v134, 16, v10
    s_waitcnt lgkmcnt(5)
    v_mfma_f32_32x32x16_bf16 v[80:95], v[44:47], a[44:47], v[80:95]
    ds_read_b128 v[32:35], v4 offset:33792
    v_and_b32 v135, 0xffff0000, v10
    v_accvgpr_read_b32 v11, a167
    s_waitcnt lgkmcnt(5)
    v_mfma_f32_32x32x16_bf16 v[96:111], v[48:51], a[44:47], v[96:111]
    ds_read_b128 v[36:39], v5 offset:31232
    v_lshlrev_b32 v158, 16, v11
    v_and_b32 v159, 0xffff0000, v11
    s_waitcnt vmcnt(7)
    s_waitcnt lgkmcnt(5)
    v_mfma_f32_32x32x16_bf16 v[64:79], v[16:19], a[48:51], v[64:79]
    ds_read_b128 v[40:43], v4 offset:35840
    s_mul_i32 s19, s3, 6144
    s_add_u32 s19, s19, 102400
    v_add_u32 v12, s19, v3
    s_waitcnt lgkmcnt(5)
    v_mfma_f32_32x32x16_bf16 v[80:95], v[20:23], a[48:51], v[80:95]
    ds_read_b128 v[44:47], v4 offset:36864
    s_xor_b32 s19, s3, 2
    s_mul_i32 s19, s19, 6144
    s_add_u32 s19, s19, 102400
    v_add_u32 v13, s19, v3
    s_waitcnt lgkmcnt(5)
    v_mfma_f32_32x32x16_bf16 v[96:111], v[24:27], a[48:51], v[96:111]
    ds_read_b128 v[48:51], v5 offset:35840
    s_lshl_b32 s19, s29, 4
    s_lshl_b32 s20, s15, 1
    s_add_u32 s19, s19, s20
    s_add_u32 s19, s19, s27
    s_waitcnt vmcnt(6)
    s_waitcnt lgkmcnt(5)
    v_mfma_f32_32x32x16_bf16 v[64:79], v[28:31], a[52:55], v[64:79]
    ds_read_b128 v[16:19], v4 offset:37888
    s_lshl_b32 s33, s19, 8
    s_add_u32 s33, s33, 65536
    v_lshlrev_b32 v14, 3, v2
    s_waitcnt lgkmcnt(5)
    v_mfma_f32_32x32x16_bf16 v[80:95], v[32:35], a[52:55], v[80:95]
    ds_read_b128 v[20:23], v4 offset:38912
    v_and_b32 v10, 31, v2
    v_lshrrev_b32 v11, 5, v2
    s_waitcnt lgkmcnt(5)
    v_mfma_f32_32x32x16_bf16 v[96:111], v[36:39], a[52:55], v[96:111]
    ds_read_b128 v[24:27], v5 offset:36352
    v_lshlrev_b32 v15, 3, v10
    v_lshl_add_u32 v15, v11, 11, v15
    s_waitcnt vmcnt(5)
    s_waitcnt lgkmcnt(5)
    v_mfma_f32_32x32x16_bf16 v[64:79], v[40:43], a[56:59], v[64:79]
    ds_read_b128 v[28:31], v4 offset:40960
    s_lshl_b32 s42, s29, 12
    s_add_u32 s42, s42, 65536
    s_waitcnt lgkmcnt(5)
    v_mfma_f32_32x32x16_bf16 v[80:95], v[44:47], a[56:59], v[80:95]
    ds_read_b128 v[32:35], v4 offset:41984
    s_waitcnt lgkmcnt(5)
    v_mfma_f32_32x32x16_bf16 v[96:111], v[48:51], a[56:59], v[96:111]
    ds_read_b128 v[36:39], v5 offset:40960
    s_waitcnt vmcnt(4)
    s_waitcnt lgkmcnt(5)
    v_mfma_f32_32x32x16_bf16 v[64:79], v[16:19], a[60:63], v[64:79]
    ds_read_b128 v[40:43], v4 offset:43008
    s_waitcnt lgkmcnt(5)
    v_mfma_f32_32x32x16_bf16 v[80:95], v[20:23], a[60:63], v[80:95]
    ds_read_b128 v[44:47], v4 offset:44032
    s_waitcnt lgkmcnt(5)
    v_mfma_f32_32x32x16_bf16 v[96:111], v[24:27], a[60:63], v[96:111]
    ds_read_b128 v[48:51], v5 offset:41472
    s_waitcnt vmcnt(3)
    s_waitcnt lgkmcnt(5)
    v_mfma_f32_32x32x16_bf16 v[64:79], v[28:31], a[64:67], v[64:79]
    ds_read_b128 v[16:19], v4 offset:46080
    s_waitcnt lgkmcnt(5)
    v_mfma_f32_32x32x16_bf16 v[80:95], v[32:35], a[64:67], v[80:95]
    ds_read_b128 v[20:23], v4 offset:47104
    s_waitcnt lgkmcnt(5)
    v_mfma_f32_32x32x16_bf16 v[96:111], v[36:39], a[64:67], v[96:111]
    ds_read_b128 v[24:27], v5 offset:46080
    s_waitcnt vmcnt(2)
    s_waitcnt lgkmcnt(5)
    v_mfma_f32_32x32x16_bf16 v[64:79], v[40:43], a[68:71], v[64:79]
    ds_read_b128 v[28:31], v4 offset:48128
    s_waitcnt lgkmcnt(5)
    v_mfma_f32_32x32x16_bf16 v[80:95], v[44:47], a[68:71], v[80:95]
    ds_read_b128 v[32:35], v4 offset:49152
    s_waitcnt lgkmcnt(5)
    v_mfma_f32_32x32x16_bf16 v[96:111], v[48:51], a[68:71], v[96:111]
    ds_read_b128 v[36:39], v5 offset:46592
    s_waitcnt vmcnt(1)
    s_waitcnt lgkmcnt(5)
    v_mfma_f32_32x32x16_bf16 v[64:79], v[16:19], a[72:75], v[64:79]
    s_waitcnt lgkmcnt(4)
    v_mfma_f32_32x32x16_bf16 v[80:95], v[20:23], a[72:75], v[80:95]
    s_waitcnt lgkmcnt(3)
    v_mfma_f32_32x32x16_bf16 v[96:111], v[24:27], a[72:75], v[96:111]
    s_waitcnt vmcnt(0)
    s_waitcnt lgkmcnt(2)
    v_mfma_f32_32x32x16_bf16 v[64:79], v[28:31], a[76:79], v[64:79]
    s_waitcnt lgkmcnt(1)
    v_mfma_f32_32x32x16_bf16 v[80:95], v[32:35], a[76:79], v[80:95]
    s_waitcnt lgkmcnt(0)
    v_mfma_f32_32x32x16_bf16 v[96:111], v[36:39], a[76:79], v[96:111]
    s_cmp_eq_u32 s27, 1
    s_cbranch_scc1 X_KH1_71
    s_nop 7
    ds_write_b128 v12, v[88:91] offset:0
    ds_write_b128 v12, v[92:95] offset:1024
    ds_write_b128 v12, v[96:99] offset:2048
    ds_write_b128 v12, v[100:103] offset:3072
    s_branch X_W_72
X_KH1_71:
    s_nop 5
    ds_write_b128 v12, v[64:67] offset:0
    ds_write_b128 v12, v[68:71] offset:1024
    ds_write_b128 v12, v[72:75] offset:2048
    ds_write_b128 v12, v[76:79] offset:3072
    ds_write_b128 v12, v[80:83] offset:4096
    ds_write_b128 v12, v[84:87] offset:5120
X_W_72:
    s_waitcnt lgkmcnt(0)
    s_barrier
    s_cmp_eq_u32 s27, 1
    s_cbranch_scc1 X_R1_73
    ds_read_b128 v[16:19], v13 offset:0
    ds_read_b128 v[20:23], v13 offset:1024
    ds_read_b128 v[24:27], v13 offset:2048
    ds_read_b128 v[28:31], v13 offset:3072
    ds_read_b128 v[32:35], v13 offset:4096
    ds_read_b128 v[36:39], v13 offset:5120
    s_waitcnt lgkmcnt(5)
    v_pk_add_f32 v[64:65], v[64:65], v[16:17]
    v_pk_add_f32 v[66:67], v[66:67], v[18:19]
    s_waitcnt lgkmcnt(4)
    v_pk_add_f32 v[68:69], v[68:69], v[20:21]
    v_pk_add_f32 v[70:71], v[70:71], v[22:23]
    s_waitcnt lgkmcnt(3)
    v_pk_add_f32 v[72:73], v[72:73], v[24:25]
    v_pk_add_f32 v[74:75], v[74:75], v[26:27]
    s_waitcnt lgkmcnt(2)
    v_pk_add_f32 v[76:77], v[76:77], v[28:29]
    v_pk_add_f32 v[78:79], v[78:79], v[30:31]
    s_waitcnt lgkmcnt(1)
    v_pk_add_f32 v[80:81], v[80:81], v[32:33]
    v_pk_add_f32 v[82:83], v[82:83], v[34:35]
    s_waitcnt lgkmcnt(0)
    v_pk_add_f32 v[84:85], v[84:85], v[36:37]
    v_pk_add_f32 v[86:87], v[86:87], v[38:39]
    s_branch X_RD_74
X_R1_73:
    ds_read_b128 v[16:19], v13 offset:0
    ds_read_b128 v[20:23], v13 offset:1024
    ds_read_b128 v[24:27], v13 offset:2048
    ds_read_b128 v[28:31], v13 offset:3072
    s_waitcnt lgkmcnt(3)
    v_pk_add_f32 v[64:65], v[88:89], v[16:17]
    v_pk_add_f32 v[66:67], v[90:91], v[18:19]
    s_waitcnt lgkmcnt(2)
    v_pk_add_f32 v[68:69], v[92:93], v[20:21]
    v_pk_add_f32 v[70:71], v[94:95], v[22:23]
    s_waitcnt lgkmcnt(1)
    v_pk_add_f32 v[72:73], v[96:97], v[24:25]
    v_pk_add_f32 v[74:75], v[98:99], v[26:27]
    s_waitcnt lgkmcnt(0)
    v_pk_add_f32 v[76:77], v[100:101], v[28:29]
    v_pk_add_f32 v[78:79], v[102:103], v[30:31]
X_RD_74:
    v_fma_f32 v12, v136, v64, v112
    v_fma_f32 v13, v137, v65, v113
    v_cvt_pk_bf16_f32 v184, v12, v13
    v_lshlrev_b32 v160, 16, v184
    v_and_b32 v161, 0xffff0000, v184
    v_mov_b32 v8, v160
    v_mov_b32 v9, v161
    v_pk_mul_f32 v[10:11], v[160:161], v[160:161]
    v_fma_f32 v12, v138, v66, v114
    v_fma_f32 v13, v139, v67, v115
    v_cvt_pk_bf16_f32 v185, v12, v13
    v_lshlrev_b32 v162, 16, v185
    v_and_b32 v163, 0xffff0000, v185
    v_pk_add_f32 v[8:9], v[8:9], v[162:163]
    v_pk_fma_f32 v[10:11], v[162:163], v[162:163], v[10:11]
    v_fma_f32 v12, v140, v68, v116
    v_fma_f32 v13, v141, v69, v117
    v_cvt_pk_bf16_f32 v186, v12, v13
    v_lshlrev_b32 v164, 16, v186
    v_and_b32 v165, 0xffff0000, v186
    v_pk_add_f32 v[8:9], v[8:9], v[164:165]
    v_pk_fma_f32 v[10:11], v[164:165], v[164:165], v[10:11]
    v_fma_f32 v12, v142, v70, v118
    v_fma_f32 v13, v143, v71, v119
    v_cvt_pk_bf16_f32 v187, v12, v13
    v_lshlrev_b32 v166, 16, v187
    v_and_b32 v167, 0xffff0000, v187
    v_pk_add_f32 v[8:9], v[8:9], v[166:167]
    v_pk_fma_f32 v[10:11], v[166:167], v[166:167], v[10:11]
    v_fma_f32 v12, v144, v72, v120
    v_fma_f32 v13, v145, v73, v121
    v_cvt_pk_bf16_f32 v188, v12, v13
    v_lshlrev_b32 v168, 16, v188
    v_and_b32 v169, 0xffff0000, v188
    v_pk_add_f32 v[8:9], v[8:9], v[168:169]
    v_pk_fma_f32 v[10:11], v[168:169], v[168:169], v[10:11]
    v_fma_f32 v12, v146, v74, v122
    v_fma_f32 v13, v147, v75, v123
    v_cvt_pk_bf16_f32 v189, v12, v13
    v_lshlrev_b32 v170, 16, v189
    v_and_b32 v171, 0xffff0000, v189
    v_pk_add_f32 v[8:9], v[8:9], v[170:171]
    v_pk_fma_f32 v[10:11], v[170:171], v[170:171], v[10:11]
    v_fma_f32 v12, v148, v76, v124
    v_fma_f32 v13, v149, v77, v125
    v_cvt_pk_bf16_f32 v190, v12, v13
    v_lshlrev_b32 v172, 16, v190
    v_and_b32 v173, 0xffff0000, v190
    v_pk_add_f32 v[8:9], v[8:9], v[172:173]
    v_pk_fma_f32 v[10:11], v[172:173], v[172:173], v[10:11]
    v_fma_f32 v12, v150, v78, v126
    v_fma_f32 v13, v151, v79, v127
    v_cvt_pk_bf16_f32 v191, v12, v13
    v_lshlrev_b32 v174, 16, v191
    v_and_b32 v175, 0xffff0000, v191
    v_pk_add_f32 v[8:9], v[8:9], v[174:175]
    v_pk_fma_f32 v[10:11], v[174:175], v[174:175], v[10:11]
    s_cmp_eq_u32 s27, 1
    s_cbranch_scc1 C_F2_75
    v_fma_f32 v12, v152, v80, v128
    v_fma_f32 v13, v153, v81, v129
    v_cvt_pk_bf16_f32 v192, v12, v13
    v_lshlrev_b32 v176, 16, v192
    v_and_b32 v177, 0xffff0000, v192
    v_pk_add_f32 v[8:9], v[8:9], v[176:177]
    v_pk_fma_f32 v[10:11], v[176:177], v[176:177], v[10:11]
    v_fma_f32 v12, v154, v82, v130
    v_fma_f32 v13, v155, v83, v131
    v_cvt_pk_bf16_f32 v193, v12, v13
    v_lshlrev_b32 v178, 16, v193
    v_and_b32 v179, 0xffff0000, v193
    v_pk_add_f32 v[8:9], v[8:9], v[178:179]
    v_pk_fma_f32 v[10:11], v[178:179], v[178:179], v[10:11]
    v_fma_f32 v12, v156, v84, v132
    v_fma_f32 v13, v157, v85, v133
    v_cvt_pk_bf16_f32 v194, v12, v13
    v_lshlrev_b32 v180, 16, v194
    v_and_b32 v181, 0xffff0000, v194
    v_pk_add_f32 v[8:9], v[8:9], v[180:181]
    v_pk_fma_f32 v[10:11], v[180:181], v[180:181], v[10:11]
    v_fma_f32 v12, v158, v86, v134
    v_fma_f32 v13, v159, v87, v135
    v_cvt_pk_bf16_f32 v195, v12, v13
    v_lshlrev_b32 v182, 16, v195
    v_and_b32 v183, 0xffff0000, v195
    v_pk_add_f32 v[8:9], v[8:9], v[182:183]
    v_pk_fma_f32 v[10:11], v[182:183], v[182:183], v[10:11]
C_F2_75:
    v_add_f32 v8, v8, v9
    v_add_f32 v9, v10, v11
    v_mov_b32 v10, v8
    v_mov_b32 v11, v9
    s_nop 0
    v_permlane32_swap_b32 v8, v10
    v_permlane32_swap_b32 v9, v11
    v_add_f32 v8, v8, v10
    v_add_f32 v9, v9, v11
    s_cmp_eq_u32 s14, 0
    s_cbranch_scc1 ST_S_76
    s_mov_b32 exec_hi, 0
    buffer_store_dwordx2 v[8:9], v14, s[8:11], s33 offen
    s_mov_b64 exec, -1
    s_branch ST_E_77
ST_S_76:
    s_mov_b32 exec_hi, 0
    buffer_store_dwordx2 v[8:9], v14, s[8:11], s33 offen sc1
    s_mov_b64 exec, -1
ST_E_77:
    s_lshr_b32 s34, s13, 1
    s_mul_i32 s34, s34, 245760
    s_add_u32 s34, s34, 46137344
    s_and_b32 s19, s13, 1
    s_mul_i32 s19, s19, 0
    s_add_u32 s34, s34, s19
    s_lshl_b32 s19, s12, 7
    s_add_u32 s19, s19, 528384
    s_lshl_b32 s20, s13, 2
    s_add_u32 s20, s20, s19
    v_mov_b32 v250, s20
    v_and_b32 v251, 31, v2
    v_lshlrev_b32 v251, 2, v251
    v_add_u32 v251, s19, v251
    v_mov_b32 v249, 1
    s_waitcnt vmcnt(0)
    s_barrier
    s_cmp_lg_u32 s3, 0
    s_cbranch_scc1 GB_78
    s_mov_b64 exec, 1
    s_cmp_eq_u32 s14, 0
    s_cbranch_scc1 ST_S_80
    global_store_dword v250, v249, s[4:5]
    s_branch ST_E_81
ST_S_80:
    global_store_dword v250, v249, s[4:5] sc1
ST_E_81:
    s_mov_b64 exec, -1
    s_mov_b32 s18, 2000000
    global_load_dword v252, v251, s[4:5] sc1
    s_nop 7
    global_load_dword v253, v251, s[4:5] sc1
    s_nop 7
POLL_82:
    global_load_dword v254, v251, s[4:5] sc1
    s_waitcnt vmcnt(2)
    v_cmp_eq_u32 vcc, 0, v252
    s_cbranch_vccz POLLX_83
    global_load_dword v252, v251, s[4:5] sc1
    s_waitcnt vmcnt(2)
    v_cmp_eq_u32 vcc, 0, v253
    s_cbranch_vccz POLLX_83
    global_load_dword v253, v251, s[4:5] sc1
    s_waitcnt vmcnt(2)
    v_cmp_eq_u32 vcc, 0, v254
    s_cbranch_vccz POLLX_83
    s_sub_u32 s18, s18, 1
    s_cmp_lg_u32 s18, 0
    s_cbranch_scc1 POLL_82
POLLX_83:
GB_78:
    s_barrier
    buffer_load_dwordx2 v[64:65], v15, s[8:11], s42 offen offset:0 sc1
    buffer_load_dwordx2 v[66:67], v15, s[8:11], s42 offen offset:256 sc1
    buffer_load_dwordx2 v[68:69], v15, s[8:11], s42 offen offset:512 sc1
    buffer_load_dwordx2 v[70:71], v15, s[8:11], s42 offen offset:768 sc1
    buffer_load_dwordx2 v[72:73], v15, s[8:11], s42 offen offset:1024 sc1
    buffer_load_dwordx2 v[74:75], v15, s[8:11], s42 offen offset:1280 sc1
    buffer_load_dwordx2 v[76:77], v15, s[8:11], s42 offen offset:1536 sc1
    buffer_load_dwordx2 v[78:79], v15, s[8:11], s42 offen offset:1792 sc1
    v_accvgpr_read_b32 v10, a168
    v_accvgpr_read_b32 v11, a180
    v_lshlrev_b32 v16, 16, v10
    v_and_b32 v17, 0xffff0000, v10
    v_lshlrev_b32 v40, 16, v11
    v_and_b32 v41, 0xffff0000, v11
    v_accvgpr_read_b32 v10, a169
    v_accvgpr_read_b32 v11, a181
    v_lshlrev_b32 v18, 16, v10
    v_and_b32 v19, 0xffff0000, v10
    v_lshlrev_b32 v42, 16, v11
    v_and_b32 v43, 0xffff0000, v11
    v_accvgpr_read_b32 v10, a170
    v_accvgpr_read_b32 v11, a182
    v_lshlrev_b32 v20, 16, v10
    v_and_b32 v21, 0xffff0000, v10
    v_lshlrev_b32 v44, 16, v11
    v_and_b32 v45, 0xffff0000, v11
    v_accvgpr_read_b32 v10, a171
    v_accvgpr_read_b32 v11, a183
    v_lshlrev_b32 v22, 16, v10
    v_and_b32 v23, 0xffff0000, v10
    v_lshlrev_b32 v46, 16, v11
    v_and_b32 v47, 0xffff0000, v11
    v_accvgpr_read_b32 v10, a172
    v_accvgpr_read_b32 v11, a184
    v_lshlrev_b32 v24, 16, v10
    v_and_b32 v25, 0xffff0000, v10
    v_lshlrev_b32 v48, 16, v11
    v_and_b32 v49, 0xffff0000, v11
    v_accvgpr_read_b32 v10, a173
    v_accvgpr_read_b32 v11, a185
    v_lshlrev_b32 v26, 16, v10
    v_and_b32 v27, 0xffff0000, v10
    v_lshlrev_b32 v50, 16, v11
    v_and_b32 v51, 0xffff0000, v11
    v_accvgpr_read_b32 v10, a174
    v_accvgpr_read_b32 v11, a186
    v_lshlrev_b32 v28, 16, v10
    v_and_b32 v29, 0xffff0000, v10
    v_lshlrev_b32 v52, 16, v11
    v_and_b32 v53, 0xffff0000, v11
    v_accvgpr_read_b32 v10, a175
    v_accvgpr_read_b32 v11, a187
    v_lshlrev_b32 v30, 16, v10
    v_and_b32 v31, 0xffff0000, v10
    v_lshlrev_b32 v54, 16, v11
    v_and_b32 v55, 0xffff0000, v11
    v_accvgpr_read_b32 v10, a176
    v_accvgpr_read_b32 v11, a188
    v_lshlrev_b32 v32, 16, v10
    v_and_b32 v33, 0xffff0000, v10
    v_lshlrev_b32 v56, 16, v11
    v_and_b32 v57, 0xffff0000, v11
    v_accvgpr_read_b32 v10, a177
    v_accvgpr_read_b32 v11, a189
    v_lshlrev_b32 v34, 16, v10
    v_and_b32 v35, 0xffff0000, v10
    v_lshlrev_b32 v58, 16, v11
    v_and_b32 v59, 0xffff0000, v11
    v_accvgpr_read_b32 v10, a178
    v_accvgpr_read_b32 v11, a190
    v_lshlrev_b32 v36, 16, v10
    v_and_b32 v37, 0xffff0000, v10
    v_lshlrev_b32 v60, 16, v11
    v_and_b32 v61, 0xffff0000, v11
    v_accvgpr_read_b32 v10, a179
    v_accvgpr_read_b32 v11, a191
    v_lshlrev_b32 v38, 16, v10
    v_and_b32 v39, 0xffff0000, v10
    v_lshlrev_b32 v62, 16, v11
    v_and_b32 v63, 0xffff0000, v11
    s_waitcnt vmcnt(0)
    v_pk_add_f32 v[64:65], v[64:65], v[66:67]
    v_pk_add_f32 v[64:65], v[64:65], v[68:69]
    v_pk_add_f32 v[64:65], v[64:65], v[70:71]
    v_pk_add_f32 v[64:65], v[64:65], v[72:73]
    v_pk_add_f32 v[64:65], v[64:65], v[74:75]
    v_pk_add_f32 v[64:65], v[64:65], v[76:77]
    v_pk_add_f32 v[64:65], v[64:65], v[78:79]
    v_mov_b32 v10, v64
    v_mov_b32 v11, v65
    s_nop 0
    v_permlane32_swap_b32 v64, v10
    v_permlane32_swap_b32 v65, v11
    v_add_f32 v10, v64, v10
    v_add_f32 v11, v65, v11
    v_mul_f32 v10, 0x3acccccd, v10
    v_mul_f32 v11, 0x3acccccd, v11
    v_fma_f32 v11, -v10, v10, v11
    v_max_f32 v11, 0, v11
    v_add_f32 v11, 0x3727c5ac, v11
    v_rsq_f32 v11, v11
    v_sub_f32 v12, 0, v10
    v_mov_b32 v14, v11
    v_mov_b32 v15, v11
    v_mov_b32 v13, v12
    s_cmp_eq_u32 s14, 0
    s_cbranch_scc1 ST_S_85
    v_pk_mul_f32 v[16:17], v[16:17], v[14:15]
    v_pk_fma_f32 v[40:41], v[16:17], v[12:13], v[40:41]
    v_pk_fma_f32 v[160:161], v[160:161], v[16:17], v[40:41]
    v_cvt_pk_bf16_f32 v196, v160, v161
    v_pk_mul_f32 v[18:19], v[18:19], v[14:15]
    v_pk_fma_f32 v[42:43], v[18:19], v[12:13], v[42:43]
    v_pk_fma_f32 v[162:163], v[162:163], v[18:19], v[42:43]
    v_cvt_pk_bf16_f32 v197, v162, v163
    v_pk_mul_f32 v[20:21], v[20:21], v[14:15]
    v_pk_fma_f32 v[44:45], v[20:21], v[12:13], v[44:45]
    v_pk_fma_f32 v[164:165], v[164:165], v[20:21], v[44:45]
    v_cvt_pk_bf16_f32 v198, v164, v165
    v_pk_mul_f32 v[22:23], v[22:23], v[14:15]
    v_pk_fma_f32 v[46:47], v[22:23], v[12:13], v[46:47]
    v_pk_fma_f32 v[166:167], v[166:167], v[22:23], v[46:47]
    v_cvt_pk_bf16_f32 v199, v166, v167
    s_add_u32 s19, s31, 1048576
    buffer_store_dwordx4 v[196:199], v3, s[8:11], s19 offen
    v_pk_mul_f32 v[24:25], v[24:25], v[14:15]
    v_pk_fma_f32 v[48:49], v[24:25], v[12:13], v[48:49]
    v_pk_fma_f32 v[168:169], v[168:169], v[24:25], v[48:49]
    v_cvt_pk_bf16_f32 v200, v168, v169
    v_pk_mul_f32 v[26:27], v[26:27], v[14:15]
    v_pk_fma_f32 v[50:51], v[26:27], v[12:13], v[50:51]
    v_pk_fma_f32 v[170:171], v[170:171], v[26:27], v[50:51]
    v_cvt_pk_bf16_f32 v201, v170, v171
    v_pk_mul_f32 v[28:29], v[28:29], v[14:15]
    v_pk_fma_f32 v[52:53], v[28:29], v[12:13], v[52:53]
    v_pk_fma_f32 v[172:173], v[172:173], v[28:29], v[52:53]
    v_cvt_pk_bf16_f32 v202, v172, v173
    v_pk_mul_f32 v[30:31], v[30:31], v[14:15]
    v_pk_fma_f32 v[54:55], v[30:31], v[12:13], v[54:55]
    v_pk_fma_f32 v[174:175], v[174:175], v[30:31], v[54:55]
    v_cvt_pk_bf16_f32 v203, v174, v175
    s_add_u32 s19, s31, 1049600
    buffer_store_dwordx4 v[200:203], v3, s[8:11], s19 offen
    s_cmp_eq_u32 s27, 1
    s_cbranch_scc1 C_S3_87
    v_pk_mul_f32 v[32:33], v[32:33], v[14:15]
    v_pk_fma_f32 v[56:57], v[32:33], v[12:13], v[56:57]
    v_pk_fma_f32 v[176:177], v[176:177], v[32:33], v[56:57]
    v_cvt_pk_bf16_f32 v204, v176, v177
    v_pk_mul_f32 v[34:35], v[34:35], v[14:15]
    v_pk_fma_f32 v[58:59], v[34:35], v[12:13], v[58:59]
    v_pk_fma_f32 v[178:179], v[178:179], v[34:35], v[58:59]
    v_cvt_pk_bf16_f32 v205, v178, v179
    v_pk_mul_f32 v[36:37], v[36:37], v[14:15]
    v_pk_fma_f32 v[60:61], v[36:37], v[12:13], v[60:61]
    v_pk_fma_f32 v[180:181], v[180:181], v[36:37], v[60:61]
    v_cvt_pk_bf16_f32 v206, v180, v181
    v_pk_mul_f32 v[38:39], v[38:39], v[14:15]
    v_pk_fma_f32 v[62:63], v[38:39], v[12:13], v[62:63]
    v_pk_fma_f32 v[182:183], v[182:183], v[38:39], v[62:63]
    v_cvt_pk_bf16_f32 v207, v182, v183
    s_add_u32 s19, s31, 1050624
    buffer_store_dwordx4 v[204:207], v3, s[8:11], s19 offen
C_S3_87:
    s_branch ST_E_86
ST_S_85:
    v_pk_mul_f32 v[16:17], v[16:17], v[14:15]
    v_pk_fma_f32 v[40:41], v[16:17], v[12:13], v[40:41]
    v_pk_fma_f32 v[160:161], v[160:161], v[16:17], v[40:41]
    v_cvt_pk_bf16_f32 v196, v160, v161
    v_pk_mul_f32 v[18:19], v[18:19], v[14:15]
    v_pk_fma_f32 v[42:43], v[18:19], v[12:13], v[42:43]
    v_pk_fma_f32 v[162:163], v[162:163], v[18:19], v[42:43]
    v_cvt_pk_bf16_f32 v197, v162, v163
    v_pk_mul_f32 v[20:21], v[20:21], v[14:15]
    v_pk_fma_f32 v[44:45], v[20:21], v[12:13], v[44:45]
    v_pk_fma_f32 v[164:165], v[164:165], v[20:21], v[44:45]
    v_cvt_pk_bf16_f32 v198, v164, v165
    v_pk_mul_f32 v[22:23], v[22:23], v[14:15]
    v_pk_fma_f32 v[46:47], v[22:23], v[12:13], v[46:47]
    v_pk_fma_f32 v[166:167], v[166:167], v[22:23], v[46:47]
    v_cvt_pk_bf16_f32 v199, v166, v167
    s_add_u32 s19, s31, 1048576
    buffer_store_dwordx4 v[196:199], v3, s[8:11], s19 offen sc1
    v_pk_mul_f32 v[24:25], v[24:25], v[14:15]
    v_pk_fma_f32 v[48:49], v[24:25], v[12:13], v[48:49]
    v_pk_fma_f32 v[168:169], v[168:169], v[24:25], v[48:49]
    v_cvt_pk_bf16_f32 v200, v168, v169
    v_pk_mul_f32 v[26:27], v[26:27], v[14:15]
    v_pk_fma_f32 v[50:51], v[26:27], v[12:13], v[50:51]
    v_pk_fma_f32 v[170:171], v[170:171], v[26:27], v[50:51]
    v_cvt_pk_bf16_f32 v201, v170, v171
    v_pk_mul_f32 v[28:29], v[28:29], v[14:15]
    v_pk_fma_f32 v[52:53], v[28:29], v[12:13], v[52:53]
    v_pk_fma_f32 v[172:173], v[172:173], v[28:29], v[52:53]
    v_cvt_pk_bf16_f32 v202, v172, v173
    v_pk_mul_f32 v[30:31], v[30:31], v[14:15]
    v_pk_fma_f32 v[54:55], v[30:31], v[12:13], v[54:55]
    v_pk_fma_f32 v[174:175], v[174:175], v[30:31], v[54:55]
    v_cvt_pk_bf16_f32 v203, v174, v175
    s_add_u32 s19, s31, 1049600
    buffer_store_dwordx4 v[200:203], v3, s[8:11], s19 offen sc1
    s_cmp_eq_u32 s27, 1
    s_cbranch_scc1 C_S3_88
    v_pk_mul_f32 v[32:33], v[32:33], v[14:15]
    v_pk_fma_f32 v[56:57], v[32:33], v[12:13], v[56:57]
    v_pk_fma_f32 v[176:177], v[176:177], v[32:33], v[56:57]
    v_cvt_pk_bf16_f32 v204, v176, v177
    v_pk_mul_f32 v[34:35], v[34:35], v[14:15]
    v_pk_fma_f32 v[58:59], v[34:35], v[12:13], v[58:59]
    v_pk_fma_f32 v[178:179], v[178:179], v[34:35], v[58:59]
    v_cvt_pk_bf16_f32 v205, v178, v179
    v_pk_mul_f32 v[36:37], v[36:37], v[14:15]
    v_pk_fma_f32 v[60:61], v[36:37], v[12:13], v[60:61]
    v_pk_fma_f32 v[180:181], v[180:181], v[36:37], v[60:61]
    v_cvt_pk_bf16_f32 v206, v180, v181
    v_pk_mul_f32 v[38:39], v[38:39], v[14:15]
    v_pk_fma_f32 v[62:63], v[38:39], v[12:13], v[62:63]
    v_pk_fma_f32 v[182:183], v[182:183], v[38:39], v[62:63]
    v_cvt_pk_bf16_f32 v207, v182, v183
    s_add_u32 s19, s31, 1050624
    buffer_store_dwordx4 v[204:207], v3, s[8:11], s19 offen sc1
C_S3_88:
ST_E_86:
    s_lshl_b32 s19, s12, 7
    s_add_u32 s19, s19, 530432
    s_lshl_b32 s20, s13, 2
    s_add_u32 s20, s20, s19
    v_mov_b32 v250, s20
    v_and_b32 v251, 31, v2
    v_lshlrev_b32 v251, 2, v251
    v_add_u32 v251, s19, v251
    v_mov_b32 v249, 1
    s_lshr_b32 s15, s13, 1
    s_and_b32 s19, s13, 1
    s_lshl_b32 s19, s19, 2
    s_lshl_b32 s29, s12, 3
    s_add_u32 s29, s29, s19
    s_add_u32 s29, s29, s3
    s_mul_i32 s22, s29, 40960
    s_add_u32 s22, s22, 1048576
    s_mul_i32 s23, s15, 245760
    s_mul_i32 s30, s3, 6144
    s_add_u32 s23, s23, s30
    s_add_u32 s23, s23, 46137344
    s_and_b32 s19, s13, 1
    s_mul_i32 s20, s19, 0
    s_sub_u32 s27, s23, s20
    s_add_u32 s23, s23, s20
    s_mul_i32 s20, s19, 0
    s_sub_u32 s26, s22, s20
    s_add_u32 s22, s22, s20
    v_mov_b32 v4, v3
    v_add_u32 v5, 0x10000, v3
    v_add_u32 v6, 0x20000, v3
    s_add_u32 s25, s22, 0
    s_waitcnt vmcnt(0)
    s_barrier
    s_cmp_lg_u32 s3, 0
    s_cbranch_scc1 GBD_90
    s_mov_b64 exec, 1
    s_cmp_eq_u32 s14, 0
    s_cbranch_scc1 ST_S_91
    global_store_dword v250, v249, s[4:5]
    s_branch ST_E_92
ST_S_91:
    global_store_dword v250, v249, s[4:5] sc1
ST_E_92:
    s_mov_b64 exec, -1
    s_mov_b32 s18, 2000000
    global_load_dword v252, v251, s[4:5] sc1
    s_nop 7
    global_load_dword v253, v251, s[4:5] sc1
    s_nop 7
POLL_93:
    global_load_dword v254, v251, s[4:5] sc1
    s_waitcnt vmcnt(2)
    v_cmp_eq_u32 vcc, 0, v252
    s_cbranch_vccz POLLX_94
    global_load_dword v252, v251, s[4:5] sc1
    s_waitcnt vmcnt(2)
    v_cmp_eq_u32 vcc, 0, v253
    s_cbranch_vccz POLLX_94
    global_load_dword v253, v251, s[4:5] sc1
    s_waitcnt vmcnt(2)
    v_cmp_eq_u32 vcc, 0, v254
    s_cbranch_vccz POLLX_94
    s_sub_u32 s18, s18, 1
    s_cmp_lg_u32 s18, 0
    s_cbranch_scc1 POLL_93
POLLX_94:
    s_branch GB_89
GBD_90:
    s_cmp_eq_u32 s3, 0
    s_cbranch_scc1 PF_N_95
    s_sub_u32 s19, s3, 1
    s_mul_i32 s19, s19, 8192
    s_add_u32 s20, s34, s19
    s_add_u32 m0, s19, 0
    s_nop 0
    buffer_load_dwordx4 v3, s[8:11], s20 offen offset:0 lds
    buffer_load_dwordx4 v3, s[8:11], s20 offen offset:1024 lds
    buffer_load_dwordx4 v3, s[8:11], s20 offen offset:2048 lds
    buffer_load_dwordx4 v3, s[8:11], s20 offen offset:3072 lds
    s_add_u32 m0, s19, 4096
    s_add_u32 s20, s20, 4096
    buffer_load_dwordx4 v3, s[8:11], s20 offen offset:0 lds
    buffer_load_dwordx4 v3, s[8:11], s20 offen offset:1024 lds
    buffer_load_dwordx4 v3, s[8:11], s20 offen offset:2048 lds
    buffer_load_dwordx4 v3, s[8:11], s20 offen offset:3072 lds
PF_N_95:
GB_89:
    s_barrier
    buffer_load_dwordx4 a[0:3], v3, s[8:11], s25 offen offset:0 sc1
    buffer_load_dwordx4 a[4:7], v3, s[8:11], s25 offen offset:1024 sc1
    buffer_load_dwordx4 a[8:11], v3, s[8:11], s25 offen offset:2048 sc1
    buffer_load_dwordx4 a[12:15], v3, s[8:11], s25 offen offset:3072 sc1
    s_add_u32 m0, s30, 24576
    s_add_u32 s24, s23, 24576
    buffer_load_dwordx4 v3, s[8:11], s24 offen offset:0 lds
    buffer_load_dwordx4 v3, s[8:11], s24 offen offset:1024 lds
    buffer_load_dwordx4 v3, s[8:11], s24 offen offset:2048 lds
    buffer_load_dwordx4 v3, s[8:11], s24 offen offset:3072 lds
    s_add_u32 m0, s30, 28672
    s_add_u32 s24, s24, 4096
    buffer_load_dwordx4 v3, s[8:11], s24 offen offset:0 lds
    buffer_load_dwordx4 v3, s[8:11], s24 offen offset:1024 lds
    s_add_u32 s25, s22, 4096
    buffer_load_dwordx4 a[16:19], v3, s[8:11], s25 offen offset:0 sc1
    buffer_load_dwordx4 a[20:23], v3, s[8:11], s25 offen offset:1024 sc1
    buffer_load_dwordx4 a[24:27], v3, s[8:11], s25 offen offset:2048 sc1
    buffer_load_dwordx4 a[28:31], v3, s[8:11], s25 offen offset:3072 sc1
    s_waitcnt vmcnt(14)
    s_barrier
    ds_read_b128 v[16:19], v4 offset:0
    ds_read_b128 v[20:23], v4 offset:1024
    ds_read_b128 v[24:27], v4 offset:2048
    ds_read_b128 v[28:31], v4 offset:3072
    ds_read_b128 v[32:35], v4 offset:4096
    ds_read_b128 v[36:39], v4 offset:5120
    ds_read_b128 v[40:43], v4 offset:6144
    ds_read_b128 v[44:47], v4 offset:7168
    ds_read_b128 v[48:51], v4 offset:8192
    ds_read_b128 v[52:55], v4 offset:9216
    ds_read_b128 v[56:59], v4 offset:10240
    ds_read_b128 v[60:63], v4 offset:11264
    s_waitcnt vmcnt(13)
    s_waitcnt lgkmcnt(11)
    v_mfma_f32_32x32x16_bf16 v[88:103], v[16:19], a[0:3], 0
    ds_read_b128 v[64:67], v4 offset:12288
    s_and_b32 s31, s29, 7
    s_mul_i32 s31, s31, 96
    s_waitcnt lgkmcnt(11)
    v_mfma_f32_32x32x16_bf16 v[104:119], v[20:23], a[0:3], 0
    ds_read_b128 v[68:71], v4 offset:13312
    s_add_u32 m0, s30, 49152
    s_add_u32 s24, s23, 49152
    buffer_load_dwordx4 v3, s[8:11], s24 offen offset:0 lds
    s_mul_i32 s19, s15, 6
    s_add_u32 s31, s31, s19
    s_lshl_b32 s31, s31, 10
    s_waitcnt lgkmcnt(11)
    v_mfma_f32_32x32x16_bf16 v[120:135], v[24:27], a[0:3], 0
    ds_read_b128 v[72:75], v4 offset:14336
    s_add_u32 s19, s12, 7
    s_and_b32 s19, s19, 7
    s_mul_i32 s19, s19, 786432
    s_waitcnt lgkmcnt(11)
    v_mfma_f32_32x32x16_bf16 v[136:151], v[28:31], a[0:3], 0
    ds_read_b128 v[76:79], v4 offset:15360
    buffer_load_dwordx4 v3, s[8:11], s24 offen offset:1024 lds
    s_add_u32 s31, s31, s19
    s_add_u32 s31, s31, 8388608
    s_add_u32 s32, s31, 4096
    s_waitcnt lgkmcnt(11)
    v_mfma_f32_32x32x16_bf16 v[152:167], v[32:35], a[0:3], 0
    ds_read_b128 v[80:83], v4 offset:16384
    s_lshr_b32 s19, s13, 2
    s_mul_i32 s34, s19, 245760
    s_add_u32 s34, s34, 50331648
    s_waitcnt lgkmcnt(11)
    v_mfma_f32_32x32x16_bf16 v[168:183], v[36:39], a[0:3], 0
    ds_read_b128 v[84:87], v4 offset:17408
    buffer_load_dwordx4 v3, s[8:11], s24 offen offset:2048 lds
    s_mul_i32 s19, s12, 10240
    s_add_u32 s34, s34, s19
    s_waitcnt vmcnt(15)
    s_waitcnt lgkmcnt(11)
    v_mfma_f32_32x32x16_bf16 v[88:103], v[40:43], a[4:7], v[88:103]
    ds_read_b128 v[16:19], v4 offset:18432
    s_waitcnt lgkmcnt(11)
    v_mfma_f32_32x32x16_bf16 v[104:119], v[44:47], a[4:7], v[104:119]
    ds_read_b128 v[20:23], v4 offset:19456
    buffer_load_dwordx4 v3, s[8:11], s24 offen offset:3072 lds
    s_waitcnt lgkmcnt(11)
    v_mfma_f32_32x32x16_bf16 v[120:135], v[48:51], a[4:7], v[120:135]
    ds_read_b128 v[24:27], v4 offset:20480
    s_waitcnt lgkmcnt(11)
    v_mfma_f32_32x32x16_bf16 v[136:151], v[52:55], a[4:7], v[136:151]
    ds_read_b128 v[28:31], v4 offset:21504
    s_add_u32 m0, s30, 53248
    s_add_u32 s24, s24, 4096
    buffer_load_dwordx4 v3, s[8:11], s24 offen offset:0 lds
    s_waitcnt lgkmcnt(11)
    v_mfma_f32_32x32x16_bf16 v[152:167], v[56:59], a[4:7], v[152:167]
    ds_read_b128 v[32:35], v4 offset:22528
    s_waitcnt lgkmcnt(11)
    v_mfma_f32_32x32x16_bf16 v[168:183], v[60:63], a[4:7], v[168:183]
    ds_read_b128 v[36:39], v4 offset:23552
    buffer_load_dwordx4 v3, s[8:11], s24 offen offset:1024 lds
    s_waitcnt vmcnt(10)
    s_barrier
    s_waitcnt vmcnt(17)
    s_waitcnt lgkmcnt(11)
    v_mfma_f32_32x32x16_bf16 v[88:103], v[64:67], a[8:11], v[88:103]
    ds_read_b128 v[40:43], v4 offset:24576
    s_waitcnt lgkmcnt(11)
    v_mfma_f32_32x32x16_bf16 v[104:119], v[68:71], a[8:11], v[104:119]
    ds_read_b128 v[44:47], v4 offset:25600
    s_add_u32 s25, s22, 8192
    buffer_load_dwordx4 a[32:35], v3, s[8:11], s25 offen offset:0 sc1
    s_waitcnt lgkmcnt(11)
    v_mfma_f32_32x32x16_bf16 v[120:135], v[72:75], a[8:11], v[120:135]
    ds_read_b128 v[48:51], v4 offset:26624
    s_waitcnt lgkmcnt(11)
    v_mfma_f32_32x32x16_bf16 v[136:151], v[76:79], a[8:11], v[136:151]
    ds_read_b128 v[52:55], v4 offset:27648
    buffer_load_dwordx4 a[36:39], v3, s[8:11], s25 offen offset:1024 sc1
    s_waitcnt lgkmcnt(11)
    v_mfma_f32_32x32x16_bf16 v[152:167], v[80:83], a[8:11], v[152:167]
    ds_read_b128 v[56:59], v4 offset:28672
    s_waitcnt lgkmcnt(11)
    v_mfma_f32_32x32x16_bf16 v[168:183], v[84:87], a[8:11], v[168:183]
    ds_read_b128 v[60:63], v4 offset:29696
    buffer_load_dwordx4 a[40:43], v3, s[8:11], s25 offen offset:2048 sc1
    s_waitcnt vmcnt(19)
    s_waitcnt lgkmcnt(11)
    v_mfma_f32_32x32x16_bf16 v[88:103], v[16:19], a[12:15], v[88:103]
    ds_read_b128 v[64:67], v4 offset:30720
    s_waitcnt lgkmcnt(11)
    v_mfma_f32_32x32x16_bf16 v[104:119], v[20:23], a[12:15], v[104:119]
    ds_read_b128 v[68:71], v4 offset:31744
    buffer_load_dwordx4 a[44:47], v3, s[8:11], s25 offen offset:3072 sc1
    s_waitcnt lgkmcnt(11)
    v_mfma_f32_32x32x16_bf16 v[120:135], v[24:27], a[12:15], v[120:135]
    ds_read_b128 v[72:75], v4 offset:32768
    s_waitcnt lgkmcnt(11)
    v_mfma_f32_32x32x16_bf16 v[136:151], v[28:31], a[12:15], v[136:151]
    ds_read_b128 v[76:79], v4 offset:33792
    s_add_u32 m0, s30, 73728
    s_add_u32 s24, s23, 73728
    buffer_load_dwordx4 v3, s[8:11], s24 offen offset:0 lds
    s_waitcnt lgkmcnt(11)
    v_mfma_f32_32x32x16_bf16 v[152:167], v[32:35], a[12:15], v[152:167]
    ds_read_b128 v[80:83], v4 offset:34816
    s_waitcnt lgkmcnt(11)
    v_mfma_f32_32x32x16_bf16 v[168:183], v[36:39], a[12:15], v[168:183]
    ds_read_b128 v[84:87], v4 offset:35840
    buffer_load_dwordx4 v3, s[8:11], s24 offen offset:1024 lds
    s_waitcnt vmcnt(15)
    s_waitcnt lgkmcnt(11)
    v_mfma_f32_32x32x16_bf16 v[88:103], v[40:43], a[16:19], v[88:103]
    ds_read_b128 v[16:19], v4 offset:36864
    s_waitcnt lgkmcnt(11)
    v_mfma_f32_32x32x16_bf16 v[104:119], v[44:47], a[16:19], v[104:119]
    ds_read_b128 v[20:23], v4 offset:37888
    buffer_load_dwordx4 v3, s[8:11], s24 offen offset:2048 lds
    s_waitcnt lgkmcnt(11)
    v_mfma_f32_32x32x16_bf16 v[120:135], v[48:51], a[16:19], v[120:135]
    ds_read_b128 v[24:27], v4 offset:38912
    s_waitcnt lgkmcnt(11)
    v_mfma_f32_32x32x16_bf16 v[136:151], v[52:55], a[16:19], v[136:151]
    ds_read_b128 v[28:31], v4 offset:39936
    buffer_load_dwordx4 v3, s[8:11], s24 offen offset:3072 lds
    s_waitcnt lgkmcnt(11)
    v_mfma_f32_32x32x16_bf16 v[152:167], v[56:59], a[16:19], v[152:167]
    ds_read_b128 v[32:35], v4 offset:40960
    s_waitcnt lgkmcnt(11)
    v_mfma_f32_32x32x16_bf16 v[168:183], v[60:63], a[16:19], v[168:183]
    ds_read_b128 v[36:39], v4 offset:41984
    s_add_u32 m0, s30, 77824
    s_add_u32 s24, s24, 4096
    buffer_load_dwordx4 v3, s[8:11], s24 offen offset:0 lds
    s_waitcnt vmcnt(17)
    s_waitcnt lgkmcnt(11)
    v_mfma_f32_32x32x16_bf16 v[88:103], v[64:67], a[20:23], v[88:103]
    ds_read_b128 v[40:43], v4 offset:43008
    s_waitcnt lgkmcnt(11)
    v_mfma_f32_32x32x16_bf16 v[104:119], v[68:71], a[20:23], v[104:119]
    ds_read_b128 v[44:47], v4 offset:44032
    buffer_load_dwordx4 v3, s[8:11], s24 offen offset:1024 lds
    s_waitcnt lgkmcnt(11)
    v_mfma_f32_32x32x16_bf16 v[120:135], v[72:75], a[20:23], v[120:135]
    ds_read_b128 v[48:51], v4 offset:45056
    s_waitcnt lgkmcnt(11)
    v_mfma_f32_32x32x16_bf16 v[136:151], v[76:79], a[20:23], v[136:151]
    ds_read_b128 v[52:55], v4 offset:46080
    s_add_u32 s25, s22, 12288
    buffer_load_dwordx4 a[48:51], v3, s[8:11], s25 offen offset:0 sc1
    s_waitcnt lgkmcnt(11)
    v_mfma_f32_32x32x16_bf16 v[152:167], v[80:83], a[20:23], v[152:167]
    ds_read_b128 v[56:59], v4 offset:47104
    s_waitcnt lgkmcnt(11)
    v_mfma_f32_32x32x16_bf16 v[168:183], v[84:87], a[20:23], v[168:183]
    ds_read_b128 v[60:63], v4 offset:48128
    buffer_load_dwordx4 a[52:55], v3, s[8:11], s25 offen offset:1024 sc1
    s_waitcnt vmcnt(12)
    s_barrier
    s_waitcnt vmcnt(19)
    s_waitcnt lgkmcnt(11)
    v_mfma_f32_32x32x16_bf16 v[88:103], v[16:19], a[24:27], v[88:103]
    ds_read_b128 v[64:67], v4 offset:49152
    s_waitcnt lgkmcnt(11)
    v_mfma_f32_32x32x16_bf16 v[104:119], v[20:23], a[24:27], v[104:119]
    ds_read_b128 v[68:71], v4 offset:50176
    buffer_load_dwordx4 a[56:59], v3, s[8:11], s25 offen offset:2048 sc1
    s_waitcnt lgkmcnt(11)
    v_mfma_f32_32x32x16_bf16 v[120:135], v[24:27], a[24:27], v[120:135]
    ds_read_b128 v[72:75], v4 offset:51200
    s_waitcnt lgkmcnt(11)
    v_mfma_f32_32x32x16_bf16 v[136:151], v[28:31], a[24:27], v[136:151]
    ds_read_b128 v[76:79], v4 offset:52224
    buffer_load_dwordx4 a[60:63], v3, s[8:11], s25 offen offset:3072 sc1
    s_waitcnt lgkmcnt(11)
    v_mfma_f32_32x32x16_bf16 v[152:167], v[32:35], a[24:27], v[152:167]
    ds_read_b128 v[80:83], v4 offset:53248
    s_waitcnt lgkmcnt(11)
    v_mfma_f32_32x32x16_bf16 v[168:183], v[36:39], a[24:27], v[168:183]
    ds_read_b128 v[84:87], v4 offset:54272
    s_add_u32 m0, s30, 98304
    s_add_u32 s24, s23, 98304
    buffer_load_dwordx4 v3, s[8:11], s24 offen offset:0 lds
    s_waitcnt vmcnt(21)
    s_waitcnt lgkmcnt(11)
    v_mfma_f32_32x32x16_bf16 v[88:103], v[40:43], a[28:31], v[88:103]
    ds_read_b128 v[16:19], v4 offset:55296
    s_waitcnt lgkmcnt(11)
    v_mfma_f32_32x32x16_bf16 v[104:119], v[44:47], a[28:31], v[104:119]
    ds_read_b128 v[20:23], v4 offset:56320
    buffer_load_dwordx4 v3, s[8:11], s24 offen offset:1024 lds
    s_waitcnt lgkmcnt(11)
    v_mfma_f32_32x32x16_bf16 v[120:135], v[48:51], a[28:31], v[120:135]
    ds_read_b128 v[24:27], v4 offset:57344
    s_waitcnt lgkmcnt(11)
    v_mfma_f32_32x32x16_bf16 v[136:151], v[52:55], a[28:31], v[136:151]
    ds_read_b128 v[28:31], v4 offset:58368
    buffer_load_dwordx4 v3, s[8:11], s24 offen offset:2048 lds
    s_waitcnt lgkmcnt(11)
    v_mfma_f32_32x32x16_bf16 v[152:167], v[56:59], a[28:31], v[152:167]
    ds_read_b128 v[32:35], v4 offset:59392
    s_waitcnt lgkmcnt(11)
    v_mfma_f32_32x32x16_bf16 v[168:183], v[60:63], a[28:31], v[168:183]
    ds_read_b128 v[36:39], v4 offset:60416
    buffer_load_dwordx4 v3, s[8:11], s24 offen offset:3072 lds
    s_waitcnt vmcnt(17)
    s_waitcnt lgkmcnt(11)
    v_mfma_f32_32x32x16_bf16 v[88:103], v[64:67], a[32:35], v[88:103]
    ds_read_b128 v[40:43], v4 offset:61440
    s_waitcnt lgkmcnt(11)
    v_mfma_f32_32x32x16_bf16 v[104:119], v[68:71], a[32:35], v[104:119]
    ds_read_b128 v[44:47], v4 offset:62464
    s_add_u32 m0, s30, 102400
    s_add_u32 s24, s24, 4096
    buffer_load_dwordx4 v3, s[8:11], s24 offen offset:0 lds
    s_waitcnt lgkmcnt(11)
    v_mfma_f32_32x32x16_bf16 v[120:135], v[72:75], a[32:35], v[120:135]
    ds_read_b128 v[48:51], v4 offset:63488
    s_waitcnt lgkmcnt(11)
    v_mfma_f32_32x32x16_bf16 v[136:151], v[76:79], a[32:35], v[136:151]
    ds_read_b128 v[52:55], v4 offset:64512
    buffer_load_dwordx4 v3, s[8:11], s24 offen offset:1024 lds
    s_waitcnt lgkmcnt(11)
    v_mfma_f32_32x32x16_bf16 v[152:167], v[80:83], a[32:35], v[152:167]
    ds_read_b128 v[56:59], v5 offset:0
    s_waitcnt lgkmcnt(11)
    v_mfma_f32_32x32x16_bf16 v[168:183], v[84:87], a[32:35], v[168:183]
    ds_read_b128 v[60:63], v5 offset:1024
    s_add_u32 s25, s22, 16384
    buffer_load_dwordx4 a[64:67], v3, s[8:11], s25 offen offset:0 sc1
    s_waitcnt vmcnt(19)
    s_waitcnt lgkmcnt(11)
    v_mfma_f32_32x32x16_bf16 v[88:103], v[16:19], a[36:39], v[88:103]
    ds_read_b128 v[64:67], v5 offset:2048
    s_waitcnt lgkmcnt(11)
    v_mfma_f32_32x32x16_bf16 v[104:119], v[20:23], a[36:39], v[104:119]
    ds_read_b128 v[68:71], v5 offset:3072
    buffer_load_dwordx4 a[68:71], v3, s[8:11], s25 offen offset:1024 sc1
    s_waitcnt lgkmcnt(11)
    v_mfma_f32_32x32x16_bf16 v[120:135], v[24:27], a[36:39], v[120:135]
    ds_read_b128 v[72:75], v5 offset:4096
    s_waitcnt lgkmcnt(11)
    v_mfma_f32_32x32x16_bf16 v[136:151], v[28:31], a[36:39], v[136:151]
    ds_read_b128 v[76:79], v5 offset:5120
    buffer_load_dwordx4 a[72:75], v3, s[8:11], s25 offen offset:2048 sc1
    s_waitcnt lgkmcnt(11)
    v_mfma_f32_32x32x16_bf16 v[152:167], v[32:35], a[36:39], v[152:167]
    ds_read_b128 v[80:83], v5 offset:6144
    s_waitcnt lgkmcnt(11)
    v_mfma_f32_32x32x16_bf16 v[168:183], v[36:39], a[36:39], v[168:183]
    ds_read_b128 v[84:87], v5 offset:7168
    buffer_load_dwordx4 a[76:79], v3, s[8:11], s25 offen offset:3072 sc1
    s_waitcnt vmcnt(14)
    s_barrier
    s_waitcnt vmcnt(21)
    s_waitcnt lgkmcnt(11)
    v_mfma_f32_32x32x16_bf16 v[88:103], v[40:43], a[40:43], v[88:103]
    ds_read_b128 v[16:19], v5 offset:8192
    s_waitcnt lgkmcnt(11)
    v_mfma_f32_32x32x16_bf16 v[104:119], v[44:47], a[40:43], v[104:119]
    ds_read_b128 v[20:23], v5 offset:9216
    s_add_u32 m0, s30, 122880
    s_add_u32 s24, s27, 122880
    buffer_load_dwordx4 v3, s[8:11], s24 offen offset:0 lds
    s_waitcnt lgkmcnt(11)
    v_mfma_f32_32x32x16_bf16 v[120:135], v[48:51], a[40:43], v[120:135]
    ds_read_b128 v[24:27], v5 offset:10240
    s_waitcnt lgkmcnt(11)
    v_mfma_f32_32x32x16_bf16 v[136:151], v[52:55], a[40:43], v[136:151]
    ds_read_b128 v[28:31], v5 offset:11264
    buffer_load_dwordx4 v3, s[8:11], s24 offen offset:1024 lds
    s_waitcnt lgkmcnt(11)
    v_mfma_f32_32x32x16_bf16 v[152:167], v[56:59], a[40:43], v[152:167]
    ds_read_b128 v[32:35], v5 offset:12288
    s_waitcnt lgkmcnt(11)
    v_mfma_f32_32x32x16_bf16 v[168:183], v[60:63], a[40:43], v[168:183]
    ds_read_b128 v[36:39], v5 offset:13312
    buffer_load_dwordx4 v3, s[8:11], s24 offen offset:2048 lds
    s_waitcnt vmcnt(23)
    s_waitcnt lgkmcnt(11)
    v_mfma_f32_32x32x16_bf16 v[88:103], v[64:67], a[44:47], v[88:103]
    ds_read_b128 v[40:43], v5 offset:14336
    s_waitcnt lgkmcnt(11)
    v_mfma_f32_32x32x16_bf16 v[104:119], v[68:71], a[44:47], v[104:119]
    ds_read_b128 v[44:47], v5 offset:15360
    buffer_load_dwordx4 v3, s[8:11], s24 offen offset:3072 lds
    s_waitcnt lgkmcnt(11)
    v_mfma_f32_32x32x16_bf16 v[120:135], v[72:75], a[44:47], v[120:135]
    ds_read_b128 v[48:51], v5 offset:16384
    s_waitcnt lgkmcnt(11)
    v_mfma_f32_32x32x16_bf16 v[136:151], v[76:79], a[44:47], v[136:151]
    ds_read_b128 v[52:55], v5 offset:17408
    s_add_u32 m0, s30, 126976
    s_add_u32 s24, s24, 4096
    buffer_load_dwordx4 v3, s[8:11], s24 offen offset:0 lds
    s_waitcnt lgkmcnt(11)
    v_mfma_f32_32x32x16_bf16 v[152:167], v[80:83], a[44:47], v[152:167]
    ds_read_b128 v[56:59], v5 offset:18432
    s_waitcnt lgkmcnt(11)
    v_mfma_f32_32x32x16_bf16 v[168:183], v[84:87], a[44:47], v[168:183]
    ds_read_b128 v[60:63], v5 offset:19456
    buffer_load_dwordx4 v3, s[8:11], s24 offen offset:1024 lds
    s_waitcnt vmcnt(19)
    s_waitcnt lgkmcnt(11)
    v_mfma_f32_32x32x16_bf16 v[88:103], v[16:19], a[48:51], v[88:103]
    ds_read_b128 v[64:67], v5 offset:20480
    s_waitcnt lgkmcnt(11)
    v_mfma_f32_32x32x16_bf16 v[104:119], v[20:23], a[48:51], v[104:119]
    ds_read_b128 v[68:71], v5 offset:21504
    s_add_u32 s25, s26, 20480
    buffer_load_dwordx4 a[80:83], v3, s[8:11], s25 offen offset:0 sc1
    s_waitcnt lgkmcnt(11)
    v_mfma_f32_32x32x16_bf16 v[120:135], v[24:27], a[48:51], v[120:135]
    ds_read_b128 v[72:75], v5 offset:22528
    s_waitcnt lgkmcnt(11)
    v_mfma_f32_32x32x16_bf16 v[136:151], v[28:31], a[48:51], v[136:151]
    ds_read_b128 v[76:79], v5 offset:23552
    buffer_load_dwordx4 a[84:87], v3, s[8:11], s25 offen offset:1024 sc1
    s_waitcnt lgkmcnt(11)
    v_mfma_f32_32x32x16_bf16 v[152:167], v[32:35], a[48:51], v[152:167]
    ds_read_b128 v[80:83], v5 offset:24576
    s_waitcnt lgkmcnt(11)
    v_mfma_f32_32x32x16_bf16 v[168:183], v[36:39], a[48:51], v[168:183]
    ds_read_b128 v[84:87], v5 offset:25600
    buffer_load_dwordx4 a[88:91], v3, s[8:11], s25 offen offset:2048 sc1
    s_waitcnt vmcnt(21)
    s_waitcnt lgkmcnt(11)
    v_mfma_f32_32x32x16_bf16 v[88:103], v[40:43], a[52:55], v[88:103]
    ds_read_b128 v[16:19], v5 offset:26624
    s_waitcnt lgkmcnt(11)
    v_mfma_f32_32x32x16_bf16 v[104:119], v[44:47], a[52:55], v[104:119]
    ds_read_b128 v[20:23], v5 offset:27648
    buffer_load_dwordx4 a[92:95], v3, s[8:11], s25 offen offset:3072 sc1
    s_waitcnt lgkmcnt(11)
    v_mfma_f32_32x32x16_bf16 v[120:135], v[48:51], a[52:55], v[120:135]
    ds_read_b128 v[24:27], v5 offset:28672
    s_waitcnt lgkmcnt(11)
    v_mfma_f32_32x32x16_bf16 v[136:151], v[52:55], a[52:55], v[136:151]
    ds_read_b128 v[28:31], v5 offset:29696
    s_add_u32 m0, s30, 0
    s_add_u32 s24, s27, 147456
    buffer_load_dwordx4 v3, s[8:11], s24 offen offset:0 lds
    s_waitcnt lgkmcnt(11)
    v_mfma_f32_32x32x16_bf16 v[152:167], v[56:59], a[52:55], v[152:167]
    ds_read_b128 v[32:35], v5 offset:30720
    s_waitcnt lgkmcnt(11)
    v_mfma_f32_32x32x16_bf16 v[168:183], v[60:63], a[52:55], v[168:183]
    ds_read_b128 v[36:39], v5 offset:31744
    buffer_load_dwordx4 v3, s[8:11], s24 offen offset:1024 lds
    s_waitcnt vmcnt(16)
    s_barrier
    s_waitcnt vmcnt(23)
    s_waitcnt lgkmcnt(11)
    v_mfma_f32_32x32x16_bf16 v[88:103], v[64:67], a[56:59], v[88:103]
    ds_read_b128 v[40:43], v5 offset:32768
    s_waitcnt lgkmcnt(11)
    v_mfma_f32_32x32x16_bf16 v[104:119], v[68:71], a[56:59], v[104:119]
    ds_read_b128 v[44:47], v5 offset:33792
    buffer_load_dwordx4 v3, s[8:11], s24 offen offset:2048 lds
    s_waitcnt lgkmcnt(11)
    v_mfma_f32_32x32x16_bf16 v[120:135], v[72:75], a[56:59], v[120:135]
    ds_read_b128 v[48:51], v5 offset:34816
    s_waitcnt lgkmcnt(11)
    v_mfma_f32_32x32x16_bf16 v[136:151], v[76:79], a[56:59], v[136:151]
    ds_read_b128 v[52:55], v5 offset:35840
    buffer_load_dwordx4 v3, s[8:11], s24 offen offset:3072 lds
    s_waitcnt lgkmcnt(11)
    v_mfma_f32_32x32x16_bf16 v[152:167], v[80:83], a[56:59], v[152:167]
    ds_read_b128 v[56:59], v5 offset:36864
    s_waitcnt lgkmcnt(11)
    v_mfma_f32_32x32x16_bf16 v[168:183], v[84:87], a[56:59], v[168:183]
    ds_read_b128 v[60:63], v5 offset:37888
    s_add_u32 m0, s30, 4096
    s_add_u32 s24, s24, 4096
    buffer_load_dwordx4 v3, s[8:11], s24 offen offset:0 lds
    s_waitcnt vmcnt(25)
    s_waitcnt lgkmcnt(11)
    v_mfma_f32_32x32x16_bf16 v[88:103], v[16:19], a[60:63], v[88:103]
    ds_read_b128 v[64:67], v5 offset:38912
    s_waitcnt lgkmcnt(11)
    v_mfma_f32_32x32x16_bf16 v[104:119], v[20:23], a[60:63], v[104:119]
    ds_read_b128 v[68:71], v5 offset:39936
    buffer_load_dwordx4 v3, s[8:11], s24 offen offset:1024 lds
    s_waitcnt lgkmcnt(11)
    v_mfma_f32_32x32x16_bf16 v[120:135], v[24:27], a[60:63], v[120:135]
    ds_read_b128 v[72:75], v5 offset:40960
    s_waitcnt lgkmcnt(11)
    v_mfma_f32_32x32x16_bf16 v[136:151], v[28:31], a[60:63], v[136:151]
    ds_read_b128 v[76:79], v5 offset:41984
    s_add_u32 s25, s26, 24576
    buffer_load_dwordx4 a[96:99], v3, s[8:11], s25 offen offset:0 sc1
    s_waitcnt lgkmcnt(11)
    v_mfma_f32_32x32x16_bf16 v[152:167], v[32:35], a[60:63], v[152:167]
    ds_read_b128 v[80:83], v5 offset:43008
    s_waitcnt lgkmcnt(11)
    v_mfma_f32_32x32x16_bf16 v[168:183], v[36:39], a[60:63], v[168:183]
    ds_read_b128 v[84:87], v5 offset:44032
    buffer_load_dwordx4 a[100:103], v3, s[8:11], s25 offen offset:1024 sc1
    s_waitcnt vmcnt(21)
    s_waitcnt lgkmcnt(11)
    v_mfma_f32_32x32x16_bf16 v[88:103], v[40:43], a[64:67], v[88:103]
    ds_read_b128 v[16:19], v5 offset:45056
    s_waitcnt lgkmcnt(11)
    v_mfma_f32_32x32x16_bf16 v[104:119], v[44:47], a[64:67], v[104:119]
    ds_read_b128 v[20:23], v5 offset:46080
    buffer_load_dwordx4 a[104:107], v3, s[8:11], s25 offen offset:2048 sc1
    s_waitcnt lgkmcnt(11)
    v_mfma_f32_32x32x16_bf16 v[120:135], v[48:51], a[64:67], v[120:135]
    ds_read_b128 v[24:27], v5 offset:47104
    s_waitcnt lgkmcnt(11)
    v_mfma_f32_32x32x16_bf16 v[136:151], v[52:55], a[64:67], v[136:151]
    ds_read_b128 v[28:31], v5 offset:48128
    buffer_load_dwordx4 a[108:111], v3, s[8:11], s25 offen offset:3072 sc1
    s_waitcnt lgkmcnt(11)
    v_mfma_f32_32x32x16_bf16 v[152:167], v[56:59], a[64:67], v[152:167]
    ds_read_b128 v[32:35], v5 offset:49152
    s_waitcnt lgkmcnt(11)
    v_mfma_f32_32x32x16_bf16 v[168:183], v[60:63], a[64:67], v[168:183]
    ds_read_b128 v[36:39], v5 offset:50176
    s_add_u32 m0, s30, 24576
    s_add_u32 s24, s27, 172032
    buffer_load_dwordx4 v3, s[8:11], s24 offen offset:0 lds
    s_waitcnt vmcnt(23)
    s_waitcnt lgkmcnt(11)
    v_mfma_f32_32x32x16_bf16 v[88:103], v[64:67], a[68:71], v[88:103]
    ds_read_b128 v[40:43], v5 offset:51200
    s_waitcnt lgkmcnt(11)
    v_mfma_f32_32x32x16_bf16 v[104:119], v[68:71], a[68:71], v[104:119]
    ds_read_b128 v[44:47], v5 offset:52224
    buffer_load_dwordx4 v3, s[8:11], s24 offen offset:1024 lds
    s_waitcnt lgkmcnt(11)
    v_mfma_f32_32x32x16_bf16 v[120:135], v[72:75], a[68:71], v[120:135]
    ds_read_b128 v[48:51], v5 offset:53248
    s_waitcnt lgkmcnt(11)
    v_mfma_f32_32x32x16_bf16 v[136:151], v[76:79], a[68:71], v[136:151]
    ds_read_b128 v[52:55], v5 offset:54272
    buffer_load_dwordx4 v3, s[8:11], s24 offen offset:2048 lds
    s_waitcnt lgkmcnt(11)
    v_mfma_f32_32x32x16_bf16 v[152:167], v[80:83], a[68:71], v[152:167]
    ds_read_b128 v[56:59], v5 offset:55296
    s_waitcnt lgkmcnt(11)
    v_mfma_f32_32x32x16_bf16 v[168:183], v[84:87], a[68:71], v[168:183]
    ds_read_b128 v[60:63], v5 offset:56320
    buffer_load_dwordx4 v3, s[8:11], s24 offen offset:3072 lds
    s_waitcnt vmcnt(18)
    s_barrier
    s_waitcnt vmcnt(25)
    s_waitcnt lgkmcnt(11)
    v_mfma_f32_32x32x16_bf16 v[88:103], v[16:19], a[72:75], v[88:103]
    ds_read_b128 v[64:67], v5 offset:57344
    s_waitcnt lgkmcnt(11)
    v_mfma_f32_32x32x16_bf16 v[104:119], v[20:23], a[72:75], v[104:119]
    ds_read_b128 v[68:71], v5 offset:58368
    s_add_u32 m0, s30, 28672
    s_add_u32 s24, s24, 4096
    buffer_load_dwordx4 v3, s[8:11], s24 offen offset:0 lds
    s_waitcnt lgkmcnt(11)
    v_mfma_f32_32x32x16_bf16 v[120:135], v[24:27], a[72:75], v[120:135]
    ds_read_b128 v[72:75], v5 offset:59392
    s_waitcnt lgkmcnt(11)
    v_mfma_f32_32x32x16_bf16 v[136:151], v[28:31], a[72:75], v[136:151]
    ds_read_b128 v[76:79], v5 offset:60416
    buffer_load_dwordx4 v3, s[8:11], s24 offen offset:1024 lds
    s_waitcnt lgkmcnt(11)
    v_mfma_f32_32x32x16_bf16 v[152:167], v[32:35], a[72:75], v[152:167]
    ds_read_b128 v[80:83], v5 offset:61440
    s_waitcnt lgkmcnt(11)
    v_mfma_f32_32x32x16_bf16 v[168:183], v[36:39], a[72:75], v[168:183]
    ds_read_b128 v[84:87], v5 offset:62464
    s_add_u32 s25, s26, 28672
    buffer_load_dwordx4 a[112:115], v3, s[8:11], s25 offen offset:0 sc1
    s_waitcnt vmcnt(27)
    s_waitcnt lgkmcnt(11)
    v_mfma_f32_32x32x16_bf16 v[88:103], v[40:43], a[76:79], v[88:103]
    ds_read_b128 v[16:19], v5 offset:63488
    s_waitcnt lgkmcnt(11)
    v_mfma_f32_32x32x16_bf16 v[104:119], v[44:47], a[76:79], v[104:119]
    ds_read_b128 v[20:23], v5 offset:64512
    buffer_load_dwordx4 a[116:119], v3, s[8:11], s25 offen offset:1024 sc1
    s_waitcnt lgkmcnt(11)
    v_mfma_f32_32x32x16_bf16 v[120:135], v[48:51], a[76:79], v[120:135]
    ds_read_b128 v[24:27], v6 offset:0
    s_waitcnt lgkmcnt(11)
    v_mfma_f32_32x32x16_bf16 v[136:151], v[52:55], a[76:79], v[136:151]
    ds_read_b128 v[28:31], v6 offset:1024
    buffer_load_dwordx4 a[120:123], v3, s[8:11], s25 offen offset:2048 sc1
    s_waitcnt lgkmcnt(11)
    v_mfma_f32_32x32x16_bf16 v[152:167], v[56:59], a[76:79], v[152:167]
    ds_read_b128 v[32:35], v6 offset:2048
    s_waitcnt lgkmcnt(11)
    v_mfma_f32_32x32x16_bf16 v[168:183], v[60:63], a[76:79], v[168:183]
    ds_read_b128 v[36:39], v6 offset:3072
    buffer_load_dwordx4 a[124:127], v3, s[8:11], s25 offen offset:3072 sc1
    s_waitcnt vmcnt(23)
    s_waitcnt lgkmcnt(11)
    v_mfma_f32_32x32x16_bf16 v[88:103], v[64:67], a[80:83], v[88:103]
    ds_read_b128 v[40:43], v6 offset:4096
    s_waitcnt lgkmcnt(11)
    v_mfma_f32_32x32x16_bf16 v[104:119], v[68:71], a[80:83], v[104:119]
    ds_read_b128 v[44:47], v6 offset:5120
    s_add_u32 m0, s30, 49152
    s_add_u32 s24, s27, 196608
    buffer_load_dwordx4 v3, s[8:11], s24 offen offset:0 lds
    s_waitcnt lgkmcnt(11)
    v_mfma_f32_32x32x16_bf16 v[120:135], v[72:75], a[80:83], v[120:135]
    ds_read_b128 v[48:51], v6 offset:6144
    s_waitcnt lgkmcnt(11)
    v_mfma_f32_32x32x16_bf16 v[136:151], v[76:79], a[80:83], v[136:151]
    ds_read_b128 v[52:55], v6 offset:7168
    buffer_load_dwordx4 v3, s[8:11], s24 offen offset:1024 lds
    s_waitcnt lgkmcnt(11)
    v_mfma_f32_32x32x16_bf16 v[152:167], v[80:83], a[80:83], v[152:167]
    ds_read_b128 v[56:59], v6 offset:8192
    s_waitcnt lgkmcnt(11)
    v_mfma_f32_32x32x16_bf16 v[168:183], v[84:87], a[80:83], v[168:183]
    ds_read_b128 v[60:63], v6 offset:9216
    buffer_load_dwordx4 v3, s[8:11], s24 offen offset:2048 lds
    s_waitcnt vmcnt(25)
    s_waitcnt lgkmcnt(11)
    v_mfma_f32_32x32x16_bf16 v[88:103], v[16:19], a[84:87], v[88:103]
    ds_read_b128 v[64:67], v6 offset:10240
    s_waitcnt lgkmcnt(11)
    v_mfma_f32_32x32x16_bf16 v[104:119], v[20:23], a[84:87], v[104:119]
    ds_read_b128 v[68:71], v6 offset:11264
    buffer_load_dwordx4 v3, s[8:11], s24 offen offset:3072 lds
    s_waitcnt lgkmcnt(11)
    v_mfma_f32_32x32x16_bf16 v[120:135], v[24:27], a[84:87], v[120:135]
    ds_read_b128 v[72:75], v6 offset:12288
    s_waitcnt lgkmcnt(11)
    v_mfma_f32_32x32x16_bf16 v[136:151], v[28:31], a[84:87], v[136:151]
    ds_read_b128 v[76:79], v6 offset:13312
    s_add_u32 m0, s30, 53248
    s_add_u32 s24, s24, 4096
    buffer_load_dwordx4 v3, s[8:11], s24 offen offset:0 lds
    s_waitcnt lgkmcnt(11)
    v_mfma_f32_32x32x16_bf16 v[152:167], v[32:35], a[84:87], v[152:167]
    ds_read_b128 v[80:83], v6 offset:14336
    s_waitcnt lgkmcnt(11)
    v_mfma_f32_32x32x16_bf16 v[168:183], v[36:39], a[84:87], v[168:183]
    ds_read_b128 v[84:87], v6 offset:15360
    buffer_load_dwordx4 v3, s[8:11], s24 offen offset:1024 lds
    s_waitcnt vmcnt(20)
    s_barrier
    s_waitcnt vmcnt(27)
    s_waitcnt lgkmcnt(11)
    v_mfma_f32_32x32x16_bf16 v[88:103], v[40:43], a[88:91], v[88:103]
    ds_read_b128 v[16:19], v4 offset:0
    s_waitcnt lgkmcnt(11)
    v_mfma_f32_32x32x16_bf16 v[104:119], v[44:47], a[88:91], v[104:119]
    ds_read_b128 v[20:23], v4 offset:1024
    s_add_u32 s25, s26, 32768
    buffer_load_dwordx4 a[128:131], v3, s[8:11], s25 offen offset:0 sc1
    s_waitcnt lgkmcnt(11)
    v_mfma_f32_32x32x16_bf16 v[120:135], v[48:51], a[88:91], v[120:135]
    ds_read_b128 v[24:27], v4 offset:2048
    s_waitcnt lgkmcnt(11)
    v_mfma_f32_32x32x16_bf16 v[136:151], v[52:55], a[88:91], v[136:151]
    ds_read_b128 v[28:31], v4 offset:3072
    buffer_load_dwordx4 a[132:135], v3, s[8:11], s25 offen offset:1024 sc1
    s_waitcnt lgkmcnt(11)
    v_mfma_f32_32x32x16_bf16 v[152:167], v[56:59], a[88:91], v[152:167]
    ds_read_b128 v[32:35], v4 offset:4096
    s_waitcnt lgkmcnt(11)
    v_mfma_f32_32x32x16_bf16 v[168:183], v[60:63], a[88:91], v[168:183]
    ds_read_b128 v[36:39], v4 offset:5120
    buffer_load_dwordx4 a[136:139], v3, s[8:11], s25 offen offset:2048 sc1
    s_waitcnt vmcnt(29)
    s_waitcnt lgkmcnt(11)
    v_mfma_f32_32x32x16_bf16 v[88:103], v[64:67], a[92:95], v[88:103]
    ds_read_b128 v[40:43], v4 offset:6144
    s_waitcnt lgkmcnt(11)
    v_mfma_f32_32x32x16_bf16 v[104:119], v[68:71], a[92:95], v[104:119]
    ds_read_b128 v[44:47], v4 offset:7168
    buffer_load_dwordx4 a[140:143], v3, s[8:11], s25 offen offset:3072 sc1
    s_waitcnt lgkmcnt(11)
    v_mfma_f32_32x32x16_bf16 v[120:135], v[72:75], a[92:95], v[120:135]
    ds_read_b128 v[48:51], v4 offset:8192
    s_waitcnt lgkmcnt(11)
    v_mfma_f32_32x32x16_bf16 v[136:151], v[76:79], a[92:95], v[136:151]
    ds_read_b128 v[52:55], v4 offset:9216
    s_add_u32 m0, s30, 73728
    s_add_u32 s24, s27, 221184
    buffer_load_dwordx4 v3, s[8:11], s24 offen offset:0 lds
    s_waitcnt lgkmcnt(11)
    v_mfma_f32_32x32x16_bf16 v[152:167], v[80:83], a[92:95], v[152:167]
    ds_read_b128 v[56:59], v4 offset:10240
    s_waitcnt lgkmcnt(11)
    v_mfma_f32_32x32x16_bf16 v[168:183], v[84:87], a[92:95], v[168:183]
    ds_read_b128 v[60:63], v4 offset:11264
    buffer_load_dwordx4 v3, s[8:11], s24 offen offset:1024 lds
    s_waitcnt vmcnt(25)
    s_waitcnt lgkmcnt(11)
    v_mfma_f32_32x32x16_bf16 v[88:103], v[16:19], a[96:99], v[88:103]
    ds_read_b128 v[64:67], v4 offset:12288
    s_waitcnt lgkmcnt(11)
    v_mfma_f32_32x32x16_bf16 v[104:119], v[20:23], a[96:99], v[104:119]
    ds_read_b128 v[68:71], v4 offset:13312
    buffer_load_dwordx4 v3, s[8:11], s24 offen offset:2048 lds
    s_waitcnt lgkmcnt(11)
    v_mfma_f32_32x32x16_bf16 v[120:135], v[24:27], a[96:99], v[120:135]
    ds_read_b128 v[72:75], v4 offset:14336
    s_waitcnt lgkmcnt(11)
    v_mfma_f32_32x32x16_bf16 v[136:151], v[28:31], a[96:99], v[136:151]
    ds_read_b128 v[76:79], v4 offset:15360
    buffer_load_dwordx4 v3, s[8:11], s24 offen offset:3072 lds
    s_waitcnt lgkmcnt(11)
    v_mfma_f32_32x32x16_bf16 v[152:167], v[32:35], a[96:99], v[152:167]
    ds_read_b128 v[80:83], v4 offset:16384
    s_waitcnt lgkmcnt(11)
    v_mfma_f32_32x32x16_bf16 v[168:183], v[36:39], a[96:99], v[168:183]
    ds_read_b128 v[84:87], v4 offset:17408
    s_add_u32 m0, s30, 77824
    s_add_u32 s24, s24, 4096
    buffer_load_dwordx4 v3, s[8:11], s24 offen offset:0 lds
    s_waitcnt vmcnt(27)
    s_waitcnt lgkmcnt(11)
    v_mfma_f32_32x32x16_bf16 v[88:103], v[40:43], a[100:103], v[88:103]
    ds_read_b128 v[16:19], v4 offset:18432
    s_waitcnt lgkmcnt(11)
    v_mfma_f32_32x32x16_bf16 v[104:119], v[44:47], a[100:103], v[104:119]
    ds_read_b128 v[20:23], v4 offset:19456
    buffer_load_dwordx4 v3, s[8:11], s24 offen offset:1024 lds
    s_waitcnt lgkmcnt(11)
    v_mfma_f32_32x32x16_bf16 v[120:135], v[48:51], a[100:103], v[120:135]
    ds_read_b128 v[24:27], v4 offset:20480
    s_waitcnt lgkmcnt(11)
    v_mfma_f32_32x32x16_bf16 v[136:151], v[52:55], a[100:103], v[136:151]
    ds_read_b128 v[28:31], v4 offset:21504
    s_add_u32 s25, s26, 36864
    buffer_load_dwordx4 a[144:147], v3, s[8:11], s25 offen offset:0 sc1
    s_waitcnt lgkmcnt(11)
    v_mfma_f32_32x32x16_bf16 v[152:167], v[56:59], a[100:103], v[152:167]
    ds_read_b128 v[32:35], v4 offset:22528
    s_waitcnt lgkmcnt(11)
    v_mfma_f32_32x32x16_bf16 v[168:183], v[60:63], a[100:103], v[168:183]
    ds_read_b128 v[36:39], v4 offset:23552
    buffer_load_dwordx4 a[148:151], v3, s[8:11], s25 offen offset:1024 sc1
    s_waitcnt vmcnt(22)
    s_barrier
    s_waitcnt vmcnt(29)
    s_waitcnt lgkmcnt(11)
    v_mfma_f32_32x32x16_bf16 v[88:103], v[64:67], a[104:107], v[88:103]
    ds_read_b128 v[40:43], v4 offset:24576
    s_waitcnt lgkmcnt(11)
    v_mfma_f32_32x32x16_bf16 v[104:119], v[68:71], a[104:107], v[104:119]
    ds_read_b128 v[44:47], v4 offset:25600
    buffer_load_dwordx4 a[152:155], v3, s[8:11], s25 offen offset:2048 sc1
    s_waitcnt lgkmcnt(11)
    v_mfma_f32_32x32x16_bf16 v[120:135], v[72:75], a[104:107], v[120:135]
    ds_read_b128 v[48:51], v4 offset:26624
    s_waitcnt lgkmcnt(11)
    v_mfma_f32_32x32x16_bf16 v[136:151], v[76:79], a[104:107], v[136:151]
    ds_read_b128 v[52:55], v4 offset:27648
    buffer_load_dwordx4 a[156:159], v3, s[8:11], s25 offen offset:3072 sc1
    s_waitcnt lgkmcnt(11)
    v_mfma_f32_32x32x16_bf16 v[152:167], v[80:83], a[104:107], v[152:167]
    ds_read_b128 v[56:59], v4 offset:28672
    s_waitcnt lgkmcnt(11)
    v_mfma_f32_32x32x16_bf16 v[168:183], v[84:87], a[104:107], v[168:183]
    ds_read_b128 v[60:63], v4 offset:29696
    s_waitcnt vmcnt(30)
    s_waitcnt lgkmcnt(11)
    v_mfma_f32_32x32x16_bf16 v[88:103], v[16:19], a[108:111], v[88:103]
    ds_read_b128 v[64:67], v4 offset:30720
    s_waitcnt lgkmcnt(11)
    v_mfma_f32_32x32x16_bf16 v[104:119], v[20:23], a[108:111], v[104:119]
    ds_read_b128 v[68:71], v4 offset:31744
    s_waitcnt lgkmcnt(11)
    v_mfma_f32_32x32x16_bf16 v[120:135], v[24:27], a[108:111], v[120:135]
    ds_read_b128 v[72:75], v4 offset:32768
    s_waitcnt lgkmcnt(11)
    v_mfma_f32_32x32x16_bf16 v[136:151], v[28:31], a[108:111], v[136:151]
    ds_read_b128 v[76:79], v4 offset:33792
    s_waitcnt lgkmcnt(11)
    v_mfma_f32_32x32x16_bf16 v[152:167], v[32:35], a[108:111], v[152:167]
    ds_read_b128 v[80:83], v4 offset:34816
    s_waitcnt lgkmcnt(11)
    v_mfma_f32_32x32x16_bf16 v[168:183], v[36:39], a[108:111], v[168:183]
    ds_read_b128 v[84:87], v4 offset:35840
    s_waitcnt vmcnt(23)
    s_waitcnt lgkmcnt(11)
    v_mfma_f32_32x32x16_bf16 v[88:103], v[40:43], a[112:115], v[88:103]
    ds_read_b128 v[16:19], v4 offset:36864
    s_waitcnt lgkmcnt(11)
    v_mfma_f32_32x32x16_bf16 v[104:119], v[44:47], a[112:115], v[104:119]
    ds_read_b128 v[20:23], v4 offset:37888
    s_waitcnt lgkmcnt(11)
    v_mfma_f32_32x32x16_bf16 v[120:135], v[48:51], a[112:115], v[120:135]
    ds_read_b128 v[24:27], v4 offset:38912
    s_waitcnt lgkmcnt(11)
    v_mfma_f32_32x32x16_bf16 v[136:151], v[52:55], a[112:115], v[136:151]
    ds_read_b128 v[28:31], v4 offset:39936
    s_waitcnt lgkmcnt(11)
    v_mfma_f32_32x32x16_bf16 v[152:167], v[56:59], a[112:115], v[152:167]
    ds_read_b128 v[32:35], v4 offset:40960
    s_waitcnt lgkmcnt(11)
    v_mfma_f32_32x32x16_bf16 v[168:183], v[60:63], a[112:115], v[168:183]
    ds_read_b128 v[36:39], v4 offset:41984
    s_waitcnt vmcnt(22)
    s_waitcnt lgkmcnt(11)
    v_mfma_f32_32x32x16_bf16 v[88:103], v[64:67], a[116:119], v[88:103]
    ds_read_b128 v[40:43], v4 offset:43008
    s_waitcnt lgkmcnt(11)
    v_mfma_f32_32x32x16_bf16 v[104:119], v[68:71], a[116:119], v[104:119]
    ds_read_b128 v[44:47], v4 offset:44032
    s_waitcnt lgkmcnt(11)
    v_mfma_f32_32x32x16_bf16 v[120:135], v[72:75], a[116:119], v[120:135]
    ds_read_b128 v[48:51], v4 offset:45056
    s_waitcnt lgkmcnt(11)
    v_mfma_f32_32x32x16_bf16 v[136:151], v[76:79], a[116:119], v[136:151]
    ds_read_b128 v[52:55], v4 offset:46080
    s_waitcnt lgkmcnt(11)
    v_mfma_f32_32x32x16_bf16 v[152:167], v[80:83], a[116:119], v[152:167]
    ds_read_b128 v[56:59], v4 offset:47104
    s_waitcnt lgkmcnt(11)
    v_mfma_f32_32x32x16_bf16 v[168:183], v[84:87], a[116:119], v[168:183]
    ds_read_b128 v[60:63], v4 offset:48128
    s_waitcnt vmcnt(14)
    s_barrier
    s_waitcnt vmcnt(21)
    s_waitcnt lgkmcnt(11)
    v_mfma_f32_32x32x16_bf16 v[88:103], v[16:19], a[120:123], v[88:103]
    ds_read_b128 v[64:67], v4 offset:49152
    s_waitcnt lgkmcnt(11)
    v_mfma_f32_32x32x16_bf16 v[104:119], v[20:23], a[120:123], v[104:119]
    ds_read_b128 v[68:71], v4 offset:50176
    s_waitcnt lgkmcnt(11)
    v_mfma_f32_32x32x16_bf16 v[120:135], v[24:27], a[120:123], v[120:135]
    ds_read_b128 v[72:75], v4 offset:51200
    s_waitcnt lgkmcnt(11)
    v_mfma_f32_32x32x16_bf16 v[136:151], v[28:31], a[120:123], v[136:151]
    ds_read_b128 v[76:79], v4 offset:52224
    s_waitcnt lgkmcnt(11)
    v_mfma_f32_32x32x16_bf16 v[152:167], v[32:35], a[120:123], v[152:167]
    ds_read_b128 v[80:83], v4 offset:53248
    s_waitcnt lgkmcnt(11)
    v_mfma_f32_32x32x16_bf16 v[168:183], v[36:39], a[120:123], v[168:183]
    ds_read_b128 v[84:87], v4 offset:54272
    s_waitcnt vmcnt(20)
    s_waitcnt lgkmcnt(11)
    v_mfma_f32_32x32x16_bf16 v[88:103], v[40:43], a[124:127], v[88:103]
    ds_read_b128 v[16:19], v4 offset:55296
    s_waitcnt lgkmcnt(11)
    v_mfma_f32_32x32x16_bf16 v[104:119], v[44:47], a[124:127], v[104:119]
    ds_read_b128 v[20:23], v4 offset:56320
    s_waitcnt lgkmcnt(11)
    v_mfma_f32_32x32x16_bf16 v[120:135], v[48:51], a[124:127], v[120:135]
    ds_read_b128 v[24:27], v4 offset:57344
    s_waitcnt lgkmcnt(11)
    v_mfma_f32_32x32x16_bf16 v[136:151], v[52:55], a[124:127], v[136:151]
    ds_read_b128 v[28:31], v4 offset:58368
    s_waitcnt lgkmcnt(11)
    v_mfma_f32_32x32x16_bf16 v[152:167], v[56:59], a[124:127], v[152:167]
    ds_read_b128 v[32:35], v4 offset:59392
    s_waitcnt lgkmcnt(11)
    v_mfma_f32_32x32x16_bf16 v[168:183], v[60:63], a[124:127], v[168:183]
    ds_read_b128 v[36:39], v4 offset:60416
    s_waitcnt vmcnt(13)
    s_waitcnt lgkmcnt(11)
    v_mfma_f32_32x32x16_bf16 v[88:103], v[64:67], a[128:131], v[88:103]
    ds_read_b128 v[40:43], v4 offset:61440
    s_waitcnt lgkmcnt(11)
    v_mfma_f32_32x32x16_bf16 v[104:119], v[68:71], a[128:131], v[104:119]
    ds_read_b128 v[44:47], v4 offset:62464
    s_waitcnt lgkmcnt(11)
    v_mfma_f32_32x32x16_bf16 v[120:135], v[72:75], a[128:131], v[120:135]
    ds_read_b128 v[48:51], v4 offset:63488
    s_waitcnt lgkmcnt(11)
    v_mfma_f32_32x32x16_bf16 v[136:151], v[76:79], a[128:131], v[136:151]
    ds_read_b128 v[52:55], v4 offset:64512
    s_waitcnt lgkmcnt(11)
    v_mfma_f32_32x32x16_bf16 v[152:167], v[80:83], a[128:131], v[152:167]
    ds_read_b128 v[56:59], v5 offset:0
    s_waitcnt lgkmcnt(11)
    v_mfma_f32_32x32x16_bf16 v[168:183], v[84:87], a[128:131], v[168:183]
    ds_read_b128 v[60:63], v5 offset:1024
    s_waitcnt vmcnt(12)
    s_waitcnt lgkmcnt(11)
    v_mfma_f32_32x32x16_bf16 v[88:103], v[16:19], a[132:135], v[88:103]
    ds_read_b128 v[64:67], v5 offset:2048
    s_waitcnt lgkmcnt(11)
    v_mfma_f32_32x32x16_bf16 v[104:119], v[20:23], a[132:135], v[104:119]
    ds_read_b128 v[68:71], v5 offset:3072
    s_waitcnt lgkmcnt(11)
    v_mfma_f32_32x32x16_bf16 v[120:135], v[24:27], a[132:135], v[120:135]
    ds_read_b128 v[72:75], v5 offset:4096
    s_waitcnt lgkmcnt(11)
    v_mfma_f32_32x32x16_bf16 v[136:151], v[28:31], a[132:135], v[136:151]
    ds_read_b128 v[76:79], v5 offset:5120
    s_waitcnt lgkmcnt(11)
    v_mfma_f32_32x32x16_bf16 v[152:167], v[32:35], a[132:135], v[152:167]
    ds_read_b128 v[80:83], v5 offset:6144
    s_waitcnt lgkmcnt(11)
    v_mfma_f32_32x32x16_bf16 v[168:183], v[36:39], a[132:135], v[168:183]
    ds_read_b128 v[84:87], v5 offset:7168
    s_waitcnt vmcnt(4)
    s_barrier
    s_waitcnt vmcnt(11)
    s_waitcnt lgkmcnt(11)
    v_mfma_f32_32x32x16_bf16 v[88:103], v[40:43], a[136:139], v[88:103]
    ds_read_b128 v[16:19], v5 offset:8192
    s_waitcnt lgkmcnt(11)
    v_mfma_f32_32x32x16_bf16 v[104:119], v[44:47], a[136:139], v[104:119]
    ds_read_b128 v[20:23], v5 offset:9216
    s_waitcnt lgkmcnt(11)
    v_mfma_f32_32x32x16_bf16 v[120:135], v[48:51], a[136:139], v[120:135]
    ds_read_b128 v[24:27], v5 offset:10240
    s_waitcnt lgkmcnt(11)
    v_mfma_f32_32x32x16_bf16 v[136:151], v[52:55], a[136:139], v[136:151]
    ds_read_b128 v[28:31], v5 offset:11264
    s_waitcnt lgkmcnt(11)
    v_mfma_f32_32x32x16_bf16 v[152:167], v[56:59], a[136:139], v[152:167]
    ds_read_b128 v[32:35], v5 offset:12288
    s_waitcnt lgkmcnt(11)
    v_mfma_f32_32x32x16_bf16 v[168:183], v[60:63], a[136:139], v[168:183]
    ds_read_b128 v[36:39], v5 offset:13312
    s_waitcnt vmcnt(10)
    s_waitcnt lgkmcnt(11)
    v_mfma_f32_32x32x16_bf16 v[88:103], v[64:67], a[140:143], v[88:103]
    ds_read_b128 v[40:43], v5 offset:14336
    s_waitcnt lgkmcnt(11)
    v_mfma_f32_32x32x16_bf16 v[104:119], v[68:71], a[140:143], v[104:119]
    ds_read_b128 v[44:47], v5 offset:15360
    s_waitcnt lgkmcnt(11)
    v_mfma_f32_32x32x16_bf16 v[120:135], v[72:75], a[140:143], v[120:135]
    ds_read_b128 v[48:51], v5 offset:16384
    s_waitcnt lgkmcnt(11)
    v_mfma_f32_32x32x16_bf16 v[136:151], v[76:79], a[140:143], v[136:151]
    ds_read_b128 v[52:55], v5 offset:17408
    s_waitcnt lgkmcnt(11)
    v_mfma_f32_32x32x16_bf16 v[152:167], v[80:83], a[140:143], v[152:167]
    ds_read_b128 v[56:59], v5 offset:18432
    s_waitcnt lgkmcnt(11)
    v_mfma_f32_32x32x16_bf16 v[168:183], v[84:87], a[140:143], v[168:183]
    ds_read_b128 v[60:63], v5 offset:19456
    s_waitcnt vmcnt(3)
    s_waitcnt lgkmcnt(11)
    v_mfma_f32_32x32x16_bf16 v[88:103], v[16:19], a[144:147], v[88:103]
    ds_read_b128 v[64:67], v5 offset:20480
    s_waitcnt lgkmcnt(11)
    v_mfma_f32_32x32x16_bf16 v[104:119], v[20:23], a[144:147], v[104:119]
    ds_read_b128 v[68:71], v5 offset:21504
    s_waitcnt lgkmcnt(11)
    v_mfma_f32_32x32x16_bf16 v[120:135], v[24:27], a[144:147], v[120:135]
    ds_read_b128 v[72:75], v5 offset:22528
    s_waitcnt lgkmcnt(11)
    v_mfma_f32_32x32x16_bf16 v[136:151], v[28:31], a[144:147], v[136:151]
    ds_read_b128 v[76:79], v5 offset:23552
    s_waitcnt lgkmcnt(11)
    v_mfma_f32_32x32x16_bf16 v[152:167], v[32:35], a[144:147], v[152:167]
    ds_read_b128 v[80:83], v5 offset:24576
    s_waitcnt lgkmcnt(11)
    v_mfma_f32_32x32x16_bf16 v[168:183], v[36:39], a[144:147], v[168:183]
    ds_read_b128 v[84:87], v5 offset:25600
    s_waitcnt vmcnt(2)
    s_waitcnt lgkmcnt(11)
    v_mfma_f32_32x32x16_bf16 v[88:103], v[40:43], a[148:151], v[88:103]
    ds_read_b128 v[16:19], v5 offset:26624
    s_waitcnt lgkmcnt(11)
    v_mfma_f32_32x32x16_bf16 v[104:119], v[44:47], a[148:151], v[104:119]
    ds_read_b128 v[20:23], v5 offset:27648
    s_waitcnt lgkmcnt(11)
    v_mfma_f32_32x32x16_bf16 v[120:135], v[48:51], a[148:151], v[120:135]
    ds_read_b128 v[24:27], v5 offset:28672
    s_waitcnt lgkmcnt(11)
    v_mfma_f32_32x32x16_bf16 v[136:151], v[52:55], a[148:151], v[136:151]
    ds_read_b128 v[28:31], v5 offset:29696
    s_waitcnt lgkmcnt(11)
    v_mfma_f32_32x32x16_bf16 v[152:167], v[56:59], a[148:151], v[152:167]
    ds_read_b128 v[32:35], v5 offset:30720
    s_waitcnt lgkmcnt(11)
    v_mfma_f32_32x32x16_bf16 v[168:183], v[60:63], a[148:151], v[168:183]
    ds_read_b128 v[36:39], v5 offset:31744
    s_waitcnt vmcnt(1)
    s_waitcnt lgkmcnt(11)
    v_mfma_f32_32x32x16_bf16 v[88:103], v[64:67], a[152:155], v[88:103]
    s_waitcnt lgkmcnt(10)
    v_mfma_f32_32x32x16_bf16 v[104:119], v[68:71], a[152:155], v[104:119]
    s_waitcnt lgkmcnt(9)
    v_mfma_f32_32x32x16_bf16 v[120:135], v[72:75], a[152:155], v[120:135]
    s_waitcnt lgkmcnt(8)
    v_mfma_f32_32x32x16_bf16 v[136:151], v[76:79], a[152:155], v[136:151]
    s_waitcnt lgkmcnt(7)
    v_mfma_f32_32x32x16_bf16 v[152:167], v[80:83], a[152:155], v[152:167]
    s_waitcnt lgkmcnt(6)
    v_mfma_f32_32x32x16_bf16 v[168:183], v[84:87], a[152:155], v[168:183]
    s_waitcnt vmcnt(0)
    s_waitcnt lgkmcnt(5)
    v_mfma_f32_32x32x16_bf16 v[88:103], v[16:19], a[156:159], v[88:103]
    s_waitcnt lgkmcnt(4)
    v_mfma_f32_32x32x16_bf16 v[104:119], v[20:23], a[156:159], v[104:119]
    s_waitcnt lgkmcnt(3)
    v_mfma_f32_32x32x16_bf16 v[120:135], v[24:27], a[156:159], v[120:135]
    s_waitcnt lgkmcnt(2)
    v_mfma_f32_32x32x16_bf16 v[136:151], v[28:31], a[156:159], v[136:151]
    s_waitcnt lgkmcnt(1)
    v_mfma_f32_32x32x16_bf16 v[152:167], v[32:35], a[156:159], v[152:167]
    s_waitcnt lgkmcnt(0)
    v_mfma_f32_32x32x16_bf16 v[168:183], v[36:39], a[156:159], v[168:183]
    s_cmp_eq_u32 s14, 0
    s_cbranch_scc1 ST_S_96
    s_nop 5
    v_pk_mul_f32 v[88:89], v[88:89], v[136:137]
    v_pk_mul_f32 v[90:91], v[90:91], v[138:139]
    v_cvt_pk_bf16_f32 v16, v88, v89
    v_cvt_pk_bf16_f32 v17, v90, v91
    v_pk_mul_f32 v[92:93], v[92:93], v[140:141]
    v_pk_mul_f32 v[94:95], v[94:95], v[142:143]
    v_cvt_pk_bf16_f32 v18, v92, v93
    v_cvt_pk_bf16_f32 v19, v94, v95
    buffer_store_dwordx4 v[16:19], v3, s[8:11], s31 offen offset:0
    v_pk_mul_f32 v[96:97], v[96:97], v[144:145]
    v_pk_mul_f32 v[98:99], v[98:99], v[146:147]
    v_cvt_pk_bf16_f32 v20, v96, v97
    v_cvt_pk_bf16_f32 v21, v98, v99
    v_pk_mul_f32 v[100:101], v[100:101], v[148:149]
    v_pk_mul_f32 v[102:103], v[102:103], v[150:151]
    v_cvt_pk_bf16_f32 v22, v100, v101
    v_cvt_pk_bf16_f32 v23, v102, v103
    buffer_store_dwordx4 v[20:23], v3, s[8:11], s31 offen offset:1024
    v_pk_mul_f32 v[104:105], v[104:105], v[152:153]
    v_pk_mul_f32 v[106:107], v[106:107], v[154:155]
    v_cvt_pk_bf16_f32 v24, v104, v105
    v_cvt_pk_bf16_f32 v25, v106, v107
    v_pk_mul_f32 v[108:109], v[108:109], v[156:157]
    v_pk_mul_f32 v[110:111], v[110:111], v[158:159]
    v_cvt_pk_bf16_f32 v26, v108, v109
    v_cvt_pk_bf16_f32 v27, v110, v111
    buffer_store_dwordx4 v[24:27], v3, s[8:11], s31 offen offset:2048
    v_pk_mul_f32 v[112:113], v[112:113], v[160:161]
    v_pk_mul_f32 v[114:115], v[114:115], v[162:163]
    v_cvt_pk_bf16_f32 v28, v112, v113
    v_cvt_pk_bf16_f32 v29, v114, v115
    v_pk_mul_f32 v[116:117], v[116:117], v[164:165]
    v_pk_mul_f32 v[118:119], v[118:119], v[166:167]
    v_cvt_pk_bf16_f32 v30, v116, v117
    v_cvt_pk_bf16_f32 v31, v118, v119
    buffer_store_dwordx4 v[28:31], v3, s[8:11], s31 offen offset:3072
    v_pk_mul_f32 v[120:121], v[120:121], v[168:169]
    v_pk_mul_f32 v[122:123], v[122:123], v[170:171]
    v_cvt_pk_bf16_f32 v32, v120, v121
    v_cvt_pk_bf16_f32 v33, v122, v123
    v_pk_mul_f32 v[124:125], v[124:125], v[172:173]
    v_pk_mul_f32 v[126:127], v[126:127], v[174:175]
    v_cvt_pk_bf16_f32 v34, v124, v125
    v_cvt_pk_bf16_f32 v35, v126, v127
    buffer_store_dwordx4 v[32:35], v3, s[8:11], s32 offen offset:0
    v_pk_mul_f32 v[128:129], v[128:129], v[176:177]
    v_pk_mul_f32 v[130:131], v[130:131], v[178:179]
    v_cvt_pk_bf16_f32 v36, v128, v129
    v_cvt_pk_bf16_f32 v37, v130, v131
    v_pk_mul_f32 v[132:133], v[132:133], v[180:181]
    v_pk_mul_f32 v[134:135], v[134:135], v[182:183]
    v_cvt_pk_bf16_f32 v38, v132, v133
    v_cvt_pk_bf16_f32 v39, v134, v135
    buffer_store_dwordx4 v[36:39], v3, s[8:11], s32 offen offset:1024
    s_branch ST_E_97
ST_S_96:
    s_nop 5
    v_pk_mul_f32 v[88:89], v[88:89], v[136:137]
    v_pk_mul_f32 v[90:91], v[90:91], v[138:139]
    v_cvt_pk_bf16_f32 v16, v88, v89
    v_cvt_pk_bf16_f32 v17, v90, v91
    v_pk_mul_f32 v[92:93], v[92:93], v[140:141]
    v_pk_mul_f32 v[94:95], v[94:95], v[142:143]
    v_cvt_pk_bf16_f32 v18, v92, v93
    v_cvt_pk_bf16_f32 v19, v94, v95
    buffer_store_dwordx4 v[16:19], v3, s[8:11], s31 offen offset:0 sc1
    v_pk_mul_f32 v[96:97], v[96:97], v[144:145]
    v_pk_mul_f32 v[98:99], v[98:99], v[146:147]
    v_cvt_pk_bf16_f32 v20, v96, v97
    v_cvt_pk_bf16_f32 v21, v98, v99
    v_pk_mul_f32 v[100:101], v[100:101], v[148:149]
    v_pk_mul_f32 v[102:103], v[102:103], v[150:151]
    v_cvt_pk_bf16_f32 v22, v100, v101
    v_cvt_pk_bf16_f32 v23, v102, v103
    buffer_store_dwordx4 v[20:23], v3, s[8:11], s31 offen offset:1024 sc1
    v_pk_mul_f32 v[104:105], v[104:105], v[152:153]
    v_pk_mul_f32 v[106:107], v[106:107], v[154:155]
    v_cvt_pk_bf16_f32 v24, v104, v105
    v_cvt_pk_bf16_f32 v25, v106, v107
    v_pk_mul_f32 v[108:109], v[108:109], v[156:157]
    v_pk_mul_f32 v[110:111], v[110:111], v[158:159]
    v_cvt_pk_bf16_f32 v26, v108, v109
    v_cvt_pk_bf16_f32 v27, v110, v111
    buffer_store_dwordx4 v[24:27], v3, s[8:11], s31 offen offset:2048 sc1
    v_pk_mul_f32 v[112:113], v[112:113], v[160:161]
    v_pk_mul_f32 v[114:115], v[114:115], v[162:163]
    v_cvt_pk_bf16_f32 v28, v112, v113
    v_cvt_pk_bf16_f32 v29, v114, v115
    v_pk_mul_f32 v[116:117], v[116:117], v[164:165]
    v_pk_mul_f32 v[118:119], v[118:119], v[166:167]
    v_cvt_pk_bf16_f32 v30, v116, v117
    v_cvt_pk_bf16_f32 v31, v118, v119
    buffer_store_dwordx4 v[28:31], v3, s[8:11], s31 offen offset:3072 sc1
    v_pk_mul_f32 v[120:121], v[120:121], v[168:169]
    v_pk_mul_f32 v[122:123], v[122:123], v[170:171]
    v_cvt_pk_bf16_f32 v32, v120, v121
    v_cvt_pk_bf16_f32 v33, v122, v123
    v_pk_mul_f32 v[124:125], v[124:125], v[172:173]
    v_pk_mul_f32 v[126:127], v[126:127], v[174:175]
    v_cvt_pk_bf16_f32 v34, v124, v125
    v_cvt_pk_bf16_f32 v35, v126, v127
    buffer_store_dwordx4 v[32:35], v3, s[8:11], s32 offen offset:0 sc1
    v_pk_mul_f32 v[128:129], v[128:129], v[176:177]
    v_pk_mul_f32 v[130:131], v[130:131], v[178:179]
    v_cvt_pk_bf16_f32 v36, v128, v129
    v_cvt_pk_bf16_f32 v37, v130, v131
    v_pk_mul_f32 v[132:133], v[132:133], v[180:181]
    v_pk_mul_f32 v[134:135], v[134:135], v[182:183]
    v_cvt_pk_bf16_f32 v38, v132, v133
    v_cvt_pk_bf16_f32 v39, v134, v135
    buffer_store_dwordx4 v[36:39], v3, s[8:11], s32 offen offset:1024 sc1
ST_E_97:
    s_lshl_b32 s19, s12, 7
    s_add_u32 s19, s19, 529408
    s_lshl_b32 s20, s13, 2
    s_add_u32 s20, s20, s19
    v_mov_b32 v250, s20
    v_and_b32 v251, 31, v2
    v_lshlrev_b32 v251, 2, v251
    v_add_u32 v251, s19, v251
    v_mov_b32 v249, 1
    s_and_b32 s26, s3, 1
    s_lshr_b32 s27, s3, 1
    s_lshr_b32 s15, s13, 2
    s_lshl_b32 s29, s12, 3
    s_and_b32 s19, s13, 3
    s_lshl_b32 s19, s19, 1
    s_add_u32 s29, s29, s19
    s_add_u32 s29, s29, s26
    s_mov_b32 s36, s6
    s_mov_b32 s37, s7
    s_mov_b32 s38, 2621440
    s_mov_b32 s39, 131072
    s_mul_i32 s28, s15, 5
    s_mul_i32 s19, s27, 3
    s_add_u32 s28, s28, s19
    s_mul_i32 s31, s29, 40
    s_add_u32 s31, s31, s28
    s_lshl_b32 s31, s31, 10
    v_lshrrev_b32 v7, 5, v2
    v_lshlrev_b32 v7, 4, v7
    s_lshl_b32 s32, s28, 5
    s_lshl_b32 s19, s12, 13
    s_add_u32 s19, s19, s32
    s_add_u32 s19, s19, 465152
    s_mov_b32 s42, s19
    s_mov_b32 s35, s12
    s_and_b32 s22, s29, 7
    s_mul_i32 s22, s22, 96
    s_mul_i32 s19, s27, 48
    s_add_u32 s22, s22, s19
    s_lshl_b32 s22, s22, 10
    s_add_u32 s19, s12, 7
    s_and_b32 s19, s19, 7
    s_mul_i32 s19, s19, 786432
    s_add_u32 s22, s22, s19
    s_add_u32 s22, s22, 8388608
    s_mul_i32 s23, s15, 48
    s_mul_i32 s19, s27, 24
    s_add_u32 s23, s23, s19
    s_add_u32 s23, s23, s26
    s_mul_i32 s23, s23, 5120
    s_add_u32 s23, s23, 50331648
    s_mul_i32 s30, s27, 61440
    s_mul_i32 s19, s26, 5120
    s_add_u32 s30, s30, s19
    s_mul_i32 s19, s27, 61440
    v_add_u32 v4, s19, v3
    v_lshrrev_b32 v5, 5, v2
    v_lshlrev_b32 v5, 8, v5
    v_and_b32 v6, 15, v2
    v_lshl_add_u32 v5, v6, 4, v5
    v_add_u32 v5, s19, v5
    v_add_u32 v5, 4096, v5
    s_waitcnt vmcnt(0)
    s_barrier
    s_cmp_lg_u32 s3, 0
    s_cbranch_scc1 GBD_99
    s_mov_b64 exec, 1
    s_cmp_eq_u32 s14, 0
    s_cbranch_scc1 ST_S_100
    global_store_dword v250, v249, s[4:5]
    s_branch ST_E_101
ST_S_100:
    global_store_dword v250, v249, s[4:5] sc1
ST_E_101:
    s_mov_b64 exec, -1
    s_mov_b32 s18, 2000000
    global_load_dword v252, v251, s[4:5] sc1
    s_nop 7
    global_load_dword v253, v251, s[4:5] sc1
    s_nop 7
POLL_102:
    global_load_dword v254, v251, s[4:5] sc1
    s_waitcnt vmcnt(2)
    v_cmp_eq_u32 vcc, 0, v252
    s_cbranch_vccz POLLX_103
    global_load_dword v252, v251, s[4:5] sc1
    s_waitcnt vmcnt(2)
    v_cmp_eq_u32 vcc, 0, v253
    s_cbranch_vccz POLLX_103
    global_load_dword v253, v251, s[4:5] sc1
    s_waitcnt vmcnt(2)
    v_cmp_eq_u32 vcc, 0, v254
    s_cbranch_vccz POLLX_103
    s_sub_u32 s18, s18, 1
    s_cmp_lg_u32 s18, 0
    s_cbranch_scc1 POLL_102
POLLX_103:
    s_branch GB_98
GBD_99:
    s_sub_u32 s19, s3, 1
    s_mul_i32 s19, s19, 20
    s_add_u32 s20, s19, 0
    s_cmp_ge_u32 s20, 30
    s_cselect_b32 s21, 1, 0
    s_mul_i32 s25, s21, 30
    s_sub_u32 s20, s20, s25
    s_lshl_b32 s20, s20, 10
    s_mul_i32 s25, s21, 122880
    s_add_u32 s25, s25, s20
    s_add_u32 s25, s25, s34
    s_mul_i32 s21, s21, 61440
    s_add_u32 s21, s21, s20
    s_add_u32 m0, s21, 0
    s_nop 0
    buffer_load_dwordx4 v3, s[8:11], s25 offen offset:0 lds
    buffer_load_dwordx4 v3, s[8:11], s25 offen offset:1024 lds
    buffer_load_dwordx4 v3, s[8:11], s25 offen offset:2048 lds
    buffer_load_dwordx4 v3, s[8:11], s25 offen offset:3072 lds
    s_add_u32 m0, s21, 4096
    s_add_u32 s25, s25, 4096
    buffer_load_dwordx4 v3, s[8:11], s25 offen offset:0 lds
    buffer_load_dwordx4 v3, s[8:11], s25 offen offset:1024 lds
    buffer_load_dwordx4 v3, s[8:11], s25 offen offset:2048 lds
    buffer_load_dwordx4 v3, s[8:11], s25 offen offset:3072 lds
    s_add_u32 m0, s21, 8192
    s_add_u32 s25, s25, 4096
    buffer_load_dwordx4 v3, s[8:11], s25 offen offset:0 lds
    buffer_load_dwordx4 v3, s[8:11], s25 offen offset:1024 lds
    s_add_u32 s20, s19, 10
    s_cmp_ge_u32 s20, 30
    s_cselect_b32 s21, 1, 0
    s_mul_i32 s25, s21, 30
    s_sub_u32 s20, s20, s25
    s_lshl_b32 s20, s20, 10
    s_mul_i32 s25, s21, 122880
    s_add_u32 s25, s25, s20
    s_add_u32 s25, s25, s34
    s_mul_i32 s21, s21, 61440
    s_add_u32 s21, s21, s20
    s_add_u32 m0, s21, 0
    s_nop 0
    buffer_load_dwordx4 v3, s[8:11], s25 offen offset:0 lds
    buffer_load_dwordx4 v3, s[8:11], s25 offen offset:1024 lds
    buffer_load_dwordx4 v3, s[8:11], s25 offen offset:2048 lds
    buffer_load_dwordx4 v3, s[8:11], s25 offen offset:3072 lds
    s_add_u32 m0, s21, 4096
    s_add_u32 s25, s25, 4096
    buffer_load_dwordx4 v3, s[8:11], s25 offen offset:0 lds
    buffer_load_dwordx4 v3, s[8:11], s25 offen offset:1024 lds
    buffer_load_dwordx4 v3, s[8:11], s25 offen offset:2048 lds
    buffer_load_dwordx4 v3, s[8:11], s25 offen offset:3072 lds
    s_add_u32 m0, s21, 8192
    s_add_u32 s25, s25, 4096
    buffer_load_dwordx4 v3, s[8:11], s25 offen offset:0 lds
    buffer_load_dwordx4 v3, s[8:11], s25 offen offset:1024 lds
GB_98:
    s_barrier
    buffer_load_dwordx4 v[124:127], v7, s[8:11], s42 offen offset:0 sc1
    buffer_load_dwordx4 v[128:131], v7, s[8:11], s42 offen offset:32 sc1
    buffer_load_dwordx4 v[132:135], v7, s[8:11], s42 offen offset:64 sc1
    s_add_u32 s33, s35, 0
    s_sub_u32 s21, s33, 12
    s_cmp_ge_u32 s33, 12
    s_cselect_b32 s33, s21, s33
    s_mul_i32 s33, s33, 4096
    s_add_u32 s25, s22, s33
    buffer_load_dwordx4 a[0:3], v3, s[8:11], s25 offen offset:0 sc1
    buffer_load_dwordx4 a[4:7], v3, s[8:11], s25 offen offset:1024 sc1
    buffer_load_dwordx4 a[8:11], v3, s[8:11], s25 offen offset:2048 sc1
    buffer_load_dwordx4 a[12:15], v3, s[8:11], s25 offen offset:3072 sc1
    s_add_u32 s33, s35, 1
    s_sub_u32 s21, s33, 12
    s_cmp_ge_u32 s33, 12
    s_cselect_b32 s33, s21, s33
    s_mul_i32 s33, s33, 4096
    s_add_u32 s25, s22, s33
    buffer_load_dwordx4 a[16:19], v3, s[8:11], s25 offen offset:0 sc1
    buffer_load_dwordx4 a[20:23], v3, s[8:11], s25 offen offset:1024 sc1
    buffer_load_dwordx4 a[24:27], v3, s[8:11], s25 offen offset:2048 sc1
    buffer_load_dwordx4 a[28:31], v3, s[8:11], s25 offen offset:3072 sc1
    s_waitcnt vmcnt(11)
    s_barrier
    ds_read_b128 v[16:19], v4 offset:0
    ds_read_b128 v[20:23], v4 offset:1024
    ds_read_b128 v[24:27], v5 offset:0
    ds_read_b128 v[28:31], v4 offset:2048
    ds_read_b128 v[32:35], v4 offset:3072
    ds_read_b128 v[36:39], v5 offset:512
    s_waitcnt vmcnt(7)
    s_waitcnt lgkmcnt(5)
    v_mfma_f32_32x32x16_bf16 v[64:79], v[16:19], a[0:3], 0
    ds_read_b128 v[40:43], v4 offset:5120
    s_add_u32 s33, s35, 2
    s_sub_u32 s21, s33, 12
    s_cmp_ge_u32 s33, 12
    s_cselect_b32 s33, s21, s33
    s_mul_i32 s33, s33, 4096
    s_add_u32 s25, s22, s33
    buffer_load_dwordx4 a[32:35], v3, s[8:11], s25 offen offset:0 sc1
    v_lshlrev_b32 v136, 16, v184
    v_and_b32 v137, 0xffff0000, v184
    s_waitcnt lgkmcnt(5)
    v_mfma_f32_32x32x16_bf16 v[80:95], v[20:23], a[0:3], 0
    ds_read_b128 v[44:47], v4 offset:6144
    buffer_load_dwordx4 a[36:39], v3, s[8:11], s25 offen offset:1024 sc1
    v_lshlrev_b32 v196, 16, v124
    v_and_b32 v197, 0xffff0000, v124
    s_waitcnt lgkmcnt(5)
    v_mfma_f32_32x32x16_bf16 v[96:111], v[24:27], a[0:3], 0
    ds_read_b128 v[48:51], v5 offset:5120
    buffer_load_dwordx4 a[40:43], v3, s[8:11], s25 offen offset:2048 sc1
    v_lshlrev_b32 v138, 16, v185
    v_and_b32 v139, 0xffff0000, v185
    s_waitcnt vmcnt(9)
    s_waitcnt lgkmcnt(5)
    v_mfma_f32_32x32x16_bf16 v[64:79], v[28:31], a[4:7], v[64:79]
    ds_read_b128 v[16:19], v4 offset:7168
    buffer_load_dwordx4 a[44:47], v3, s[8:11], s25 offen offset:3072 sc1
    v_lshlrev_b32 v198, 16, v125
    v_and_b32 v199, 0xffff0000, v125
    s_waitcnt lgkmcnt(5)
    v_mfma_f32_32x32x16_bf16 v[80:95], v[32:35], a[4:7], v[80:95]
    ds_read_b128 v[20:23], v4 offset:8192
    s_add_u32 m0, s30, 30720
    s_add_u32 s33, s35, 3
    s_sub_u32 s21, s33, 12
    s_cmp_ge_u32 s33, 12
    s_cselect_b32 s33, s21, s33
    s_mul_i32 s33, s33, 10240
    s_add_u32 s24, s23, s33
    buffer_load_dwordx4 v3, s[8:11], s24 offen offset:0 lds
    v_lshlrev_b32 v140, 16, v186
    v_and_b32 v141, 0xffff0000, v186
    s_waitcnt lgkmcnt(5)
    v_mfma_f32_32x32x16_bf16 v[96:111], v[36:39], a[4:7], v[96:111]
    ds_read_b128 v[24:27], v5 offset:5632
    buffer_load_dwordx4 v3, s[8:11], s24 offen offset:1024 lds
    v_lshlrev_b32 v200, 16, v126
    v_and_b32 v201, 0xffff0000, v126
    s_barrier
    s_waitcnt vmcnt(11)
    s_waitcnt lgkmcnt(5)
    v_mfma_f32_32x32x16_bf16 v[64:79], v[40:43], a[8:11], v[64:79]
    ds_read_b128 v[28:31], v4 offset:10240
    buffer_load_dwordx4 v3, s[8:11], s24 offen offset:2048 lds
    v_lshlrev_b32 v142, 16, v187
    v_and_b32 v143, 0xffff0000, v187
    s_waitcnt lgkmcnt(5)
    v_mfma_f32_32x32x16_bf16 v[80:95], v[44:47], a[8:11], v[80:95]
    ds_read_b128 v[32:35], v4 offset:11264
    buffer_load_dwordx4 v3, s[8:11], s24 offen offset:3072 lds
    v_lshlrev_b32 v202, 16, v127
    v_and_b32 v203, 0xffff0000, v127
    s_waitcnt lgkmcnt(5)
    v_mfma_f32_32x32x16_bf16 v[96:111], v[48:51], a[8:11], v[96:111]
    ds_read_b128 v[36:39], v5 offset:10240
    s_add_u32 m0, s30, 34816
    s_add_u32 s24, s24, 4096
    buffer_load_dwordx4 v3, s[8:11], s24 offen lds
    v_lshlrev_b32 v144, 16, v188
    v_and_b32 v145, 0xffff0000, v188
    s_waitcnt vmcnt(13)
    s_waitcnt lgkmcnt(5)
    v_mfma_f32_32x32x16_bf16 v[64:79], v[16:19], a[12:15], v[64:79]
    ds_read_b128 v[40:43], v4 offset:12288
    s_add_u32 s33, s35, 3
    s_sub_u32 s21, s33, 12
    s_cmp_ge_u32 s33, 12
    s_cselect_b32 s33, s21, s33
    s_mul_i32 s33, s33, 4096
    s_add_u32 s25, s22, s33
    buffer_load_dwordx4 a[48:51], v3, s[8:11], s25 offen offset:0 sc1
    v_lshlrev_b32 v204, 16, v128
    v_and_b32 v205, 0xffff0000, v128
    s_waitcnt lgkmcnt(5)
    v_mfma_f32_32x32x16_bf16 v[80:95], v[20:23], a[12:15], v[80:95]
    ds_read_b128 v[44:47], v4 offset:13312
    buffer_load_dwordx4 a[52:55], v3, s[8:11], s25 offen offset:1024 sc1
    v_lshlrev_b32 v146, 16, v189
    v_and_b32 v147, 0xffff0000, v189
    s_waitcnt lgkmcnt(5)
    v_mfma_f32_32x32x16_bf16 v[96:111], v[24:27], a[12:15], v[96:111]
    ds_read_b128 v[48:51], v5 offset:10752
    buffer_load_dwordx4 a[56:59], v3, s[8:11], s25 offen offset:2048 sc1
    v_lshlrev_b32 v206, 16, v129
    v_and_b32 v207, 0xffff0000, v129
    s_waitcnt vmcnt(15)
    s_waitcnt lgkmcnt(5)
    v_mfma_f32_32x32x16_bf16 v[64:79], v[28:31], a[16:19], v[64:79]
    ds_read_b128 v[16:19], v4 offset:15360
    buffer_load_dwordx4 a[60:63], v3, s[8:11], s25 offen offset:3072 sc1
    v_lshlrev_b32 v148, 16, v190
    v_and_b32 v149, 0xffff0000, v190
    s_waitcnt lgkmcnt(5)
    v_mfma_f32_32x32x16_bf16 v[80:95], v[32:35], a[16:19], v[80:95]
    ds_read_b128 v[20:23], v4 offset:16384
    s_add_u32 m0, s30, 40960
    s_add_u32 s33, s35, 4
    s_sub_u32 s21, s33, 12
    s_cmp_ge_u32 s33, 12
    s_cselect_b32 s33, s21, s33
    s_mul_i32 s33, s33, 10240
    s_add_u32 s24, s23, s33
    buffer_load_dwordx4 v3, s[8:11], s24 offen offset:0 lds
    v_lshlrev_b32 v208, 16, v130
    v_and_b32 v209, 0xffff0000, v130
    s_waitcnt lgkmcnt(5)
    v_mfma_f32_32x32x16_bf16 v[96:111], v[36:39], a[16:19], v[96:111]
    ds_read_b128 v[24:27], v5 offset:15360
    buffer_load_dwordx4 v3, s[8:11], s24 offen offset:1024 lds
    v_lshlrev_b32 v150, 16, v191
    v_and_b32 v151, 0xffff0000, v191
    s_waitcnt vmcnt(17)
    s_waitcnt lgkmcnt(5)
    v_mfma_f32_32x32x16_bf16 v[64:79], v[40:43], a[20:23], v[64:79]
    ds_read_b128 v[28:31], v4 offset:17408
    buffer_load_dwordx4 v3, s[8:11], s24 offen offset:2048 lds
    v_lshlrev_b32 v210, 16, v131
    v_and_b32 v211, 0xffff0000, v131
    s_waitcnt lgkmcnt(5)
    v_mfma_f32_32x32x16_bf16 v[80:95], v[44:47], a[20:23], v[80:95]
    ds_read_b128 v[32:35], v4 offset:18432
    buffer_load_dwordx4 v3, s[8:11], s24 offen offset:3072 lds
    v_lshlrev_b32 v152, 16, v192
    v_and_b32 v153, 0xffff0000, v192
    s_waitcnt lgkmcnt(5)
    v_mfma_f32_32x32x16_bf16 v[96:111], v[48:51], a[20:23], v[96:111]
    ds_read_b128 v[36:39], v5 offset:15872
    s_add_u32 m0, s30, 45056
    s_add_u32 s24, s24, 4096
    buffer_load_dwordx4 v3, s[8:11], s24 offen lds
    v_lshlrev_b32 v212, 16, v132
    v_and_b32 v213, 0xffff0000, v132
    s_barrier
    s_waitcnt vmcnt(19)
    s_waitcnt lgkmcnt(5)
    v_mfma_f32_32x32x16_bf16 v[64:79], v[16:19], a[24:27], v[64:79]
    ds_read_b128 v[40:43], v4 offset:20480
    s_add_u32 s33, s35, 4
    s_sub_u32 s21, s33, 12
    s_cmp_ge_u32 s33, 12
    s_cselect_b32 s33, s21, s33
    s_mul_i32 s33, s33, 4096
    s_add_u32 s25, s22, s33
    buffer_load_dwordx4 a[64:67], v3, s[8:11], s25 offen offset:0 sc1
    v_lshlrev_b32 v154, 16, v193
    v_and_b32 v155, 0xffff0000, v193
    s_waitcnt lgkmcnt(5)
    v_mfma_f32_32x32x16_bf16 v[80:95], v[20:23], a[24:27], v[80:95]
    ds_read_b128 v[44:47], v4 offset:21504
    buffer_load_dwordx4 a[68:71], v3, s[8:11], s25 offen offset:1024 sc1
    v_lshlrev_b32 v214, 16, v133
    v_and_b32 v215, 0xffff0000, v133
    s_waitcnt lgkmcnt(5)
    v_mfma_f32_32x32x16_bf16 v[96:111], v[24:27], a[24:27], v[96:111]
    ds_read_b128 v[48:51], v5 offset:20480
    buffer_load_dwordx4 a[72:75], v3, s[8:11], s25 offen offset:2048 sc1
    v_lshlrev_b32 v156, 16, v194
    v_and_b32 v157, 0xffff0000, v194
    s_waitcnt vmcnt(21)
    s_waitcnt lgkmcnt(5)
    v_mfma_f32_32x32x16_bf16 v[64:79], v[28:31], a[28:31], v[64:79]
    ds_read_b128 v[16:19], v4 offset:22528
    buffer_load_dwordx4 a[76:79], v3, s[8:11], s25 offen offset:3072 sc1
    v_lshlrev_b32 v216, 16, v134
    v_and_b32 v217, 0xffff0000, v134
    s_waitcnt lgkmcnt(5)
    v_mfma_f32_32x32x16_bf16 v[80:95], v[32:35], a[28:31], v[80:95]
    ds_read_b128 v[20:23], v4 offset:23552
    s_add_u32 m0, s30, 51200
    s_add_u32 s33, s35, 5
    s_sub_u32 s21, s33, 12
    s_cmp_ge_u32 s33, 12
    s_cselect_b32 s33, s21, s33
    s_mul_i32 s33, s33, 10240
    s_add_u32 s24, s23, s33
    buffer_load_dwordx4 v3, s[8:11], s24 offen offset:0 lds
    v_lshlrev_b32 v158, 16, v195
    v_and_b32 v159, 0xffff0000, v195
    s_waitcnt lgkmcnt(5)
    v_mfma_f32_32x32x16_bf16 v[96:111], v[36:39], a[28:31], v[96:111]
    ds_read_b128 v[24:27], v5 offset:20992
    buffer_load_dwordx4 v3, s[8:11], s24 offen offset:1024 lds
    v_lshlrev_b32 v218, 16, v135
    v_and_b32 v219, 0xffff0000, v135
    s_waitcnt vmcnt(23)
    s_waitcnt lgkmcnt(5)
    v_mfma_f32_32x32x16_bf16 v[64:79], v[40:43], a[32:35], v[64:79]
    ds_read_b128 v[28:31], v4 offset:25600
    buffer_load_dwordx4 v3, s[8:11], s24 offen offset:2048 lds
    s_mul_i32 s19, s3, 6144
    s_add_u32 s19, s19, 122880
    v_add_u32 v12, s19, v3
    s_waitcnt lgkmcnt(5)
    v_mfma_f32_32x32x16_bf16 v[80:95], v[44:47], a[32:35], v[80:95]
    ds_read_b128 v[32:35], v4 offset:26624
    buffer_load_dwordx4 v3, s[8:11], s24 offen offset:3072 lds
    s_xor_b32 s19, s3, 2
    s_mul_i32 s19, s19, 6144
    s_add_u32 s19, s19, 122880
    v_add_u32 v13, s19, v3
    s_waitcnt lgkmcnt(5)
    v_mfma_f32_32x32x16_bf16 v[96:111], v[48:51], a[32:35], v[96:111]
    ds_read_b128 v[36:39], v5 offset:25600
    s_add_u32 m0, s30, 55296
    s_add_u32 s24, s24, 4096
    buffer_load_dwordx4 v3, s[8:11], s24 offen lds
    v_and_b32 v8, 31, v2
    s_lshl_b32 s19, s29, 5
    v_add_u32 v8, s19, v8
    s_waitcnt vmcnt(25)
    s_waitcnt lgkmcnt(5)
    v_mfma_f32_32x32x16_bf16 v[64:79], v[16:19], a[36:39], v[64:79]
    ds_read_b128 v[40:43], v4 offset:27648
    s_add_u32 s33, s35, 5
    s_sub_u32 s21, s33, 12
    s_cmp_ge_u32 s33, 12
    s_cselect_b32 s33, s21, s33
    s_mul_i32 s33, s33, 4096
    s_add_u32 s25, s22, s33
    buffer_load_dwordx4 a[80:83], v3, s[8:11], s25 offen offset:0 sc1
    v_mul_u32_u24 v8, 1280, v8
    v_add_u32 v8, v8, v7
    s_waitcnt lgkmcnt(5)
    v_mfma_f32_32x32x16_bf16 v[80:95], v[20:23], a[36:39], v[80:95]
    ds_read_b128 v[44:47], v4 offset:28672
    buffer_load_dwordx4 a[84:87], v3, s[8:11], s25 offen offset:1024 sc1
    s_waitcnt lgkmcnt(5)
    v_mfma_f32_32x32x16_bf16 v[96:111], v[24:27], a[36:39], v[96:111]
    ds_read_b128 v[48:51], v5 offset:26112
    buffer_load_dwordx4 a[88:91], v3, s[8:11], s25 offen offset:2048 sc1
    s_waitcnt vmcnt(21)
    s_barrier
    s_waitcnt vmcnt(27)
    s_waitcnt lgkmcnt(5)
    v_mfma_f32_32x32x16_bf16 v[64:79], v[28:31], a[40:43], v[64:79]
    ds_read_b128 v[16:19], v4 offset:30720
    buffer_load_dwordx4 a[92:95], v3, s[8:11], s25 offen offset:3072 sc1
    s_waitcnt lgkmcnt(5)
    v_mfma_f32_32x32x16_bf16 v[80:95], v[32:35], a[40:43], v[80:95]
    ds_read_b128 v[20:23], v4 offset:31744
    s_add_u32 m0, s30, 0
    s_add_u32 s33, s35, 6
    s_sub_u32 s21, s33, 12
    s_cmp_ge_u32 s33, 12
    s_cselect_b32 s33, s21, s33
    s_mul_i32 s33, s33, 10240
    s_add_u32 s24, s23, s33
    buffer_load_dwordx4 v3, s[8:11], s24 offen offset:0 lds
    s_waitcnt lgkmcnt(5)
    v_mfma_f32_32x32x16_bf16 v[96:111], v[36:39], a[40:43], v[96:111]
    ds_read_b128 v[24:27], v5 offset:30720
    buffer_load_dwordx4 v3, s[8:11], s24 offen offset:1024 lds
    s_waitcnt vmcnt(29)
    s_waitcnt lgkmcnt(5)
    v_mfma_f32_32x32x16_bf16 v[64:79], v[40:43], a[44:47], v[64:79]
    ds_read_b128 v[28:31], v4 offset:32768
    buffer_load_dwordx4 v3, s[8:11], s24 offen offset:2048 lds
    s_waitcnt lgkmcnt(5)
    v_mfma_f32_32x32x16_bf16 v[80:95], v[44:47], a[44:47], v[80:95]
    ds_read_b128 v[32:35], v4 offset:33792
    buffer_load_dwordx4 v3, s[8:11], s24 offen offset:3072 lds
    s_waitcnt lgkmcnt(5)
    v_mfma_f32_32x32x16_bf16 v[96:111], v[48:51], a[44:47], v[96:111]
    ds_read_b128 v[36:39], v5 offset:31232
    s_add_u32 m0, s30, 4096
    s_add_u32 s24, s24, 4096
    buffer_load_dwordx4 v3, s[8:11], s24 offen lds
    s_waitcnt vmcnt(26)
    s_waitcnt lgkmcnt(5)
    v_mfma_f32_32x32x16_bf16 v[64:79], v[16:19], a[48:51], v[64:79]
    ds_read_b128 v[40:43], v4 offset:35840
    s_add_u32 s33, s35, 6
    s_sub_u32 s21, s33, 12
    s_cmp_ge_u32 s33, 12
    s_cselect_b32 s33, s21, s33
    s_mul_i32 s33, s33, 4096
    s_add_u32 s25, s22, s33
    buffer_load_dwordx4 a[96:99], v3, s[8:11], s25 offen offset:0 sc1
    s_waitcnt lgkmcnt(5)
    v_mfma_f32_32x32x16_bf16 v[80:95], v[20:23], a[48:51], v[80:95]
    ds_read_b128 v[44:47], v4 offset:36864
    buffer_load_dwordx4 a[100:103], v3, s[8:11], s25 offen offset:1024 sc1
    s_waitcnt lgkmcnt(5)
    v_mfma_f32_32x32x16_bf16 v[96:111], v[24:27], a[48:51], v[96:111]
    ds_read_b128 v[48:51], v5 offset:35840
    buffer_load_dwordx4 a[104:107], v3, s[8:11], s25 offen offset:2048 sc1
    s_waitcnt vmcnt(28)
    s_waitcnt lgkmcnt(5)
    v_mfma_f32_32x32x16_bf16 v[64:79], v[28:31], a[52:55], v[64:79]
    ds_read_b128 v[16:19], v4 offset:37888
    buffer_load_dwordx4 a[108:111], v3, s[8:11], s25 offen offset:3072 sc1
    s_waitcnt lgkmcnt(5)
    v_mfma_f32_32x32x16_bf16 v[80:95], v[32:35], a[52:55], v[80:95]
    ds_read_b128 v[20:23], v4 offset:38912
    s_add_u32 m0, s30, 10240
    s_add_u32 s33, s35, 7
    s_sub_u32 s21, s33, 12
    s_cmp_ge_u32 s33, 12
    s_cselect_b32 s33, s21, s33
    s_mul_i32 s33, s33, 10240
    s_add_u32 s24, s23, s33
    buffer_load_dwordx4 v3, s[8:11], s24 offen offset:0 lds
    s_waitcnt lgkmcnt(5)
    v_mfma_f32_32x32x16_bf16 v[96:111], v[36:39], a[52:55], v[96:111]
    ds_read_b128 v[24:27], v5 offset:36352
    buffer_load_dwordx4 v3, s[8:11], s24 offen offset:1024 lds
    s_waitcnt vmcnt(24)
    s_barrier
    s_waitcnt vmcnt(30)
    s_waitcnt lgkmcnt(5)
    v_mfma_f32_32x32x16_bf16 v[64:79], v[40:43], a[56:59], v[64:79]
    ds_read_b128 v[28:31], v4 offset:40960
    buffer_load_dwordx4 v3, s[8:11], s24 offen offset:2048 lds
    s_waitcnt lgkmcnt(5)
    v_mfma_f32_32x32x16_bf16 v[80:95], v[44:47], a[56:59], v[80:95]
    ds_read_b128 v[32:35], v4 offset:41984
    buffer_load_dwordx4 v3, s[8:11], s24 offen offset:3072 lds
    s_waitcnt lgkmcnt(5)
    v_mfma_f32_32x32x16_bf16 v[96:111], v[48:51], a[56:59], v[96:111]
    ds_read_b128 v[36:39], v5 offset:40960
    s_add_u32 m0, s30, 14336
    s_add_u32 s24, s24, 4096
    buffer_load_dwordx4 v3, s[8:11], s24 offen lds
    s_waitcnt vmcnt(32)
    s_waitcnt lgkmcnt(5)
    v_mfma_f32_32x32x16_bf16 v[64:79], v[16:19], a[60:63], v[64:79]
    ds_read_b128 v[40:43], v4 offset:43008
    s_add_u32 s33, s35, 7
    s_sub_u32 s21, s33, 12
    s_cmp_ge_u32 s33, 12
    s_cselect_b32 s33, s21, s33
    s_mul_i32 s33, s33, 4096
    s_add_u32 s25, s22, s33
    buffer_load_dwordx4 a[112:115], v3, s[8:11], s25 offen offset:0 sc1
    s_waitcnt lgkmcnt(5)
    v_mfma_f32_32x32x16_bf16 v[80:95], v[20:23], a[60:63], v[80:95]
    ds_read_b128 v[44:47], v4 offset:44032
    buffer_load_dwordx4 a[116:119], v3, s[8:11], s25 offen offset:1024 sc1
    s_waitcnt lgkmcnt(5)
    v_mfma_f32_32x32x16_bf16 v[96:111], v[24:27], a[60:63], v[96:111]
    ds_read_b128 v[48:51], v5 offset:41472
    buffer_load_dwordx4 a[120:123], v3, s[8:11], s25 offen offset:2048 sc1
    s_waitcnt vmcnt(29)
    s_waitcnt lgkmcnt(5)
    v_mfma_f32_32x32x16_bf16 v[64:79], v[28:31], a[64:67], v[64:79]
    ds_read_b128 v[16:19], v4 offset:46080
    buffer_load_dwordx4 a[124:127], v3, s[8:11], s25 offen offset:3072 sc1
    s_waitcnt lgkmcnt(5)
    v_mfma_f32_32x32x16_bf16 v[80:95], v[32:35], a[64:67], v[80:95]
    ds_read_b128 v[20:23], v4 offset:47104
    s_add_u32 m0, s30, 20480
    s_add_u32 s33, s35, 8
    s_sub_u32 s21, s33, 12
    s_cmp_ge_u32 s33, 12
    s_cselect_b32 s33, s21, s33
    s_mul_i32 s33, s33, 10240
    s_add_u32 s24, s23, s33
    buffer_load_dwordx4 v3, s[8:11], s24 offen offset:0 lds
    s_waitcnt lgkmcnt(5)
    v_mfma_f32_32x32x16_bf16 v[96:111], v[36:39], a[64:67], v[96:111]
    ds_read_b128 v[24:27], v5 offset:46080
    buffer_load_dwordx4 v3, s[8:11], s24 offen offset:1024 lds
    s_waitcnt vmcnt(31)
    s_waitcnt lgkmcnt(5)
    v_mfma_f32_32x32x16_bf16 v[64:79], v[40:43], a[68:71], v[64:79]
    ds_read_b128 v[28:31], v4 offset:48128
    buffer_load_dwordx4 v3, s[8:11], s24 offen offset:2048 lds
    s_waitcnt lgkmcnt(5)
    v_mfma_f32_32x32x16_bf16 v[80:95], v[44:47], a[68:71], v[80:95]
    ds_read_b128 v[32:35], v4 offset:49152
    buffer_load_dwordx4 v3, s[8:11], s24 offen offset:3072 lds
    s_waitcnt lgkmcnt(5)
    v_mfma_f32_32x32x16_bf16 v[96:111], v[48:51], a[68:71], v[96:111]
    ds_read_b128 v[36:39], v5 offset:46592
    s_add_u32 m0, s30, 24576
    s_add_u32 s24, s24, 4096
    buffer_load_dwordx4 v3, s[8:11], s24 offen lds
    s_waitcnt vmcnt(27)
    s_barrier
    s_waitcnt vmcnt(33)
    s_waitcnt lgkmcnt(5)
    v_mfma_f32_32x32x16_bf16 v[64:79], v[16:19], a[72:75], v[64:79]
    ds_read_b128 v[40:43], v4 offset:51200
    s_add_u32 s33, s35, 8
    s_sub_u32 s21, s33, 12
    s_cmp_ge_u32 s33, 12
    s_cselect_b32 s33, s21, s33
    s_mul_i32 s33, s33, 4096
    s_add_u32 s25, s22, s33
    buffer_load_dwordx4 a[128:131], v3, s[8:11], s25 offen offset:0 sc1
    s_waitcnt lgkmcnt(5)
    v_mfma_f32_32x32x16_bf16 v[80:95], v[20:23], a[72:75], v[80:95]
    ds_read_b128 v[44:47], v4 offset:52224
    buffer_load_dwordx4 a[132:135], v3, s[8:11], s25 offen offset:1024 sc1
    s_waitcnt lgkmcnt(5)
    v_mfma_f32_32x32x16_bf16 v[96:111], v[24:27], a[72:75], v[96:111]
    ds_read_b128 v[48:51], v5 offset:51200
    buffer_load_dwordx4 a[136:139], v3, s[8:11], s25 offen offset:2048 sc1
    s_waitcnt vmcnt(35)
    s_waitcnt lgkmcnt(5)
    v_mfma_f32_32x32x16_bf16 v[64:79], v[28:31], a[76:79], v[64:79]
    ds_read_b128 v[16:19], v4 offset:53248
    buffer_load_dwordx4 a[140:143], v3, s[8:11], s25 offen offset:3072 sc1
    s_waitcnt lgkmcnt(5)
    v_mfma_f32_32x32x16_bf16 v[80:95], v[32:35], a[76:79], v[80:95]
    ds_read_b128 v[20:23], v4 offset:54272
    s_add_u32 m0, s30, 30720
    s_add_u32 s33, s35, 9
    s_sub_u32 s21, s33, 12
    s_cmp_ge_u32 s33, 12
    s_cselect_b32 s33, s21, s33
    s_mul_i32 s33, s33, 10240
    s_add_u32 s24, s23, s33
    buffer_load_dwordx4 v3, s[8:11], s24 offen offset:0 lds
    s_waitcnt lgkmcnt(5)
    v_mfma_f32_32x32x16_bf16 v[96:111], v[36:39], a[76:79], v[96:111]
    ds_read_b128 v[24:27], v5 offset:51712
    buffer_load_dwordx4 v3, s[8:11], s24 offen offset:1024 lds
    s_waitcnt vmcnt(32)
    s_waitcnt lgkmcnt(5)
    v_mfma_f32_32x32x16_bf16 v[64:79], v[40:43], a[80:83], v[64:79]
    ds_read_b128 v[28:31], v4 offset:56320
    buffer_load_dwordx4 v3, s[8:11], s24 offen offset:2048 lds
    s_waitcnt lgkmcnt(5)
    v_mfma_f32_32x32x16_bf16 v[80:95], v[44:47], a[80:83], v[80:95]
    ds_read_b128 v[32:35], v4 offset:57344
    buffer_load_dwordx4 v3, s[8:11], s24 offen offset:3072 lds
    s_waitcnt lgkmcnt(5)
    v_mfma_f32_32x32x16_bf16 v[96:111], v[48:51], a[80:83], v[96:111]
    ds_read_b128 v[36:39], v5 offset:56320
    s_add_u32 m0, s30, 34816
    s_add_u32 s24, s24, 4096
    buffer_load_dwordx4 v3, s[8:11], s24 offen lds
    s_waitcnt vmcnt(34)
    s_waitcnt lgkmcnt(5)
    v_mfma_f32_32x32x16_bf16 v[64:79], v[16:19], a[84:87], v[64:79]
    ds_read_b128 v[40:43], v4 offset:58368
    s_add_u32 s33, s35, 9
    s_sub_u32 s21, s33, 12
    s_cmp_ge_u32 s33, 12
    s_cselect_b32 s33, s21, s33
    s_mul_i32 s33, s33, 4096
    s_add_u32 s25, s22, s33
    buffer_load_dwordx4 a[144:147], v3, s[8:11], s25 offen offset:0 sc1
    s_waitcnt lgkmcnt(5)
    v_mfma_f32_32x32x16_bf16 v[80:95], v[20:23], a[84:87], v[80:95]
    ds_read_b128 v[44:47], v4 offset:59392
    buffer_load_dwordx4 a[148:151], v3, s[8:11], s25 offen offset:1024 sc1
    s_waitcnt lgkmcnt(5)
    v_mfma_f32_32x32x16_bf16 v[96:111], v[24:27], a[84:87], v[96:111]
    ds_read_b128 v[48:51], v5 offset:56832
    buffer_load_dwordx4 a[152:155], v3, s[8:11], s25 offen offset:2048 sc1
    s_waitcnt vmcnt(30)
    s_barrier
    s_waitcnt vmcnt(36)
    s_waitcnt lgkmcnt(5)
    v_mfma_f32_32x32x16_bf16 v[64:79], v[28:31], a[88:91], v[64:79]
    ds_read_b128 v[16:19], v4 offset:0
    buffer_load_dwordx4 a[156:159], v3, s[8:11], s25 offen offset:3072 sc1
    s_waitcnt lgkmcnt(5)
    v_mfma_f32_32x32x16_bf16 v[80:95], v[32:35], a[88:91], v[80:95]
    ds_read_b128 v[20:23], v4 offset:1024
    s_add_u32 m0, s30, 40960
    s_add_u32 s33, s35, 10
    s_sub_u32 s21, s33, 12
    s_cmp_ge_u32 s33, 12
    s_cselect_b32 s33, s21, s33
    s_mul_i32 s33, s33, 10240
    s_add_u32 s24, s23, s33
    buffer_load_dwordx4 v3, s[8:11], s24 offen offset:0 lds
    s_waitcnt lgkmcnt(5)
    v_mfma_f32_32x32x16_bf16 v[96:111], v[36:39], a[88:91], v[96:111]
    ds_read_b128 v[24:27], v5 offset:0
    buffer_load_dwordx4 v3, s[8:11], s24 offen offset:1024 lds
    s_waitcnt vmcnt(38)
    s_waitcnt lgkmcnt(5)
    v_mfma_f32_32x32x16_bf16 v[64:79], v[40:43], a[92:95], v[64:79]
    ds_read_b128 v[28:31], v4 offset:2048
    buffer_load_dwordx4 v3, s[8:11], s24 offen offset:2048 lds
    s_waitcnt lgkmcnt(5)
    v_mfma_f32_32x32x16_bf16 v[80:95], v[44:47], a[92:95], v[80:95]
    ds_read_b128 v[32:35], v4 offset:3072
    buffer_load_dwordx4 v3, s[8:11], s24 offen offset:3072 lds
    s_waitcnt lgkmcnt(5)
    v_mfma_f32_32x32x16_bf16 v[96:111], v[48:51], a[92:95], v[96:111]
    ds_read_b128 v[36:39], v5 offset:512
    s_add_u32 m0, s30, 45056
    s_add_u32 s24, s24, 4096
    buffer_load_dwordx4 v3, s[8:11], s24 offen lds
    s_waitcnt vmcnt(35)
    s_waitcnt lgkmcnt(5)
    v_mfma_f32_32x32x16_bf16 v[64:79], v[16:19], a[96:99], v[64:79]
    ds_read_b128 v[40:43], v4 offset:5120
    s_add_u32 s33, s35, 10
    s_sub_u32 s21, s33, 12
    s_cmp_ge_u32 s33, 12
    s_cselect_b32 s33, s21, s33
    s_mul_i32 s33, s33, 4096
    s_add_u32 s25, s22, s33
    buffer_load_dwordx4 a[160:163], v3, s[8:11], s25 offen offset:0 sc1
    s_waitcnt lgkmcnt(5)
    v_mfma_f32_32x32x16_bf16 v[80:95], v[20:23], a[96:99], v[80:95]
    ds_read_b128 v[44:47], v4 offset:6144
    buffer_load_dwordx4 a[164:167], v3, s[8:11], s25 offen offset:1024 sc1
    s_waitcnt lgkmcnt(5)
    v_mfma_f32_32x32x16_bf16 v[96:111], v[24:27], a[96:99], v[96:111]
    ds_read_b128 v[48:51], v5 offset:5120
    buffer_load_dwordx4 a[168:171], v3, s[8:11], s25 offen offset:2048 sc1
    s_waitcnt vmcnt(37)
    s_waitcnt lgkmcnt(5)
    v_mfma_f32_32x32x16_bf16 v[64:79], v[28:31], a[100:103], v[64:79]
    ds_read_b128 v[16:19], v4 offset:7168
    buffer_load_dwordx4 a[172:175], v3, s[8:11], s25 offen offset:3072 sc1
    s_waitcnt lgkmcnt(5)
    v_mfma_f32_32x32x16_bf16 v[80:95], v[32:35], a[100:103], v[80:95]
    ds_read_b128 v[20:23], v4 offset:8192
    s_waitcnt lgkmcnt(5)
    v_mfma_f32_32x32x16_bf16 v[96:111], v[36:39], a[100:103], v[96:111]
    ds_read_b128 v[24:27], v5 offset:5632
    s_waitcnt vmcnt(31)
    s_barrier
    s_waitcnt vmcnt(37)
    s_waitcnt lgkmcnt(5)
    v_mfma_f32_32x32x16_bf16 v[64:79], v[40:43], a[104:107], v[64:79]
    ds_read_b128 v[28:31], v4 offset:10240
    s_add_u32 m0, s30, 51200
    s_add_u32 s33, s35, 11
    s_sub_u32 s21, s33, 12
    s_cmp_ge_u32 s33, 12
    s_cselect_b32 s33, s21, s33
    s_mul_i32 s33, s33, 10240
    s_add_u32 s24, s23, s33
    buffer_load_dwordx4 v3, s[8:11], s24 offen offset:0 lds
    s_waitcnt lgkmcnt(5)
    v_mfma_f32_32x32x16_bf16 v[80:95], v[44:47], a[104:107], v[80:95]
    ds_read_b128 v[32:35], v4 offset:11264
    buffer_load_dwordx4 v3, s[8:11], s24 offen offset:1024 lds
    s_waitcnt lgkmcnt(5)
    v_mfma_f32_32x32x16_bf16 v[96:111], v[48:51], a[104:107], v[96:111]
    ds_read_b128 v[36:39], v5 offset:10240
    buffer_load_dwordx4 v3, s[8:11], s24 offen offset:2048 lds
    s_waitcnt vmcnt(39)
    s_waitcnt lgkmcnt(5)
    v_mfma_f32_32x32x16_bf16 v[64:79], v[16:19], a[108:111], v[64:79]
    ds_read_b128 v[40:43], v4 offset:12288
    buffer_load_dwordx4 v3, s[8:11], s24 offen offset:3072 lds
    s_waitcnt lgkmcnt(5)
    v_mfma_f32_32x32x16_bf16 v[80:95], v[20:23], a[108:111], v[80:95]
    ds_read_b128 v[44:47], v4 offset:13312
    s_add_u32 m0, s30, 55296
    s_add_u32 s24, s24, 4096
    buffer_load_dwordx4 v3, s[8:11], s24 offen lds
    s_waitcnt lgkmcnt(5)
    v_mfma_f32_32x32x16_bf16 v[96:111], v[24:27], a[108:111], v[96:111]
    ds_read_b128 v[48:51], v5 offset:10752
    s_add_u32 s33, s35, 11
    s_sub_u32 s21, s33, 12
    s_cmp_ge_u32 s33, 12
    s_cselect_b32 s33, s21, s33
    s_mul_i32 s33, s33, 4096
    s_add_u32 s25, s22, s33
    buffer_load_dwordx4 a[176:179], v3, s[8:11], s25 offen offset:0 sc1
    s_waitcnt vmcnt(36)
    s_waitcnt lgkmcnt(5)
    v_mfma_f32_32x32x16_bf16 v[64:79], v[28:31], a[112:115], v[64:79]
    ds_read_b128 v[16:19], v4 offset:15360
    buffer_load_dwordx4 a[180:183], v3, s[8:11], s25 offen offset:1024 sc1
    s_waitcnt lgkmcnt(5)
    v_mfma_f32_32x32x16_bf16 v[80:95], v[32:35], a[112:115], v[80:95]
    ds_read_b128 v[20:23], v4 offset:16384
    buffer_load_dwordx4 a[184:187], v3, s[8:11], s25 offen offset:2048 sc1
    s_waitcnt lgkmcnt(5)
    v_mfma_f32_32x32x16_bf16 v[96:111], v[36:39], a[112:115], v[96:111]
    ds_read_b128 v[24:27], v5 offset:15360
    buffer_load_dwordx4 a[188:191], v3, s[8:11], s25 offen offset:3072 sc1
    s_waitcnt vmcnt(38)
    s_waitcnt lgkmcnt(5)
    v_mfma_f32_32x32x16_bf16 v[64:79], v[40:43], a[116:119], v[64:79]
    ds_read_b128 v[28:31], v4 offset:17408
    s_waitcnt lgkmcnt(5)
    v_mfma_f32_32x32x16_bf16 v[80:95], v[44:47], a[116:119], v[80:95]
    ds_read_b128 v[32:35], v4 offset:18432
    s_waitcnt lgkmcnt(5)
    v_mfma_f32_32x32x16_bf16 v[96:111], v[48:51], a[116:119], v[96:111]
    ds_read_b128 v[36:39], v5 offset:15872
    s_waitcnt vmcnt(31)
    s_barrier
    s_waitcnt vmcnt(37)
    s_waitcnt lgkmcnt(5)
    v_mfma_f32_32x32x16_bf16 v[64:79], v[16:19], a[120:123], v[64:79]
    ds_read_b128 v[40:43], v4 offset:20480
    s_waitcnt lgkmcnt(5)
    v_mfma_f32_32x32x16_bf16 v[80:95], v[20:23], a[120:123], v[80:95]
    ds_read_b128 v[44:47], v4 offset:21504
    s_waitcnt lgkmcnt(5)
    v_mfma_f32_32x32x16_bf16 v[96:111], v[24:27], a[120:123], v[96:111]
    ds_read_b128 v[48:51], v5 offset:20480
    s_waitcnt vmcnt(36)
    s_waitcnt lgkmcnt(5)
    v_mfma_f32_32x32x16_bf16 v[64:79], v[28:31], a[124:127], v[64:79]
    ds_read_b128 v[16:19], v4 offset:22528
    s_waitcnt lgkmcnt(5)
    v_mfma_f32_32x32x16_bf16 v[80:95], v[32:35], a[124:127], v[80:95]
    ds_read_b128 v[20:23], v4 offset:23552
    s_waitcnt lgkmcnt(5)
    v_mfma_f32_32x32x16_bf16 v[96:111], v[36:39], a[124:127], v[96:111]
    ds_read_b128 v[24:27], v5 offset:20992
    s_waitcnt vmcnt(30)
    s_waitcnt lgkmcnt(5)
    v_mfma_f32_32x32x16_bf16 v[64:79], v[40:43], a[128:131], v[64:79]
    ds_read_b128 v[28:31], v4 offset:25600
    s_waitcnt lgkmcnt(5)
    v_mfma_f32_32x32x16_bf16 v[80:95], v[44:47], a[128:131], v[80:95]
    ds_read_b128 v[32:35], v4 offset:26624
    s_waitcnt lgkmcnt(5)
    v_mfma_f32_32x32x16_bf16 v[96:111], v[48:51], a[128:131], v[96:111]
    ds_read_b128 v[36:39], v5 offset:25600
    s_waitcnt vmcnt(29)
    s_waitcnt lgkmcnt(5)
    v_mfma_f32_32x32x16_bf16 v[64:79], v[16:19], a[132:135], v[64:79]
    ds_read_b128 v[40:43], v4 offset:27648
    s_waitcnt lgkmcnt(5)
    v_mfma_f32_32x32x16_bf16 v[80:95], v[20:23], a[132:135], v[80:95]
    ds_read_b128 v[44:47], v4 offset:28672
    s_waitcnt lgkmcnt(5)
    v_mfma_f32_32x32x16_bf16 v[96:111], v[24:27], a[132:135], v[96:111]
    ds_read_b128 v[48:51], v5 offset:26112
    s_waitcnt vmcnt(22)
    s_barrier
    s_waitcnt vmcnt(28)
    s_waitcnt lgkmcnt(5)
    v_mfma_f32_32x32x16_bf16 v[64:79], v[28:31], a[136:139], v[64:79]
    ds_read_b128 v[16:19], v4 offset:30720
    s_waitcnt lgkmcnt(5)
    v_mfma_f32_32x32x16_bf16 v[80:95], v[32:35], a[136:139], v[80:95]
    ds_read_b128 v[20:23], v4 offset:31744
    s_waitcnt lgkmcnt(5)
    v_mfma_f32_32x32x16_bf16 v[96:111], v[36:39], a[136:139], v[96:111]
    ds_read_b128 v[24:27], v5 offset:30720
    s_waitcnt vmcnt(27)
    s_waitcnt lgkmcnt(5)
    v_mfma_f32_32x32x16_bf16 v[64:79], v[40:43], a[140:143], v[64:79]
    ds_read_b128 v[28:31], v4 offset:32768
    s_waitcnt lgkmcnt(5)
    v_mfma_f32_32x32x16_bf16 v[80:95], v[44:47], a[140:143], v[80:95]
    ds_read_b128 v[32:35], v4 offset:33792
    s_waitcnt lgkmcnt(5)
    v_mfma_f32_32x32x16_bf16 v[96:111], v[48:51], a[140:143], v[96:111]
    ds_read_b128 v[36:39], v5 offset:31232
    s_waitcnt vmcnt(21)
    s_waitcnt lgkmcnt(5)
    v_mfma_f32_32x32x16_bf16 v[64:79], v[16:19], a[144:147], v[64:79]
    ds_read_b128 v[40:43], v4 offset:35840
    s_waitcnt lgkmcnt(5)
    v_mfma_f32_32x32x16_bf16 v[80:95], v[20:23], a[144:147], v[80:95]
    ds_read_b128 v[44:47], v4 offset:36864
    s_waitcnt lgkmcnt(5)
    v_mfma_f32_32x32x16_bf16 v[96:111], v[24:27], a[144:147], v[96:111]
    ds_read_b128 v[48:51], v5 offset:35840
    s_waitcnt vmcnt(20)
    s_waitcnt lgkmcnt(5)
    v_mfma_f32_32x32x16_bf16 v[64:79], v[28:31], a[148:151], v[64:79]
    ds_read_b128 v[16:19], v4 offset:37888
    s_waitcnt lgkmcnt(5)
    v_mfma_f32_32x32x16_bf16 v[80:95], v[32:35], a[148:151], v[80:95]
    ds_read_b128 v[20:23], v4 offset:38912
    s_waitcnt lgkmcnt(5)
    v_mfma_f32_32x32x16_bf16 v[96:111], v[36:39], a[148:151], v[96:111]
    ds_read_b128 v[24:27], v5 offset:36352
    s_waitcnt vmcnt(13)
    s_barrier
    s_waitcnt vmcnt(19)
    s_waitcnt lgkmcnt(5)
    v_mfma_f32_32x32x16_bf16 v[64:79], v[40:43], a[152:155], v[64:79]
    ds_read_b128 v[28:31], v4 offset:40960
    s_waitcnt lgkmcnt(5)
    v_mfma_f32_32x32x16_bf16 v[80:95], v[44:47], a[152:155], v[80:95]
    ds_read_b128 v[32:35], v4 offset:41984
    s_waitcnt lgkmcnt(5)
    v_mfma_f32_32x32x16_bf16 v[96:111], v[48:51], a[152:155], v[96:111]
    ds_read_b128 v[36:39], v5 offset:40960
    s_waitcnt vmcnt(18)
    s_waitcnt lgkmcnt(5)
    v_mfma_f32_32x32x16_bf16 v[64:79], v[16:19], a[156:159], v[64:79]
    ds_read_b128 v[40:43], v4 offset:43008
    s_waitcnt lgkmcnt(5)
    v_mfma_f32_32x32x16_bf16 v[80:95], v[20:23], a[156:159], v[80:95]
    ds_read_b128 v[44:47], v4 offset:44032
    s_waitcnt lgkmcnt(5)
    v_mfma_f32_32x32x16_bf16 v[96:111], v[24:27], a[156:159], v[96:111]
    ds_read_b128 v[48:51], v5 offset:41472
    s_waitcnt vmcnt(12)
    s_waitcnt lgkmcnt(5)
    v_mfma_f32_32x32x16_bf16 v[64:79], v[28:31], a[160:163], v[64:79]
    ds_read_b128 v[16:19], v4 offset:46080
    s_waitcnt lgkmcnt(5)
    v_mfma_f32_32x32x16_bf16 v[80:95], v[32:35], a[160:163], v[80:95]
    ds_read_b128 v[20:23], v4 offset:47104
    s_waitcnt lgkmcnt(5)
    v_mfma_f32_32x32x16_bf16 v[96:111], v[36:39], a[160:163], v[96:111]
    ds_read_b128 v[24:27], v5 offset:46080
    s_waitcnt vmcnt(11)
    s_waitcnt lgkmcnt(5)
    v_mfma_f32_32x32x16_bf16 v[64:79], v[40:43], a[164:167], v[64:79]
    ds_read_b128 v[28:31], v4 offset:48128
    s_waitcnt lgkmcnt(5)
    v_mfma_f32_32x32x16_bf16 v[80:95], v[44:47], a[164:167], v[80:95]
    ds_read_b128 v[32:35], v4 offset:49152
    s_waitcnt lgkmcnt(5)
    v_mfma_f32_32x32x16_bf16 v[96:111], v[48:51], a[164:167], v[96:111]
    ds_read_b128 v[36:39], v5 offset:46592
    s_waitcnt vmcnt(4)
    s_barrier
    s_waitcnt vmcnt(10)
    s_waitcnt lgkmcnt(5)
    v_mfma_f32_32x32x16_bf16 v[64:79], v[16:19], a[168:171], v[64:79]
    ds_read_b128 v[40:43], v4 offset:51200
    s_waitcnt lgkmcnt(5)
    v_mfma_f32_32x32x16_bf16 v[80:95], v[20:23], a[168:171], v[80:95]
    ds_read_b128 v[44:47], v4 offset:52224
    s_waitcnt lgkmcnt(5)
    v_mfma_f32_32x32x16_bf16 v[96:111], v[24:27], a[168:171], v[96:111]
    ds_read_b128 v[48:51], v5 offset:51200
    s_waitcnt vmcnt(9)
    s_waitcnt lgkmcnt(5)
    v_mfma_f32_32x32x16_bf16 v[64:79], v[28:31], a[172:175], v[64:79]
    ds_read_b128 v[16:19], v4 offset:53248
    s_waitcnt lgkmcnt(5)
    v_mfma_f32_32x32x16_bf16 v[80:95], v[32:35], a[172:175], v[80:95]
    ds_read_b128 v[20:23], v4 offset:54272
    s_waitcnt lgkmcnt(5)
    v_mfma_f32_32x32x16_bf16 v[96:111], v[36:39], a[172:175], v[96:111]
    ds_read_b128 v[24:27], v5 offset:51712
    s_waitcnt vmcnt(3)
    s_waitcnt lgkmcnt(5)
    v_mfma_f32_32x32x16_bf16 v[64:79], v[40:43], a[176:179], v[64:79]
    ds_read_b128 v[28:31], v4 offset:56320
    s_waitcnt lgkmcnt(5)
    v_mfma_f32_32x32x16_bf16 v[80:95], v[44:47], a[176:179], v[80:95]
    ds_read_b128 v[32:35], v4 offset:57344
    s_waitcnt lgkmcnt(5)
    v_mfma_f32_32x32x16_bf16 v[96:111], v[48:51], a[176:179], v[96:111]
    ds_read_b128 v[36:39], v5 offset:56320
    s_waitcnt vmcnt(2)
    s_waitcnt lgkmcnt(5)
    v_mfma_f32_32x32x16_bf16 v[64:79], v[16:19], a[180:183], v[64:79]
    ds_read_b128 v[40:43], v4 offset:58368
    s_waitcnt lgkmcnt(5)
    v_mfma_f32_32x32x16_bf16 v[80:95], v[20:23], a[180:183], v[80:95]
    ds_read_b128 v[44:47], v4 offset:59392
    s_waitcnt lgkmcnt(5)
    v_mfma_f32_32x32x16_bf16 v[96:111], v[24:27], a[180:183], v[96:111]
    ds_read_b128 v[48:51], v5 offset:56832
    s_waitcnt vmcnt(1)
    s_waitcnt lgkmcnt(5)
    v_mfma_f32_32x32x16_bf16 v[64:79], v[28:31], a[184:187], v[64:79]
    s_waitcnt lgkmcnt(4)
    v_mfma_f32_32x32x16_bf16 v[80:95], v[32:35], a[184:187], v[80:95]
    s_waitcnt lgkmcnt(3)
    v_mfma_f32_32x32x16_bf16 v[96:111], v[36:39], a[184:187], v[96:111]
    s_waitcnt vmcnt(0)
    s_waitcnt lgkmcnt(2)
    v_mfma_f32_32x32x16_bf16 v[64:79], v[40:43], a[188:191], v[64:79]
    s_waitcnt lgkmcnt(1)
    v_mfma_f32_32x32x16_bf16 v[80:95], v[44:47], a[188:191], v[80:95]
    s_waitcnt lgkmcnt(0)
    v_mfma_f32_32x32x16_bf16 v[96:111], v[48:51], a[188:191], v[96:111]
    s_cmp_eq_u32 s27, 1
    s_cbranch_scc1 X_KH1_104
    s_nop 7
    ds_write_b128 v12, v[88:91] offset:0
    ds_write_b128 v12, v[92:95] offset:1024
    ds_write_b128 v12, v[96:99] offset:2048
    ds_write_b128 v12, v[100:103] offset:3072
    s_branch X_W_105
X_KH1_104:
    s_nop 5
    ds_write_b128 v12, v[64:67] offset:0
    ds_write_b128 v12, v[68:71] offset:1024
    ds_write_b128 v12, v[72:75] offset:2048
    ds_write_b128 v12, v[76:79] offset:3072
    ds_write_b128 v12, v[80:83] offset:4096
    ds_write_b128 v12, v[84:87] offset:5120
X_W_105:
    s_waitcnt lgkmcnt(0)
    s_barrier
    s_cmp_eq_u32 s27, 1
    s_cbranch_scc1 X_R1_106
    ds_read_b128 v[16:19], v13 offset:0
    ds_read_b128 v[20:23], v13 offset:1024
    ds_read_b128 v[24:27], v13 offset:2048
    ds_read_b128 v[28:31], v13 offset:3072
    ds_read_b128 v[32:35], v13 offset:4096
    ds_read_b128 v[36:39], v13 offset:5120
    s_waitcnt lgkmcnt(5)
    v_pk_add_f32 v[64:65], v[64:65], v[16:17]
    v_pk_add_f32 v[66:67], v[66:67], v[18:19]
    s_waitcnt lgkmcnt(4)
    v_pk_add_f32 v[68:69], v[68:69], v[20:21]
    v_pk_add_f32 v[70:71], v[70:71], v[22:23]
    s_waitcnt lgkmcnt(3)
    v_pk_add_f32 v[72:73], v[72:73], v[24:25]
    v_pk_add_f32 v[74:75], v[74:75], v[26:27]
    s_waitcnt lgkmcnt(2)
    v_pk_add_f32 v[76:77], v[76:77], v[28:29]
    v_pk_add_f32 v[78:79], v[78:79], v[30:31]
    s_waitcnt lgkmcnt(1)
    v_pk_add_f32 v[80:81], v[80:81], v[32:33]
    v_pk_add_f32 v[82:83], v[82:83], v[34:35]
    s_waitcnt lgkmcnt(0)
    v_pk_add_f32 v[84:85], v[84:85], v[36:37]
    v_pk_add_f32 v[86:87], v[86:87], v[38:39]
    s_branch X_RD_107
X_R1_106:
    ds_read_b128 v[16:19], v13 offset:0
    ds_read_b128 v[20:23], v13 offset:1024
    ds_read_b128 v[24:27], v13 offset:2048
    ds_read_b128 v[28:31], v13 offset:3072
    s_waitcnt lgkmcnt(3)
    v_pk_add_f32 v[64:65], v[88:89], v[16:17]
    v_pk_add_f32 v[66:67], v[90:91], v[18:19]
    s_waitcnt lgkmcnt(2)
    v_pk_add_f32 v[68:69], v[92:93], v[20:21]
    v_pk_add_f32 v[70:71], v[94:95], v[22:23]
    s_waitcnt lgkmcnt(1)
    v_pk_add_f32 v[72:73], v[96:97], v[24:25]
    v_pk_add_f32 v[74:75], v[98:99], v[26:27]
    s_waitcnt lgkmcnt(0)
    v_pk_add_f32 v[76:77], v[100:101], v[28:29]
    v_pk_add_f32 v[78:79], v[102:103], v[30:31]
X_RD_107:
    v_pk_fma_f32 v[64:65], v[196:197], v[64:65], v[136:137]
    v_cvt_pk_bf16_f32 v16, v64, v65
    v_pk_fma_f32 v[66:67], v[198:199], v[66:67], v[138:139]
    v_cvt_pk_bf16_f32 v17, v66, v67
    v_pk_fma_f32 v[68:69], v[200:201], v[68:69], v[140:141]
    v_cvt_pk_bf16_f32 v18, v68, v69
    v_pk_fma_f32 v[70:71], v[202:203], v[70:71], v[142:143]
    v_cvt_pk_bf16_f32 v19, v70, v71
    v_permlane32_swap_b32 v16, v18
    s_nop 0
    v_permlane32_swap_b32 v17, v19
    buffer_store_dwordx4 v[16:19], v8, s[36:39], s32 offen offset:0
    v_pk_fma_f32 v[72:73], v[204:205], v[72:73], v[144:145]
    v_cvt_pk_bf16_f32 v20, v72, v73
    v_pk_fma_f32 v[74:75], v[206:207], v[74:75], v[146:147]
    v_cvt_pk_bf16_f32 v21, v74, v75
    v_pk_fma_f32 v[76:77], v[208:209], v[76:77], v[148:149]
    v_cvt_pk_bf16_f32 v22, v76, v77
    v_pk_fma_f32 v[78:79], v[210:211], v[78:79], v[150:151]
    v_cvt_pk_bf16_f32 v23, v78, v79
    v_permlane32_swap_b32 v20, v22
    s_nop 0
    v_permlane32_swap_b32 v21, v23
    buffer_store_dwordx4 v[20:23], v8, s[36:39], s32 offen offset:32
    s_cmp_eq_u32 s27, 1
    s_cbranch_scc1 E_F2_108
    v_pk_fma_f32 v[80:81], v[212:213], v[80:81], v[152:153]
    v_cvt_pk_bf16_f32 v24, v80, v81
    v_pk_fma_f32 v[82:83], v[214:215], v[82:83], v[154:155]
    v_cvt_pk_bf16_f32 v25, v82, v83
    v_pk_fma_f32 v[84:85], v[216:217], v[84:85], v[156:157]
    v_cvt_pk_bf16_f32 v26, v84, v85
    v_pk_fma_f32 v[86:87], v[218:219], v[86:87], v[158:159]
    v_cvt_pk_bf16_f32 v27, v86, v87
    v_permlane32_swap_b32 v24, v26
    s_nop 0
    v_permlane32_swap_b32 v25, v27
    buffer_store_dwordx4 v[24:27], v8, s[36:39], s32 offen offset:64
E_F2_108:
KP_END:
    s_endpgm
KP_CODE_END:

.section .rodata,"a"
.p2align 6
.amdhsa_kernel k0_kernel
  .amdhsa_next_free_vgpr 72
  .amdhsa_next_free_sgpr 70
  .amdhsa_accum_offset 72
  .amdhsa_group_segment_fixed_size 0
  .amdhsa_kernarg_size 96
  .amdhsa_user_sgpr_count 2
  .amdhsa_user_sgpr_kernarg_segment_ptr 1
  .amdhsa_system_sgpr_workgroup_id_x 1
  .amdhsa_float_denorm_mode_32 3
.end_amdhsa_kernel
.p2align 6
.amdhsa_kernel kp_kernel
  .amdhsa_next_free_vgpr 512
  .amdhsa_next_free_sgpr 96
  .amdhsa_accum_offset 256
  .amdhsa_group_segment_fixed_size 0
  .amdhsa_kernarg_size 96
  .amdhsa_user_sgpr_count 2
  .amdhsa_user_sgpr_kernarg_segment_ptr 1
  .amdhsa_system_sgpr_workgroup_id_x 1
  .amdhsa_float_denorm_mode_32 3
.end_amdhsa_kernel
```
